```python
import torch

def _softmax(x, axis=-1):
    return torch.softmax(x, dim=axis)
def _gelu(x):
    return torch.nn.functional.gelu(x, approximate="tanh")
def _silu(x):
    return torch.nn.functional.silu(x)
def _sigmoid(x):
    return torch.sigmoid(x)
def _layernorm(x, axis=-1, eps=1e-5):
    m = x.mean(dim=axis, keepdim=True)
    v = x.var(dim=axis, keepdim=True, unbiased=False)
    return (x - m) / torch.sqrt(v + eps)
def _scatter_add(tgt, idx, src, axis=0):
    return tgt.clone().index_add_(axis, idx, src)
def _segment_sum(src, seg, n):
    out = torch.zeros((n,) + src.shape[1:], dtype=src.dtype)
    return out.index_add_(0, seg, src)
def _pad(x, pw):
    flat = tuple(v for pair in reversed(pw) for v in pair)
    return torch.nn.functional.pad(x, flat)

kernel_name = 'interleave_layers__ssm_conv_h3__mixer_channel_mlp__prompt'

def setup_inputs():

    _w = (lambda a: (lambda t: t.to(torch.bfloat16) if t.is_floating_point() else t)(torch.as_tensor(a)))
    def _A_setup():
        B, S, D = 1, 2048, 640
        ks = 4
        return {
            "q": _w((lambda *s: torch.randn(*s, dtype=torch.bfloat16) * 0.05)(B, S, D)),
            "k": _w((lambda *s: torch.randn(*s, dtype=torch.bfloat16) * 0.2)(B, S, D)),
            "v": _w((lambda *s: torch.randn(*s, dtype=torch.bfloat16) * 0.2)(B, S, D)),
            "shift_k": _w((lambda *s: torch.randn(*s, dtype=torch.bfloat16) * 0.2)(D, ks) * 0.5),
            "ssm_k": _w((lambda *s: torch.randn(*s, dtype=torch.bfloat16) * 0.4)(D, S) * (1.0 / S ** 0.5)),
            "ssm_D": _w((lambda *s: torch.randn(*s, dtype=torch.bfloat16) * 0.2)(D)),
        }
    _A_in = _A_setup()

    def _B_setup():
        B, S, D, F = 1, 2048, 640, 1728
        return {
            "x": _w((lambda *s: torch.randn(*s, dtype=torch.bfloat16) * 0.05)(B, S, D)),
            "w1": _w((lambda *s: torch.randn(*s, dtype=torch.bfloat16) * 0.8)(D, F) * (D ** -0.5)),
            "b1": _w((lambda *s: torch.randn(*s, dtype=torch.bfloat16) * 0.4)(F)),
            "w2": _w((lambda *s: torch.randn(*s, dtype=torch.bfloat16) * 0.05)(F, D) * (F ** -0.5)),
            "b2": _w((lambda *s: torch.randn(*s, dtype=torch.bfloat16) * 0.05)(D)),
        }
    _B_in = _B_setup()

    return {
        "A_q": _A_in["q"],
        "A_k": _A_in["k"],
        "A_v": _A_in["v"],
        "A_shift_k": _A_in["shift_k"],
        "A_ssm_k": _A_in["ssm_k"],
        "A_ssm_D": _A_in["ssm_D"],
        "B_x": _B_in["x"],
        "B_w1": _B_in["w1"],
        "B_b1": _B_in["b1"],
        "B_w2": _B_in["w2"],
        "B_b2": _B_in["b2"],
    }

def reference(A_q, A_k, A_v, A_shift_k, A_ssm_k, A_ssm_D, B_x, B_w1, B_b1, B_w2, B_b2):
    def _A_ref(q, k, v, shift_k, ssm_k, ssm_D):
        B, S, D = q.shape
        ks = shift_k.shape[-1]
        k_pad = _pad(k, ((0, 0), (ks - 1, 0), (0, 0)))
        k_shift = torch.zeros_like(k)
        for t in range(ks):
            k_shift = k_shift + k_pad[:, t:t + S, :] * shift_k[:, ks - 1 - t][None, None, :]
        kv = k_shift * v
        L = 2 * S
        kv_pad = _pad(kv, ((0, 0), (0, S), (0, 0)))
        kf_pad = _pad(ssm_k, ((0, 0), (0, S)))
        kv_f = (lambda x, axes=(-2,-1): torch.fft.rfft2(x.float(), dim=axes))(kv_pad[:, None, :, :], axes=(1, 2))
        kf_f = (lambda x, axes=(-2,-1): torch.fft.rfft2(x.float(), dim=axes))(kf_pad[:, None, :], axes=(1, 2))
        kf_f = (lambda x, *d: x.permute(*d))(kf_f, 1, 2, 0)
        y_f = kv_f * kf_f[None, :, :, :]
        y = (lambda x, s, axes=(-2,-1): torch.fft.irfft2(x, s=s, dim=axes).to(torch.bfloat16))(y_f, (1, L), axes=(1, 2))[:, 0, :S, :]
        y = y + kv * ssm_D[None, None, :]
        return q * y

    def _B_ref(x, w1, b1, w2, b2):
        y = _layernorm(x, axis=-1)
        h = _gelu(torch.einsum("bsd,df->bsf", y, w1) + b1)
        return torch.einsum("bsf,fd->bsd", h, w2) + b2

    x = A_q
    x = x + _A_ref(_layernorm(x, axis=-1), A_k, A_v, A_shift_k, A_ssm_k, A_ssm_D)
    x = x + _B_ref(_layernorm(x, axis=-1), B_w1, B_b1, B_w2, B_b2)
    x = x + _A_ref(_layernorm(x, axis=-1), A_k, A_v, A_shift_k, A_ssm_k, A_ssm_D)
    x = x + _B_ref(_layernorm(x, axis=-1), B_w1, B_b1, B_w2, B_b2)
    return x
```

```asm
; @launch grid=(256,1,1) block=(512,1,1) lds=163840
.amdgcn_target "amdgcn-amd-amdhsa--gfx950"
.text
.globl interleave_layers__ssm_conv_h3__mixer_channel_mlp__prompt_kernel
.p2align 8
.type interleave_layers__ssm_conv_h3__mixer_channel_mlp__prompt_kernel,@function
interleave_layers__ssm_conv_h3__mixer_channel_mlp__prompt_kernel:
    s_cmp_ge_u32 s2, 256
    s_cbranch_scc1 END
    s_load_dwordx2 s[26:27], s[0:1], 104
    s_load_dwordx4 s[4:7], s[0:1], 0
    s_load_dwordx4 s[8:11], s[0:1], 16
    s_load_dwordx4 s[12:15], s[0:1], 32
    s_load_dwordx4 s[16:19], s[0:1], 56
    s_load_dwordx4 s[20:23], s[0:1], 72
    s_load_dwordx2 s[24:25], s[0:1], 88
    v_lshrrev_b32 v1, 6, v0
    s_nop 0
    v_readfirstlane_b32 s29, v1
    v_and_b32 v1, 63, v0
    v_lshlrev_b32 v2, 4, v1
    v_lshlrev_b32 v3, 2, v1
    s_and_b32 s28, s2, 7
    s_lshr_b32 s30, s2, 3
    s_and_b32 s31, s29, 3
    s_lshr_b32 s52, s29, 2
    v_mov_b32 v12, 0
    v_mov_b32 v13, 0
    v_mov_b32 v14, 0
    v_mov_b32 v15, 0
    v_add_u32 v4, 163328, v3
    ds_write_b32 v4, v12
    s_lshl_b32 s64, s29, 10
    s_add_u32 s64, s64, 122880
    v_add_u32 v4, s64, v2
    ds_write_b128 v4, v[12:15]
    s_movk_i32 s65, 5958
    s_movk_i32 s66, 1104
    s_add_u32 s67, s31, 8
    s_lshl_b32 s67, s67, 6
    v_mul_u32_u24 v10, s65, v0
    v_lshrrev_b32 v10, 16, v10
    v_mul_u32_u24 v11, 11, v10
    v_sub_u32 v11, v0, v11
    v_lshlrev_b32 v8, 4, v0
    v_mad_u32_u24 v8, v10, s66, v8
    v_cmp_eq_u32 vcc, 10, v11
    v_mov_b32 v11, 0x40000000
    s_nop 0
    v_cndmask_b32 v8, v8, v11, vcc
    v_add_u32 v9, s67, v1
    v_mul_u32_u24 v10, s65, v9
    v_lshrrev_b32 v10, 16, v10
    v_mul_u32_u24 v11, 11, v10
    v_sub_u32 v11, v9, v11
    v_lshlrev_b32 v9, 4, v9
    v_mad_u32_u24 v9, v10, s66, v9
    v_cmp_eq_u32 vcc, 10, v11
    v_mov_b32 v11, 0x40000000
    s_nop 0
    v_cndmask_b32 v9, v9, v11, vcc
    s_mul_i32 s65, s30, 81920
    s_mul_i32 s66, s28, 160
    s_add_u32 s65, s65, s66
    s_sub_u32 s66, s65, 5120
    v_add_u32 v10, s66, v8
    v_add_u32 v8, s65, v8
    s_cmp_eq_u32 s52, 0
    s_cselect_b32 s65, s66, s65
    v_add_u32 v9, s65, v9
    s_getreg_b32 s54, hwreg(HW_REG_XCC_ID, 0, 3)
    s_mov_b32 s57, 20000
    s_mov_b32 s59, 0xffff0000
    s_mov_b32 s60, 0x3acccccd
    s_mov_b32 s61, 0x3727c5ac
    s_mov_b32 s62, 0x3eeff558
    s_mov_b32 s89, 0x3f80
    s_mov_b32 s90, 0x3f800000
    s_mov_b32 s55, 0
    s_mov_b32 m0, s64
    s_waitcnt lgkmcnt(0)
    s_mov_b32 s32, s26
    s_mov_b32 s33, s27
    s_mov_b32 s34, 0x10000000
    s_mov_b32 s35, 0x20000
    s_mov_b32 s40, s6
    s_mov_b32 s41, s7
    s_mov_b32 s42, 0x280000
    s_mov_b32 s43, 0x20000
    s_mov_b32 s44, s8
    s_mov_b32 s45, s9
    s_mov_b32 s46, 0x280000
    s_mov_b32 s47, 0x20000
    buffer_load_dword v4, off, s[32:35], 0 sc1
    buffer_load_dwordx4 v10, s[40:43], 0 offen lds
    s_add_u32 m0, s64, 12288
    s_nop 0
    buffer_load_dwordx4 v8, s[44:47], 0 offen lds
    s_cmp_eq_u32 s52, 0
    s_cselect_b64 s[44:45], s[40:41], s[44:45]
    s_cselect_b32 s65, 131072, s57
    s_cselect_b32 s66, 0, 123360
    s_add_u32 s65, s65, s66
    s_lshl_b32 s66, s31, 10
    s_add_u32 m0, s65, s66
    s_nop 0
    buffer_load_dwordx4 v9, s[44:47], 0 offen lds
    s_mov_b64 s[36:37], s[32:33]
    s_mov_b64 s[38:39], s[34:35]
    s_mov_b64 s[48:49], s[32:33]
    s_mov_b64 s[50:51], s[34:35]
    v_mov_b32 v76, 0
    v_mov_b32 v77, 0
    v_mov_b32 v78, 0
    v_mov_b32 v79, 0
    v_mov_b32 v80, 0
    s_barrier
    s_cmp_ge_u32 s29, 5
    s_cbranch_scc1 E_BLD
    s_cmp_ge_u32 s30, 29
    s_cbranch_scc1 E_10
    s_cmp_ge_u32 s30, 14
    s_cbranch_scc1 E_12
    s_mov_b32 s48, s10
    s_mov_b32 s49, s11
    s_mov_b32 s50, 5120
    s_mov_b32 s51, 0x20000
    s_mul_i32 s66, s28, 640
    s_lshl_b32 s67, s29, 7
    s_add_u32 s66, s66, s67
    v_and_b32 v10, 3, v1
    v_lshlrev_b32 v10, 3, v10
    buffer_load_dwordx2 v[16:17], v10, s[48:51], s66 offen offset:0
    buffer_load_dwordx2 v[18:19], v10, s[48:51], s66 offen offset:32
    buffer_load_dwordx2 v[20:21], v10, s[48:51], s66 offen offset:64
    buffer_load_dwordx2 v[22:23], v10, s[48:51], s66 offen offset:96
    s_mov_b32 s36, s16
    s_mov_b32 s37, s17
    s_mov_b32 s38, 2211840
    s_mov_b32 s39, 0x20000
    s_lshl_b32 s66, s30, 8
    v_lshrrev_b32 v10, 4, v1
    v_bfe_u32 v11, v1, 2, 2
    v_xor_b32 v12, v10, v11
    v_and_b32 v13, 3, v1
    v_lshl_add_u32 v12, v12, 2, v13
    v_mul_u32_u24 v8, 3456, v10
    v_lshl_add_u32 v8, v12, 4, v8
    v_add_u32 v8, s66, v8
    v_lshrrev_b32 v12, 5, v1
    v_lshl_add_u32 v12, v12, 3, v11
    v_lshlrev_b32 v9, 8, v12
    v_xor_b32 v12, s31, v11
    v_lshl_add_u32 v9, v12, 6, v9
    v_and_b32 v12, 1, v13
    v_lshl_add_u32 v9, v12, 5, v9
    v_and_b32 v12, 1, v10
    v_lshl_add_u32 v9, v12, 4, v9
    v_lshrrev_b32 v12, 1, v13
    v_lshl_add_u32 v9, v12, 3, v9
    s_waitcnt vmcnt(4)
    v_readfirstlane_b32 s53, v4
    s_nop 1
    s_mul_i32 s53, s53, 0x9E3779B1
    s_add_u32 s53, s53, 0x7F4A7C15
    s_barrier
    s_branch KV
E_12:
    s_mov_b32 s48, s10
    s_mov_b32 s49, s11
    s_mov_b32 s50, 5120
    s_mov_b32 s51, 0x20000
    s_mul_i32 s66, s28, 640
    s_lshl_b32 s67, s29, 7
    s_add_u32 s66, s66, s67
    v_and_b32 v10, 3, v1
    v_lshlrev_b32 v10, 3, v10
    buffer_load_dwordx2 v[16:17], v10, s[48:51], s66 offen offset:0
    buffer_load_dwordx2 v[18:19], v10, s[48:51], s66 offen offset:32
    buffer_load_dwordx2 v[20:21], v10, s[48:51], s66 offen offset:64
    buffer_load_dwordx2 v[22:23], v10, s[48:51], s66 offen offset:96
    s_mov_b32 s36, s20
    s_mov_b32 s37, s21
    s_mov_b32 s38, 2211840
    s_mov_b32 s39, 0x20000
    s_sub_u32 s67, s30, 14
    s_mul_i32 s66, s67, 52
    s_lshr_b32 s66, s66, 8
    s_mul_i32 s63, s66, 5
    s_sub_u32 s67, s67, s63
    s_mul_i32 s66, s66, 737280
    s_lshl_b32 s67, s67, 8
    s_add_u32 s66, s66, s67
    v_lshrrev_b32 v10, 4, v1
    v_bfe_u32 v11, v1, 2, 2
    v_xor_b32 v12, v10, v11
    v_and_b32 v13, 3, v1
    v_lshl_add_u32 v12, v12, 2, v13
    v_mul_u32_u24 v8, 1280, v10
    v_lshl_add_u32 v8, v12, 4, v8
    v_add_u32 v8, s66, v8
    v_lshrrev_b32 v12, 5, v1
    v_lshl_add_u32 v12, v12, 3, v11
    v_lshlrev_b32 v9, 8, v12
    v_xor_b32 v12, s31, v11
    v_lshl_add_u32 v9, v12, 6, v9
    v_and_b32 v12, 1, v13
    v_lshl_add_u32 v9, v12, 5, v9
    v_and_b32 v12, 1, v10
    v_lshl_add_u32 v9, v12, 4, v9
    v_lshrrev_b32 v12, 1, v13
    v_lshl_add_u32 v9, v12, 3, v9
    s_waitcnt vmcnt(4)
    v_readfirstlane_b32 s53, v4
    s_nop 1
    s_mul_i32 s53, s53, 0x9E3779B1
    s_add_u32 s53, s53, 0x7F4A7C15
    s_barrier
    s_branch KV
E_10:
    s_mov_b32 s48, s10
    s_mov_b32 s49, s11
    s_mov_b32 s50, 5120
    s_mov_b32 s51, 0x20000
    s_mul_i32 s66, s28, 640
    s_lshl_b32 s67, s29, 7
    s_add_u32 s66, s66, s67
    v_and_b32 v10, 3, v1
    v_lshlrev_b32 v10, 3, v10
    buffer_load_dwordx2 v[16:17], v10, s[48:51], s66 offen offset:0
    buffer_load_dwordx2 v[18:19], v10, s[48:51], s66 offen offset:32
    buffer_load_dwordx2 v[20:21], v10, s[48:51], s66 offen offset:64
    buffer_load_dwordx2 v[22:23], v10, s[48:51], s66 offen offset:96
    s_waitcnt vmcnt(4)
    v_readfirstlane_b32 s53, v4
    s_nop 1
    s_mul_i32 s53, s53, 0x9E3779B1
    s_add_u32 s53, s53, 0x7F4A7C15
    s_barrier
    s_branch KV
E_BLD:
    s_cmp_ge_u32 s30, 29
    s_cbranch_scc1 E_00
    s_cmp_ge_u32 s30, 14
    s_cbranch_scc1 E_02
    s_cmp_eq_u32 s29, 7
    s_cbranch_scc1 E_LD
    s_cmp_eq_u32 s29, 6
    s_cselect_b32 s67, 0, 0x10000000
    v_add_u32 v6, s67, v2
    v_mov_b32 v12, -1
    v_mov_b32 v13, -1
    v_mov_b32 v14, -1
    v_mov_b32 v15, -1
    s_lshr_b32 s66, s30, 2
    s_lshl_b32 s66, s66, 3
    s_add_u32 s66, s66, s28
    s_lshl_b32 s66, s66, 2
    s_and_b32 s67, s30, 3
    s_add_u32 s66, s66, s67
    s_mul_i32 s66, s66, 10240
    s_add_u32 s66, s66, 0x700000
    buffer_store_dwordx4 v[12:15], v6, s[32:35], s66 offen offset:0 sc1
    buffer_store_dwordx4 v[12:15], v6, s[32:35], s66 offen offset:1024 sc1
    buffer_store_dwordx4 v[12:15], v6, s[32:35], s66 offen offset:2048 sc1
    buffer_store_dwordx4 v[12:15], v6, s[32:35], s66 offen offset:3072 sc1
    s_add_u32 s66, s66, 4096
    buffer_store_dwordx4 v[12:15], v6, s[32:35], s66 offen offset:0 sc1
    buffer_store_dwordx4 v[12:15], v6, s[32:35], s66 offen offset:1024 sc1
    buffer_store_dwordx4 v[12:15], v6, s[32:35], s66 offen offset:2048 sc1
    buffer_store_dwordx4 v[12:15], v6, s[32:35], s66 offen offset:3072 sc1
    s_add_u32 s66, s66, 4096
    buffer_store_dwordx4 v[12:15], v6, s[32:35], s66 offen offset:0 sc1
    buffer_store_dwordx4 v[12:15], v6, s[32:35], s66 offen offset:1024 sc1
    s_sub_u32 s68, s29, 5
    s_lshl_b32 s66, s30, 1
    s_add_u32 s66, s66, s68
    s_cmp_ge_u32 s66, 80
    s_cselect_b32 s67, 1, 0
    s_cselect_b32 s63, 80, 0
    s_sub_u32 s66, s66, s63
    s_mul_i32 s67, s28, 80
    s_add_u32 s66, s66, s67
    s_lshl_b32 s66, s66, 12
    s_add_u32 s48, s12, s66
    s_addc_u32 s49, s13, 0
    s_mov_b32 s50, 4096
    s_mov_b32 s51, 0x20000
    v_subrev_u32 v10, 32, v2
    v_subrev_u32 v11, 16, v2
    v_add_u32 v12, 992, v2
    buffer_load_dwordx4 v[16:19], v10, s[48:51], 0 offen
    buffer_load_dwordx2 v[40:41], v11, s[48:51], 0 offen
    buffer_load_dwordx4 v[20:23], v12, s[48:51], 0 offen offset:0
    buffer_load_dwordx2 v[42:43], v12, s[48:51], 0 offen offset:16
    buffer_load_dwordx4 v[24:27], v12, s[48:51], 0 offen offset:1024
    buffer_load_dwordx2 v[44:45], v12, s[48:51], 0 offen offset:1040
    buffer_load_dwordx4 v[28:31], v12, s[48:51], 0 offen offset:2048
    buffer_load_dwordx2 v[46:47], v12, s[48:51], 0 offen offset:2064
    buffer_load_dwordx4 v[32:35], v12, s[48:51], 0 offen offset:3072
    buffer_load_dwordx2 v[48:49], v12, s[48:51], 0 offen offset:3088
    s_mov_b32 s36, s16
    s_mov_b32 s37, s17
    s_mov_b32 s38, 2211840
    s_mov_b32 s39, 0x20000
    s_lshl_b32 s66, s30, 8
    v_lshrrev_b32 v10, 4, v1
    v_bfe_u32 v11, v1, 2, 2
    v_xor_b32 v12, v10, v11
    v_and_b32 v13, 3, v1
    v_lshl_add_u32 v12, v12, 2, v13
    v_mul_u32_u24 v8, 3456, v10
    v_lshl_add_u32 v8, v12, 4, v8
    v_add_u32 v8, s66, v8
    v_lshrrev_b32 v12, 5, v1
    v_lshl_add_u32 v12, v12, 3, v11
    v_lshlrev_b32 v9, 8, v12
    v_xor_b32 v12, s31, v11
    v_lshl_add_u32 v9, v12, 6, v9
    v_and_b32 v12, 1, v13
    v_lshl_add_u32 v9, v12, 5, v9
    v_and_b32 v12, 1, v10
    v_lshl_add_u32 v9, v12, 4, v9
    v_lshrrev_b32 v12, 1, v13
    v_lshl_add_u32 v9, v12, 3, v9
    s_waitcnt vmcnt(20)
    v_readfirstlane_b32 s53, v4
    s_nop 1
    s_mul_i32 s53, s53, 0x9E3779B1
    s_add_u32 s53, s53, 0x7F4A7C15
    s_barrier
    s_waitcnt vmcnt(0)
    s_lshr_b32 s66, s2, 2
    s_lshl_b32 s66, s66, 5
    s_and_b32 s67, s2, 3
    s_add_u32 s66, s66, s67
    s_lshl_b32 s66, s66, 2
    s_add_u32 s66, s66, 327680
    v_mov_b32 v4, s53
    s_mov_b64 exec, 1
    buffer_store_dword v4, v6, s[32:35], s66 offen sc1
    s_mov_b64 exec, -1
    s_mul_i32 s66, s68, 21248
    v_add_u32 v5, s66, v2
    v_mov_b32 v56, 0
    v_mov_b32 v57, 0
    v_mov_b32 v58, 0
    v_mov_b32 v59, 0
    s_mov_b32 exec_lo, -1
    s_mov_b32 exec_hi, 0
    ds_write_b128 v5, v[56:59] offset:20736
    s_mov_b64 exec, -1
    ds_write_b128 v5, v[16:19] offset:0
    v_alignbit_b32 v60, v17, v16, 16
    v_alignbit_b32 v61, v18, v17, 16
    v_alignbit_b32 v62, v19, v18, 16
    v_alignbit_b32 v63, v40, v19, 16
    ds_write_b128 v5, v[60:63] offset:4160
    v_mov_b32 v64, v17
    v_mov_b32 v65, v18
    v_mov_b32 v66, v19
    v_mov_b32 v67, v40
    ds_write_b128 v5, v[64:67] offset:8320
    v_alignbit_b32 v68, v18, v17, 16
    v_alignbit_b32 v69, v19, v18, 16
    v_alignbit_b32 v70, v40, v19, 16
    v_alignbit_b32 v71, v41, v40, 16
    ds_write_b128 v5, v[68:71] offset:12480
    ds_write_b128 v5, v[20:23] offset:1024
    v_alignbit_b32 v72, v21, v20, 16
    v_alignbit_b32 v73, v22, v21, 16
    v_alignbit_b32 v74, v23, v22, 16
    v_alignbit_b32 v75, v42, v23, 16
    ds_write_b128 v5, v[72:75] offset:5184
    v_mov_b32 v76, v21
    v_mov_b32 v77, v22
    v_mov_b32 v78, v23
    v_mov_b32 v79, v42
    ds_write_b128 v5, v[76:79] offset:9344
    v_alignbit_b32 v80, v22, v21, 16
    v_alignbit_b32 v81, v23, v22, 16
    v_alignbit_b32 v82, v42, v23, 16
    v_alignbit_b32 v83, v43, v42, 16
    ds_write_b128 v5, v[80:83] offset:13504
    s_waitcnt lgkmcnt(4)
    ds_write_b128 v5, v[24:27] offset:2048
    v_alignbit_b32 v60, v25, v24, 16
    v_alignbit_b32 v61, v26, v25, 16
    v_alignbit_b32 v62, v27, v26, 16
    v_alignbit_b32 v63, v44, v27, 16
    ds_write_b128 v5, v[60:63] offset:6208
    v_mov_b32 v64, v25
    v_mov_b32 v65, v26
    v_mov_b32 v66, v27
    v_mov_b32 v67, v44
    ds_write_b128 v5, v[64:67] offset:10368
    v_alignbit_b32 v68, v26, v25, 16
    v_alignbit_b32 v69, v27, v26, 16
    v_alignbit_b32 v70, v44, v27, 16
    v_alignbit_b32 v71, v45, v44, 16
    ds_write_b128 v5, v[68:71] offset:14528
    ds_write_b128 v5, v[28:31] offset:3072
    v_alignbit_b32 v72, v29, v28, 16
    v_alignbit_b32 v73, v30, v29, 16
    v_alignbit_b32 v74, v31, v30, 16
    v_alignbit_b32 v75, v46, v31, 16
    ds_write_b128 v5, v[72:75] offset:7232
    v_mov_b32 v76, v29
    v_mov_b32 v77, v30
    v_mov_b32 v78, v31
    v_mov_b32 v79, v46
    ds_write_b128 v5, v[76:79] offset:11392
    v_alignbit_b32 v80, v30, v29, 16
    v_alignbit_b32 v81, v31, v30, 16
    v_alignbit_b32 v82, v46, v31, 16
    v_alignbit_b32 v83, v47, v46, 16
    ds_write_b128 v5, v[80:83] offset:15552
    s_waitcnt lgkmcnt(4)
    s_mov_b64 exec, 3
    ds_write_b128 v5, v[32:35] offset:4096
    v_alignbit_b32 v60, v33, v32, 16
    v_alignbit_b32 v61, v34, v33, 16
    v_alignbit_b32 v62, v35, v34, 16
    v_alignbit_b32 v63, v48, v35, 16
    ds_write_b128 v5, v[60:63] offset:8256
    v_mov_b32 v64, v33
    v_mov_b32 v65, v34
    v_mov_b32 v66, v35
    v_mov_b32 v67, v48
    ds_write_b128 v5, v[64:67] offset:12416
    v_alignbit_b32 v68, v34, v33, 16
    v_alignbit_b32 v69, v35, v34, 16
    v_alignbit_b32 v70, v48, v35, 16
    v_alignbit_b32 v71, v49, v48, 16
    ds_write_b128 v5, v[68:71] offset:16576
    s_mov_b64 exec, -1
    s_branch NOBUILD
E_LD:
    s_mov_b32 s36, s16
    s_mov_b32 s37, s17
    s_mov_b32 s38, 2211840
    s_mov_b32 s39, 0x20000
    s_lshl_b32 s66, s30, 8
    v_lshrrev_b32 v10, 4, v1
    v_bfe_u32 v11, v1, 2, 2
    v_xor_b32 v12, v10, v11
    v_and_b32 v13, 3, v1
    v_lshl_add_u32 v12, v12, 2, v13
    v_mul_u32_u24 v8, 3456, v10
    v_lshl_add_u32 v8, v12, 4, v8
    v_add_u32 v8, s66, v8
    v_lshrrev_b32 v12, 5, v1
    v_lshl_add_u32 v12, v12, 3, v11
    v_lshlrev_b32 v9, 8, v12
    v_xor_b32 v12, s31, v11
    v_lshl_add_u32 v9, v12, 6, v9
    v_and_b32 v12, 1, v13
    v_lshl_add_u32 v9, v12, 5, v9
    v_and_b32 v12, 1, v10
    v_lshl_add_u32 v9, v12, 4, v9
    v_lshrrev_b32 v12, 1, v13
    v_lshl_add_u32 v9, v12, 3, v9
    s_sub_u32 s63, s29, 7
    s_lshl_b32 s92, s63, 10
    s_add_u32 s92, s92, 44544
    s_add_u32 s63, s63, 0
    s_mul_i32 s91, s63, 13824
    s_mov_b32 s93, 13824
    s_mov_b32 m0, s92
    s_add_u32 s92, s92, 1024
    buffer_load_dwordx4 v8, s[36:39], s91 offen lds
    s_add_u32 s91, s91, s93
    s_mov_b32 m0, s92
    s_add_u32 s92, s92, 1024
    buffer_load_dwordx4 v8, s[36:39], s91 offen lds
    s_add_u32 s91, s91, s93
    s_mov_b32 m0, s92
    s_add_u32 s92, s92, 1024
    buffer_load_dwordx4 v8, s[36:39], s91 offen lds
    s_add_u32 s91, s91, s93
    s_mov_b32 m0, s92
    s_add_u32 s92, s92, 1024
    buffer_load_dwordx4 v8, s[36:39], s91 offen lds
    s_add_u32 s91, s91, s93
    s_mov_b32 m0, s92
    s_add_u32 s92, s92, 1024
    buffer_load_dwordx4 v8, s[36:39], s91 offen lds
    s_add_u32 s91, s91, s93
    s_mov_b32 m0, s92
    s_add_u32 s92, s92, 1024
    buffer_load_dwordx4 v8, s[36:39], s91 offen lds
    s_add_u32 s91, s91, s93
    s_mov_b32 m0, s92
    s_add_u32 s92, s92, 1024
    buffer_load_dwordx4 v8, s[36:39], s91 offen lds
    s_add_u32 s91, s91, s93
    s_mov_b32 m0, s92
    s_add_u32 s92, s92, 1024
    buffer_load_dwordx4 v8, s[36:39], s91 offen lds
    s_add_u32 s91, s91, s93
    s_mov_b32 m0, s92
    s_add_u32 s92, s92, 1024
    buffer_load_dwordx4 v8, s[36:39], s91 offen lds
    s_add_u32 s91, s91, s93
    s_mov_b32 m0, s92
    s_add_u32 s92, s92, 1024
    buffer_load_dwordx4 v8, s[36:39], s91 offen lds
    s_add_u32 s91, s91, s93
    s_mov_b32 m0, s92
    s_add_u32 s92, s92, 1024
    buffer_load_dwordx4 v8, s[36:39], s91 offen lds
    s_add_u32 s91, s91, s93
    s_mov_b32 m0, s92
    s_add_u32 s92, s92, 1024
    buffer_load_dwordx4 v8, s[36:39], s91 offen lds
    s_add_u32 s91, s91, s93
    s_mov_b32 m0, s92
    s_add_u32 s92, s92, 1024
    buffer_load_dwordx4 v8, s[36:39], s91 offen lds
    s_add_u32 s91, s91, s93
    s_mov_b32 m0, s92
    s_add_u32 s92, s92, 1024
    buffer_load_dwordx4 v8, s[36:39], s91 offen lds
    s_add_u32 s91, s91, s93
    s_mov_b32 m0, s92
    s_add_u32 s92, s92, 1024
    buffer_load_dwordx4 v8, s[36:39], s91 offen lds
    s_add_u32 s91, s91, s93
    s_mov_b32 m0, s92
    s_add_u32 s92, s92, 1024
    buffer_load_dwordx4 v8, s[36:39], s91 offen lds
    s_add_u32 s91, s91, s93
    s_mov_b32 m0, s92
    s_add_u32 s92, s92, 1024
    buffer_load_dwordx4 v8, s[36:39], s91 offen lds
    s_add_u32 s91, s91, s93
    s_mov_b32 m0, s92
    s_add_u32 s92, s92, 1024
    buffer_load_dwordx4 v8, s[36:39], s91 offen lds
    s_add_u32 s91, s91, s93
    s_mov_b32 m0, s92
    s_add_u32 s92, s92, 1024
    buffer_load_dwordx4 v8, s[36:39], s91 offen lds
    s_add_u32 s91, s91, s93
    s_mov_b32 m0, s92
    s_add_u32 s92, s92, 1024
    buffer_load_dwordx4 v8, s[36:39], s91 offen lds
    s_add_u32 s91, s91, s93
    s_mov_b32 m0, s92
    s_add_u32 s92, s92, 1024
    buffer_load_dwordx4 v8, s[36:39], s91 offen lds
    s_add_u32 s91, s91, s93
    s_mov_b32 m0, s92
    s_add_u32 s92, s92, 1024
    buffer_load_dwordx4 v8, s[36:39], s91 offen lds
    s_add_u32 s91, s91, s93
    s_mov_b32 m0, s92
    s_add_u32 s92, s92, 1024
    buffer_load_dwordx4 v8, s[36:39], s91 offen lds
    s_add_u32 s91, s91, s93
    s_mov_b32 m0, s92
    s_add_u32 s92, s92, 1024
    buffer_load_dwordx4 v8, s[36:39], s91 offen lds
    s_add_u32 s91, s91, s93
    s_lshl_b32 s66, s2, 7
    s_and_b32 s66, s66, 0x380
    s_lshl_b32 s66, s66, 5
    s_lshl_b32 s67, s30, 7
    s_add_u32 s66, s66, s67
    s_add_u32 s66, s66, 262144
    s_cmp_eq_u32 s29, 7
    s_cselect_b32 s67, 0, 0x10000000
    v_mov_b32 v5, s67
    s_lshl_b32 s67, s54, 1
    s_waitcnt vmcnt(27)
    v_readfirstlane_b32 s53, v4
    s_nop 1
    s_mul_i32 s53, s53, 0x9E3779B1
    s_add_u32 s53, s53, 0x7F4A7C15
    s_xor_b32 s67, s67, s53
    v_mov_b32 v4, s67
    s_mov_b64 exec, 1
    buffer_store_dword v4, v5, s[32:35], s66 offen sc1
    s_mov_b64 exec, -1
    s_waitcnt vmcnt(25)
    s_barrier
    v_mov_b32 v12, 163356
    v_mov_b32 v10, 1
    ds_write_b32 v12, v10
    ds_write_b32 v12, v10 offset:192
    s_mov_b32 s63, 24
WS_1:
    s_waitcnt vmcnt(23)
    s_mov_b32 m0, s92
    s_add_u32 s92, s92, 1024
    buffer_load_dwordx4 v8, s[36:39], s91 offen lds
    s_add_u32 s91, s91, s93
    s_sub_u32 s63, s63, 1
    s_cmp_lg_u32 s63, 0
    s_cbranch_scc1 WS_1
    s_branch BUILT
E_02:
    s_cmp_eq_u32 s29, 6
    s_cselect_b32 s67, 0, 0x10000000
    v_add_u32 v6, s67, v2
    v_mov_b32 v12, -1
    v_mov_b32 v13, -1
    v_mov_b32 v14, -1
    v_mov_b32 v15, -1
    s_lshr_b32 s66, s30, 2
    s_lshl_b32 s66, s66, 3
    s_add_u32 s66, s66, s28
    s_lshl_b32 s66, s66, 2
    s_and_b32 s67, s30, 3
    s_add_u32 s66, s66, s67
    s_mul_i32 s66, s66, 10240
    s_add_u32 s66, s66, 0x700000
    buffer_store_dwordx4 v[12:15], v6, s[32:35], s66 offen offset:0 sc1
    buffer_store_dwordx4 v[12:15], v6, s[32:35], s66 offen offset:1024 sc1
    buffer_store_dwordx4 v[12:15], v6, s[32:35], s66 offen offset:2048 sc1
    buffer_store_dwordx4 v[12:15], v6, s[32:35], s66 offen offset:3072 sc1
    s_add_u32 s66, s66, 4096
    buffer_store_dwordx4 v[12:15], v6, s[32:35], s66 offen offset:0 sc1
    buffer_store_dwordx4 v[12:15], v6, s[32:35], s66 offen offset:1024 sc1
    buffer_store_dwordx4 v[12:15], v6, s[32:35], s66 offen offset:2048 sc1
    buffer_store_dwordx4 v[12:15], v6, s[32:35], s66 offen offset:3072 sc1
    s_add_u32 s66, s66, 4096
    buffer_store_dwordx4 v[12:15], v6, s[32:35], s66 offen offset:0 sc1
    buffer_store_dwordx4 v[12:15], v6, s[32:35], s66 offen offset:1024 sc1
    s_sub_u32 s68, s29, 5
    s_lshl_b32 s66, s30, 2
    s_sub_u32 s66, s66, 28
    s_add_u32 s66, s66, s68
    s_cmp_ge_u32 s66, 80
    s_cselect_b32 s67, 1, 0
    s_cselect_b32 s63, 80, 0
    s_sub_u32 s66, s66, s63
    s_mul_i32 s67, s28, 80
    s_add_u32 s66, s66, s67
    s_lshl_b32 s66, s66, 12
    s_add_u32 s48, s12, s66
    s_addc_u32 s49, s13, 0
    s_mov_b32 s50, 4096
    s_mov_b32 s51, 0x20000
    v_subrev_u32 v10, 32, v2
    v_subrev_u32 v11, 16, v2
    v_add_u32 v12, 992, v2
    buffer_load_dwordx4 v[16:19], v10, s[48:51], 0 offen
    buffer_load_dwordx2 v[40:41], v11, s[48:51], 0 offen
    buffer_load_dwordx4 v[20:23], v12, s[48:51], 0 offen offset:0
    buffer_load_dwordx2 v[42:43], v12, s[48:51], 0 offen offset:16
    buffer_load_dwordx4 v[24:27], v12, s[48:51], 0 offen offset:1024
    buffer_load_dwordx2 v[44:45], v12, s[48:51], 0 offen offset:1040
    buffer_load_dwordx4 v[28:31], v12, s[48:51], 0 offen offset:2048
    buffer_load_dwordx2 v[46:47], v12, s[48:51], 0 offen offset:2064
    buffer_load_dwordx4 v[32:35], v12, s[48:51], 0 offen offset:3072
    buffer_load_dwordx2 v[48:49], v12, s[48:51], 0 offen offset:3088
    s_mov_b32 s69, 3
    s_lshl_b32 s66, s30, 2
    s_sub_u32 s66, s66, 28
    s_add_u32 s66, s66, s69
    s_cmp_ge_u32 s66, 80
    s_cselect_b32 s67, 1, 0
    s_cselect_b32 s63, 80, 0
    s_sub_u32 s66, s66, s63
    s_mul_i32 s67, s28, 80
    s_add_u32 s66, s66, s67
    s_lshl_b32 s66, s66, 12
    s_add_u32 s48, s12, s66
    s_addc_u32 s49, s13, 0
    s_mov_b32 s50, 4096
    s_mov_b32 s51, 0x20000
    v_subrev_u32 v10, 32, v2
    v_subrev_u32 v11, 16, v2
    v_add_u32 v12, 992, v2
    buffer_load_dwordx4 v[100:103], v10, s[48:51], 0 offen
    buffer_load_dwordx2 v[124:125], v11, s[48:51], 0 offen
    buffer_load_dwordx4 v[104:107], v12, s[48:51], 0 offen offset:0
    buffer_load_dwordx2 v[126:127], v12, s[48:51], 0 offen offset:16
    buffer_load_dwordx4 v[108:111], v12, s[48:51], 0 offen offset:1024
    buffer_load_dwordx2 v[128:129], v12, s[48:51], 0 offen offset:1040
    buffer_load_dwordx4 v[112:115], v12, s[48:51], 0 offen offset:2048
    buffer_load_dwordx2 v[130:131], v12, s[48:51], 0 offen offset:2064
    buffer_load_dwordx4 v[116:119], v12, s[48:51], 0 offen offset:3072
    buffer_load_dwordx2 v[132:133], v12, s[48:51], 0 offen offset:3088
    s_mov_b32 s36, s20
    s_mov_b32 s37, s21
    s_mov_b32 s38, 2211840
    s_mov_b32 s39, 0x20000
    s_sub_u32 s67, s30, 14
    s_mul_i32 s66, s67, 52
    s_lshr_b32 s66, s66, 8
    s_mul_i32 s63, s66, 5
    s_sub_u32 s67, s67, s63
    s_mul_i32 s66, s66, 737280
    s_lshl_b32 s67, s67, 8
    s_add_u32 s66, s66, s67
    v_lshrrev_b32 v10, 4, v1
    v_bfe_u32 v11, v1, 2, 2
    v_xor_b32 v12, v10, v11
    v_and_b32 v13, 3, v1
    v_lshl_add_u32 v12, v12, 2, v13
    v_mul_u32_u24 v8, 1280, v10
    v_lshl_add_u32 v8, v12, 4, v8
    v_add_u32 v8, s66, v8
    v_lshrrev_b32 v12, 5, v1
    v_lshl_add_u32 v12, v12, 3, v11
    v_lshlrev_b32 v9, 8, v12
    v_xor_b32 v12, s31, v11
    v_lshl_add_u32 v9, v12, 6, v9
    v_and_b32 v12, 1, v13
    v_lshl_add_u32 v9, v12, 5, v9
    v_and_b32 v12, 1, v10
    v_lshl_add_u32 v9, v12, 4, v9
    v_lshrrev_b32 v12, 1, v13
    v_lshl_add_u32 v9, v12, 3, v9
    s_lshl_b32 s66, s2, 7
    s_and_b32 s66, s66, 0x380
    s_lshl_b32 s66, s66, 5
    s_lshl_b32 s67, s30, 7
    s_add_u32 s66, s66, s67
    s_add_u32 s66, s66, 262144
    s_cmp_eq_u32 s29, 7
    s_cselect_b32 s67, 0, 0x10000000
    v_mov_b32 v5, s67
    s_lshl_b32 s67, s54, 1
    s_waitcnt vmcnt(33)
    v_readfirstlane_b32 s53, v4
    s_nop 1
    s_mul_i32 s53, s53, 0x9E3779B1
    s_add_u32 s53, s53, 0x7F4A7C15
    s_xor_b32 s67, s67, s53
    v_mov_b32 v4, s67
    s_mov_b64 exec, 1
    buffer_store_dword v4, v5, s[32:35], s66 offen sc1
    s_mov_b64 exec, -1
    s_waitcnt vmcnt(31)
    s_barrier
    s_waitcnt vmcnt(11)
    s_lshr_b32 s66, s2, 2
    s_lshl_b32 s66, s66, 5
    s_and_b32 s67, s2, 3
    s_add_u32 s66, s66, s67
    s_lshl_b32 s66, s66, 2
    s_add_u32 s66, s66, 327680
    v_mov_b32 v4, s53
    s_mov_b64 exec, 1
    buffer_store_dword v4, v6, s[32:35], s66 offen sc1
    s_mov_b64 exec, -1
    s_mul_i32 s66, s68, 21248
    v_add_u32 v5, s66, v2
    v_mov_b32 v56, 0
    v_mov_b32 v57, 0
    v_mov_b32 v58, 0
    v_mov_b32 v59, 0
    s_mov_b32 exec_lo, -1
    s_mov_b32 exec_hi, 0
    ds_write_b128 v5, v[56:59] offset:20736
    s_mov_b64 exec, -1
    ds_write_b128 v5, v[16:19] offset:0
    v_alignbit_b32 v60, v17, v16, 16
    v_alignbit_b32 v61, v18, v17, 16
    v_alignbit_b32 v62, v19, v18, 16
    v_alignbit_b32 v63, v40, v19, 16
    ds_write_b128 v5, v[60:63] offset:4160
    v_mov_b32 v64, v17
    v_mov_b32 v65, v18
    v_mov_b32 v66, v19
    v_mov_b32 v67, v40
    ds_write_b128 v5, v[64:67] offset:8320
    v_alignbit_b32 v68, v18, v17, 16
    v_alignbit_b32 v69, v19, v18, 16
    v_alignbit_b32 v70, v40, v19, 16
    v_alignbit_b32 v71, v41, v40, 16
    ds_write_b128 v5, v[68:71] offset:12480
    ds_write_b128 v5, v[20:23] offset:1024
    v_alignbit_b32 v72, v21, v20, 16
    v_alignbit_b32 v73, v22, v21, 16
    v_alignbit_b32 v74, v23, v22, 16
    v_alignbit_b32 v75, v42, v23, 16
    ds_write_b128 v5, v[72:75] offset:5184
    v_mov_b32 v76, v21
    v_mov_b32 v77, v22
    v_mov_b32 v78, v23
    v_mov_b32 v79, v42
    ds_write_b128 v5, v[76:79] offset:9344
    v_alignbit_b32 v80, v22, v21, 16
    v_alignbit_b32 v81, v23, v22, 16
    v_alignbit_b32 v82, v42, v23, 16
    v_alignbit_b32 v83, v43, v42, 16
    ds_write_b128 v5, v[80:83] offset:13504
    s_waitcnt lgkmcnt(4)
    ds_write_b128 v5, v[24:27] offset:2048
    v_alignbit_b32 v60, v25, v24, 16
    v_alignbit_b32 v61, v26, v25, 16
    v_alignbit_b32 v62, v27, v26, 16
    v_alignbit_b32 v63, v44, v27, 16
    ds_write_b128 v5, v[60:63] offset:6208
    v_mov_b32 v64, v25
    v_mov_b32 v65, v26
    v_mov_b32 v66, v27
    v_mov_b32 v67, v44
    ds_write_b128 v5, v[64:67] offset:10368
    v_alignbit_b32 v68, v26, v25, 16
    v_alignbit_b32 v69, v27, v26, 16
    v_alignbit_b32 v70, v44, v27, 16
    v_alignbit_b32 v71, v45, v44, 16
    ds_write_b128 v5, v[68:71] offset:14528
    ds_write_b128 v5, v[28:31] offset:3072
    v_alignbit_b32 v72, v29, v28, 16
    v_alignbit_b32 v73, v30, v29, 16
    v_alignbit_b32 v74, v31, v30, 16
    v_alignbit_b32 v75, v46, v31, 16
    ds_write_b128 v5, v[72:75] offset:7232
    v_mov_b32 v76, v29
    v_mov_b32 v77, v30
    v_mov_b32 v78, v31
    v_mov_b32 v79, v46
    ds_write_b128 v5, v[76:79] offset:11392
    v_alignbit_b32 v80, v30, v29, 16
    v_alignbit_b32 v81, v31, v30, 16
    v_alignbit_b32 v82, v46, v31, 16
    v_alignbit_b32 v83, v47, v46, 16
    ds_write_b128 v5, v[80:83] offset:15552
    s_waitcnt lgkmcnt(4)
    s_mov_b64 exec, 3
    ds_write_b128 v5, v[32:35] offset:4096
    v_alignbit_b32 v60, v33, v32, 16
    v_alignbit_b32 v61, v34, v33, 16
    v_alignbit_b32 v62, v35, v34, 16
    v_alignbit_b32 v63, v48, v35, 16
    ds_write_b128 v5, v[60:63] offset:8256
    v_mov_b32 v64, v33
    v_mov_b32 v65, v34
    v_mov_b32 v66, v35
    v_mov_b32 v67, v48
    ds_write_b128 v5, v[64:67] offset:12416
    v_alignbit_b32 v68, v34, v33, 16
    v_alignbit_b32 v69, v35, v34, 16
    v_alignbit_b32 v70, v48, v35, 16
    v_alignbit_b32 v71, v49, v48, 16
    ds_write_b128 v5, v[68:71] offset:16576
    s_mov_b64 exec, -1
    s_cmp_lg_u32 s29, 5
    s_cbranch_scc1 NOBUILD
    s_waitcnt vmcnt(2)
    s_mul_i32 s66, s69, 21248
    v_add_u32 v5, s66, v2
    v_mov_b32 v56, 0
    v_mov_b32 v57, 0
    v_mov_b32 v58, 0
    v_mov_b32 v59, 0
    s_mov_b32 exec_lo, -1
    s_mov_b32 exec_hi, 0
    ds_write_b128 v5, v[56:59] offset:20736
    s_mov_b64 exec, -1
    ds_write_b128 v5, v[100:103] offset:0
    v_alignbit_b32 v60, v101, v100, 16
    v_alignbit_b32 v61, v102, v101, 16
    v_alignbit_b32 v62, v103, v102, 16
    v_alignbit_b32 v63, v124, v103, 16
    ds_write_b128 v5, v[60:63] offset:4160
    v_mov_b32 v64, v101
    v_mov_b32 v65, v102
    v_mov_b32 v66, v103
    v_mov_b32 v67, v124
    ds_write_b128 v5, v[64:67] offset:8320
    v_alignbit_b32 v68, v102, v101, 16
    v_alignbit_b32 v69, v103, v102, 16
    v_alignbit_b32 v70, v124, v103, 16
    v_alignbit_b32 v71, v125, v124, 16
    ds_write_b128 v5, v[68:71] offset:12480
    ds_write_b128 v5, v[104:107] offset:1024
    v_alignbit_b32 v72, v105, v104, 16
    v_alignbit_b32 v73, v106, v105, 16
    v_alignbit_b32 v74, v107, v106, 16
    v_alignbit_b32 v75, v126, v107, 16
    ds_write_b128 v5, v[72:75] offset:5184
    v_mov_b32 v76, v105
    v_mov_b32 v77, v106
    v_mov_b32 v78, v107
    v_mov_b32 v79, v126
    ds_write_b128 v5, v[76:79] offset:9344
    v_alignbit_b32 v80, v106, v105, 16
    v_alignbit_b32 v81, v107, v106, 16
    v_alignbit_b32 v82, v126, v107, 16
    v_alignbit_b32 v83, v127, v126, 16
    ds_write_b128 v5, v[80:83] offset:13504
    s_waitcnt lgkmcnt(4)
    ds_write_b128 v5, v[108:111] offset:2048
    v_alignbit_b32 v60, v109, v108, 16
    v_alignbit_b32 v61, v110, v109, 16
    v_alignbit_b32 v62, v111, v110, 16
    v_alignbit_b32 v63, v128, v111, 16
    ds_write_b128 v5, v[60:63] offset:6208
    v_mov_b32 v64, v109
    v_mov_b32 v65, v110
    v_mov_b32 v66, v111
    v_mov_b32 v67, v128
    ds_write_b128 v5, v[64:67] offset:10368
    v_alignbit_b32 v68, v110, v109, 16
    v_alignbit_b32 v69, v111, v110, 16
    v_alignbit_b32 v70, v128, v111, 16
    v_alignbit_b32 v71, v129, v128, 16
    ds_write_b128 v5, v[68:71] offset:14528
    ds_write_b128 v5, v[112:115] offset:3072
    v_alignbit_b32 v72, v113, v112, 16
    v_alignbit_b32 v73, v114, v113, 16
    v_alignbit_b32 v74, v115, v114, 16
    v_alignbit_b32 v75, v130, v115, 16
    ds_write_b128 v5, v[72:75] offset:7232
    v_mov_b32 v76, v113
    v_mov_b32 v77, v114
    v_mov_b32 v78, v115
    v_mov_b32 v79, v130
    ds_write_b128 v5, v[76:79] offset:11392
    v_alignbit_b32 v80, v114, v113, 16
    v_alignbit_b32 v81, v115, v114, 16
    v_alignbit_b32 v82, v130, v115, 16
    v_alignbit_b32 v83, v131, v130, 16
    ds_write_b128 v5, v[80:83] offset:15552
    s_waitcnt lgkmcnt(4)
    s_mov_b64 exec, 3
    ds_write_b128 v5, v[116:119] offset:4096
    v_alignbit_b32 v60, v117, v116, 16
    v_alignbit_b32 v61, v118, v117, 16
    v_alignbit_b32 v62, v119, v118, 16
    v_alignbit_b32 v63, v132, v119, 16
    ds_write_b128 v5, v[60:63] offset:8256
    v_mov_b32 v64, v117
    v_mov_b32 v65, v118
    v_mov_b32 v66, v119
    v_mov_b32 v67, v132
    ds_write_b128 v5, v[64:67] offset:12416
    v_alignbit_b32 v68, v118, v117, 16
    v_alignbit_b32 v69, v119, v118, 16
    v_alignbit_b32 v70, v132, v119, 16
    v_alignbit_b32 v71, v133, v132, 16
    ds_write_b128 v5, v[68:71] offset:16576
    s_mov_b64 exec, -1
    s_branch NOBUILD
E_00:
    s_cmp_eq_u32 s29, 6
    s_cselect_b32 s67, 0, 0x10000000
    v_add_u32 v6, s67, v2
    v_mov_b32 v12, -1
    v_mov_b32 v13, -1
    v_mov_b32 v14, -1
    v_mov_b32 v15, -1
    s_lshr_b32 s66, s30, 2
    s_lshl_b32 s66, s66, 3
    s_add_u32 s66, s66, s28
    s_lshl_b32 s66, s66, 2
    s_and_b32 s67, s30, 3
    s_add_u32 s66, s66, s67
    s_mul_i32 s66, s66, 10240
    s_add_u32 s66, s66, 0x700000
    buffer_store_dwordx4 v[12:15], v6, s[32:35], s66 offen offset:0 sc1
    buffer_store_dwordx4 v[12:15], v6, s[32:35], s66 offen offset:1024 sc1
    buffer_store_dwordx4 v[12:15], v6, s[32:35], s66 offen offset:2048 sc1
    buffer_store_dwordx4 v[12:15], v6, s[32:35], s66 offen offset:3072 sc1
    s_add_u32 s66, s66, 4096
    buffer_store_dwordx4 v[12:15], v6, s[32:35], s66 offen offset:0 sc1
    buffer_store_dwordx4 v[12:15], v6, s[32:35], s66 offen offset:1024 sc1
    buffer_store_dwordx4 v[12:15], v6, s[32:35], s66 offen offset:2048 sc1
    buffer_store_dwordx4 v[12:15], v6, s[32:35], s66 offen offset:3072 sc1
    s_add_u32 s66, s66, 4096
    buffer_store_dwordx4 v[12:15], v6, s[32:35], s66 offen offset:0 sc1
    buffer_store_dwordx4 v[12:15], v6, s[32:35], s66 offen offset:1024 sc1
    s_mov_b32 s36, s4
    s_mov_b32 s37, s5
    s_mov_b32 s38, 0x280000
    s_mov_b32 s39, 0x20000
    s_movk_i32 s63, 820
    v_add_u32 v10, 0, v1
    v_mul_u32_u24 v11, s63, v10
    v_lshrrev_b32 v11, 16, v11
    v_lshlrev_b32 v11, 1, v11
    v_xor_b32 v10, v10, v11
    v_lshlrev_b32 v76, 4, v10
    v_add_u32 v10, 64, v1
    v_mul_u32_u24 v11, s63, v10
    v_lshrrev_b32 v11, 16, v11
    v_lshlrev_b32 v11, 1, v11
    v_xor_b32 v10, v10, v11
    v_lshlrev_b32 v77, 4, v10
    v_add_u32 v10, 128, v1
    v_mul_u32_u24 v11, s63, v10
    v_lshrrev_b32 v11, 16, v11
    v_lshlrev_b32 v11, 1, v11
    v_xor_b32 v10, v10, v11
    v_lshlrev_b32 v78, 4, v10
    v_add_u32 v10, 192, v1
    v_mul_u32_u24 v11, s63, v10
    v_lshrrev_b32 v11, 16, v11
    v_lshlrev_b32 v11, 1, v11
    v_xor_b32 v10, v10, v11
    v_lshlrev_b32 v79, 4, v10
    v_add_u32 v10, 256, v1
    v_mul_u32_u24 v11, s63, v10
    v_lshrrev_b32 v11, 16, v11
    v_lshlrev_b32 v11, 1, v11
    v_xor_b32 v10, v10, v11
    v_lshlrev_b32 v80, 4, v10
    s_add_u32 s74, s29, -5
    s_min_u32 s74, s74, 7
    s_lshr_b32 s75, s74, 2
    s_and_b32 s74, s74, 3
    s_sub_u32 s70, s30, 29
    s_mul_i32 s71, s75, 3
    s_add_u32 s70, s70, s71
    s_and_b32 s71, s70, 1
    s_lshr_b32 s70, s70, 1
    s_mul_i32 s72, s75, 20480
    s_mul_i32 s63, s74, 5120
    s_add_u32 s72, s72, s63
    s_lshl_b32 s73, s70, 8
    s_lshl_b32 s63, s28, 5
    s_add_u32 s73, s73, s63
    s_lshl_b32 s63, s71, 4
    s_add_u32 s73, s73, s63
    s_lshl_b32 s63, s74, 2
    s_add_u32 s73, s73, s63
    s_mul_i32 s73, s73, 1280
    s_add_u32 s66, s73, 0
    s_min_u32 s66, s66, 2616320
    s_add_u32 m0, s72, 0
    s_nop 0
    buffer_load_dwordx4 v76, s[36:39], s66 offen lds
    s_add_u32 m0, s72, 1024
    s_nop 0
    buffer_load_dwordx4 v77, s[36:39], s66 offen lds
    s_add_u32 m0, s72, 2048
    s_nop 0
    buffer_load_dwordx4 v78, s[36:39], s66 offen lds
    s_add_u32 m0, s72, 3072
    s_nop 0
    buffer_load_dwordx4 v79, s[36:39], s66 offen lds
    s_add_u32 m0, s72, 4096
    s_nop 0
    buffer_load_dwordx4 v80, s[36:39], s66 offen lds
    s_add_u32 s74, s29, -2
    s_min_u32 s74, s74, 7
    s_lshr_b32 s75, s74, 2
    s_and_b32 s74, s74, 3
    s_sub_u32 s70, s30, 29
    s_mul_i32 s71, s75, 3
    s_add_u32 s70, s70, s71
    s_and_b32 s71, s70, 1
    s_lshr_b32 s70, s70, 1
    s_mul_i32 s72, s75, 20480
    s_mul_i32 s63, s74, 5120
    s_add_u32 s72, s72, s63
    s_lshl_b32 s73, s70, 8
    s_lshl_b32 s63, s28, 5
    s_add_u32 s73, s73, s63
    s_lshl_b32 s63, s71, 4
    s_add_u32 s73, s73, s63
    s_lshl_b32 s63, s74, 2
    s_add_u32 s73, s73, s63
    s_mul_i32 s73, s73, 1280
    s_add_u32 s66, s73, 0
    s_min_u32 s66, s66, 2616320
    s_add_u32 m0, s72, 0
    s_nop 0
    buffer_load_dwordx4 v76, s[36:39], s66 offen lds
    s_add_u32 m0, s72, 1024
    s_nop 0
    buffer_load_dwordx4 v77, s[36:39], s66 offen lds
    s_add_u32 m0, s72, 2048
    s_nop 0
    buffer_load_dwordx4 v78, s[36:39], s66 offen lds
    s_add_u32 m0, s72, 3072
    s_nop 0
    buffer_load_dwordx4 v79, s[36:39], s66 offen lds
    s_add_u32 m0, s72, 4096
    s_nop 0
    buffer_load_dwordx4 v80, s[36:39], s66 offen lds
    s_add_u32 s74, s29, 1
    s_min_u32 s74, s74, 7
    s_lshr_b32 s75, s74, 2
    s_and_b32 s74, s74, 3
    s_sub_u32 s70, s30, 29
    s_mul_i32 s71, s75, 3
    s_add_u32 s70, s70, s71
    s_and_b32 s71, s70, 1
    s_lshr_b32 s70, s70, 1
    s_mul_i32 s72, s75, 20480
    s_mul_i32 s63, s74, 5120
    s_add_u32 s72, s72, s63
    s_lshl_b32 s73, s70, 8
    s_lshl_b32 s63, s28, 5
    s_add_u32 s73, s73, s63
    s_lshl_b32 s63, s71, 4
    s_add_u32 s73, s73, s63
    s_lshl_b32 s63, s74, 2
    s_add_u32 s73, s73, s63
    s_mul_i32 s73, s73, 1280
    s_add_u32 s66, s73, 0
    s_min_u32 s66, s66, 2616320
    s_add_u32 m0, s72, 0
    s_nop 0
    buffer_load_dwordx4 v76, s[36:39], s66 offen lds
    s_add_u32 m0, s72, 1024
    s_nop 0
    buffer_load_dwordx4 v77, s[36:39], s66 offen lds
    s_add_u32 m0, s72, 2048
    s_nop 0
    buffer_load_dwordx4 v78, s[36:39], s66 offen lds
    s_add_u32 m0, s72, 3072
    s_nop 0
    buffer_load_dwordx4 v79, s[36:39], s66 offen lds
    s_add_u32 m0, s72, 4096
    s_nop 0
    buffer_load_dwordx4 v80, s[36:39], s66 offen lds
    s_lshl_b32 s66, s2, 7
    s_and_b32 s66, s66, 0x380
    s_lshl_b32 s66, s66, 5
    s_lshl_b32 s67, s30, 7
    s_add_u32 s66, s66, s67
    s_add_u32 s66, s66, 262144
    s_cmp_eq_u32 s29, 7
    s_cselect_b32 s67, 0, 0x10000000
    v_mov_b32 v5, s67
    s_lshl_b32 s67, s54, 1
    s_waitcnt vmcnt(28)
    v_readfirstlane_b32 s53, v4
    s_nop 1
    s_mul_i32 s53, s53, 0x9E3779B1
    s_add_u32 s53, s53, 0x7F4A7C15
    s_xor_b32 s67, s67, s53
    v_mov_b32 v4, s67
    s_mov_b64 exec, 1
    buffer_store_dword v4, v5, s[32:35], s66 offen sc1
    s_mov_b64 exec, -1
    s_waitcnt vmcnt(26)
    s_barrier
    s_waitcnt vmcnt(16)
    s_lshr_b32 s66, s2, 2
    s_lshl_b32 s66, s66, 5
    s_and_b32 s67, s2, 3
    s_add_u32 s66, s66, s67
    s_lshl_b32 s66, s66, 2
    s_add_u32 s66, s66, 327680
    v_mov_b32 v4, s53
    s_mov_b64 exec, 1
    buffer_store_dword v4, v6, s[32:35], s66 offen sc1
    s_mov_b64 exec, -1
    s_branch NOBUILD
KV:
    v_and_b32 v10, 3, v1
    v_bfe_u32 v11, v1, 2, 2
    v_and_b32 v12, 0x30, v1
    v_lshl_add_u32 v12, v10, 2, v12
    v_add_u32 v12, v12, v11
    v_mul_u32_u24 v12, 176, v12
    s_lshl_b32 s66, s29, 5
    s_add_u32 s66, s66, 122880
    v_add_u32 v12, s66, v12
    ds_read_b64_tr_b16 v[24:25], v12 offset:0
    ds_read_b64_tr_b16 v[32:33], v12 offset:704
    ds_read_b64_tr_b16 v[40:41], v12 offset:12288
    ds_read_b64_tr_b16 v[26:27], v12 offset:8
    ds_read_b64_tr_b16 v[34:35], v12 offset:712
    ds_read_b64_tr_b16 v[42:43], v12 offset:12296
    ds_read_b64_tr_b16 v[28:29], v12 offset:16
    ds_read_b64_tr_b16 v[36:37], v12 offset:720
    ds_read_b64_tr_b16 v[44:45], v12 offset:12304
    ds_read_b64_tr_b16 v[30:31], v12 offset:24
    ds_read_b64_tr_b16 v[38:39], v12 offset:728
    ds_read_b64_tr_b16 v[46:47], v12 offset:12312
    s_waitcnt vmcnt(0)
    v_alignbit_b32 v16, v16, v16, 16
    v_alignbit_b32 v17, v17, v17, 16
    v_alignbit_b32 v18, v18, v18, 16
    v_alignbit_b32 v19, v19, v19, 16
    v_alignbit_b32 v20, v20, v20, 16
    v_alignbit_b32 v21, v21, v21, 16
    v_alignbit_b32 v22, v22, v22, 16
    v_alignbit_b32 v23, v23, v23, 16
    s_mul_i32 s66, s29, 2560
    s_add_u32 s66, s66, 147456
    v_mul_u32_u24 v13, 160, v10
    v_lshrrev_b32 v11, 2, v1
    v_lshlrev_b32 v11, 3, v11
    v_sub_u32 v13, v13, v11
    s_add_u32 s67, s66, 120
    v_add_u32 v13, s67, v13
    v_lshrrev_b32 v10, 3, v1
    v_and_b32 v11, 7, v1
    v_lshlrev_b32 v11, 4, v11
    v_mul_u32_u24 v14, 160, v10
    v_add3_u32 v14, s66, v14, v11
    v_lshl_add_u32 v5, v10, 12, v11
    s_waitcnt lgkmcnt(9)
    v_alignbit_b32 v48, v25, v24, 16
    v_alignbit_b32 v49, v32, v25, 16
    v_alignbit_b32 v50, v33, v32, 16
    v_dot2_f32_bf16 v52, v48, v17, 0
    v_dot2_f32_bf16 v53, v25, v17, 0
    v_dot2_f32_bf16 v54, v49, v17, 0
    v_dot2_f32_bf16 v55, v32, v17, 0
    v_lshlrev_b32 v56, 16, v40
    v_and_b32 v57, s59, v40
    v_dot2c_f32_bf16 v52, v49, v16
    v_dot2c_f32_bf16 v53, v32, v16
    v_dot2c_f32_bf16 v54, v50, v16
    v_dot2c_f32_bf16 v55, v33, v16
    v_lshlrev_b32 v58, 16, v41
    v_and_b32 v59, s59, v41
    v_mul_f32 v52, v52, v56
    v_mul_f32 v53, v53, v57
    v_mul_f32 v54, v54, v58
    v_mul_f32 v55, v55, v59
    v_cvt_pk_bf16_f32 v24, v55, v54
    v_cvt_pk_bf16_f32 v25, v53, v52
    ds_write_b64 v13, v[24:25] offset:0
    s_waitcnt lgkmcnt(7)
    v_alignbit_b32 v48, v27, v26, 16
    v_alignbit_b32 v49, v34, v27, 16
    v_alignbit_b32 v50, v35, v34, 16
    v_dot2_f32_bf16 v52, v48, v19, 0
    v_dot2_f32_bf16 v53, v27, v19, 0
    v_dot2_f32_bf16 v54, v49, v19, 0
    v_dot2_f32_bf16 v55, v34, v19, 0
    v_lshlrev_b32 v56, 16, v42
    v_and_b32 v57, s59, v42
    v_dot2c_f32_bf16 v52, v49, v18
    v_dot2c_f32_bf16 v53, v34, v18
    v_dot2c_f32_bf16 v54, v50, v18
    v_dot2c_f32_bf16 v55, v35, v18
    v_lshlrev_b32 v58, 16, v43
    v_and_b32 v59, s59, v43
    v_mul_f32 v52, v52, v56
    v_mul_f32 v53, v53, v57
    v_mul_f32 v54, v54, v58
    v_mul_f32 v55, v55, v59
    v_cvt_pk_bf16_f32 v26, v55, v54
    v_cvt_pk_bf16_f32 v27, v53, v52
    ds_write_b64 v13, v[26:27] offset:640
    s_waitcnt lgkmcnt(5)
    v_alignbit_b32 v48, v29, v28, 16
    v_alignbit_b32 v49, v36, v29, 16
    v_alignbit_b32 v50, v37, v36, 16
    v_dot2_f32_bf16 v52, v48, v21, 0
    v_dot2_f32_bf16 v53, v29, v21, 0
    v_dot2_f32_bf16 v54, v49, v21, 0
    v_dot2_f32_bf16 v55, v36, v21, 0
    v_lshlrev_b32 v56, 16, v44
    v_and_b32 v57, s59, v44
    v_dot2c_f32_bf16 v52, v49, v20
    v_dot2c_f32_bf16 v53, v36, v20
    v_dot2c_f32_bf16 v54, v50, v20
    v_dot2c_f32_bf16 v55, v37, v20
    v_lshlrev_b32 v58, 16, v45
    v_and_b32 v59, s59, v45
    v_mul_f32 v52, v52, v56
    v_mul_f32 v53, v53, v57
    v_mul_f32 v54, v54, v58
    v_mul_f32 v55, v55, v59
    v_cvt_pk_bf16_f32 v28, v55, v54
    v_cvt_pk_bf16_f32 v29, v53, v52
    ds_write_b64 v13, v[28:29] offset:1280
    s_waitcnt lgkmcnt(3)
    v_alignbit_b32 v48, v31, v30, 16
    v_alignbit_b32 v49, v38, v31, 16
    v_alignbit_b32 v50, v39, v38, 16
    v_dot2_f32_bf16 v52, v48, v23, 0
    v_dot2_f32_bf16 v53, v31, v23, 0
    v_dot2_f32_bf16 v54, v49, v23, 0
    v_dot2_f32_bf16 v55, v38, v23, 0
    v_lshlrev_b32 v56, 16, v46
    v_and_b32 v57, s59, v46
    v_dot2c_f32_bf16 v52, v49, v22
    v_dot2c_f32_bf16 v53, v38, v22
    v_dot2c_f32_bf16 v54, v50, v22
    v_dot2c_f32_bf16 v55, v39, v22
    v_lshlrev_b32 v58, 16, v47
    v_and_b32 v59, s59, v47
    v_mul_f32 v52, v52, v56
    v_mul_f32 v53, v53, v57
    v_mul_f32 v54, v54, v58
    v_mul_f32 v55, v55, v59
    v_cvt_pk_bf16_f32 v30, v55, v54
    v_cvt_pk_bf16_f32 v31, v53, v52
    ds_write_b64 v13, v[30:31] offset:1920
    s_mul_i32 s67, s28, 835584
    s_lshl_b32 s66, s29, 16
    s_add_u32 s67, s67, s66
    s_lshl_b32 s66, s30, 7
    s_sub_u32 s67, s67, s66
    s_add_u32 s67, s67, 3968
    ds_read_b128 v[32:35], v14
    ds_read_b128 v[36:39], v14 offset:1280
    s_mul_i32 s68, s28, 5
    s_add_u32 s68, s68, s29
    s_lshl_b32 s68, s68, 7
    s_lshl_b32 s66, s30, 2
    s_add_u32 s68, s68, s66
    s_add_u32 s66, s67, 0x1400000
    s_waitcnt lgkmcnt(1)
    buffer_store_dwordx4 v[32:35], v5, s[32:35], s66 offen sc1
    s_add_u32 s66, s67, 0x1408000
    s_waitcnt lgkmcnt(0)
    buffer_store_dwordx4 v[36:39], v5, s[32:35], s66 offen sc1
    s_cmp_ge_u32 s30, 29
    s_cbranch_scc1 BW_2
    s_lshl_b32 s66, s29, 2
    s_add_u32 s66, s66, 163520
    v_mov_b32 v12, s66
    v_mov_b32 v13, 1
    ds_write_b32 v12, v13
BW_2:
    s_lshl_b32 s69, s28, 12
    s_add_u32 s69, s69, 262144
    v_and_b32 v46, 0x7c, v3
    v_lshlrev_b32 v46, 5, v46
    buffer_load_dword v44, v46, s[32:35], s69 offen sc1
    s_lshl_b32 s66, s54, 1
    s_add_u32 s66, s66, s53
    v_mov_b32 v4, s66
    s_add_u32 s66, s68, 8192
    s_waitcnt vmcnt(1)
    s_mov_b64 exec, 1
    buffer_store_dword v4, off, s[32:35], s66
    s_mov_b64 exec, -1
    s_mov_b32 s58, 0
    s_waitcnt vmcnt(1)
    s_branch HC_4
HL_3:
    buffer_load_dword v44, v46, s[32:35], s69 offen sc1
    s_add_u32 s58, s58, 1
    s_waitcnt vmcnt(0)
HC_4:
    v_xor_b32 v44, s53, v44
    v_cmp_lt_u32 vcc, 15, v44
    v_and_b32 v45, 1, v44
    v_cmp_ne_u32 s[64:65], 0, v45
    s_nop 1
    s_or_b64 vcc, vcc, s[64:65]
    s_cbranch_vccz HD_5
    s_cmp_lt_u32 s58, s57
    s_cbranch_scc1 HL_3
    s_mov_b32 s57, 0
HD_5:
    s_lshl_b32 s69, s54, 1
    v_cmp_ne_u32 vcc, s69, v44
    s_nop 1
    s_cmp_lg_u64 vcc, 0
    s_cselect_b32 s55, 1, 0
    s_cmp_eq_u32 s55, 0
    s_cbranch_scc1 ROLES
    s_add_u32 s66, s67, 0x2000000
    buffer_store_dwordx4 v[32:35], v5, s[32:35], s66 offen sc1
    s_add_u32 s66, s67, 0x2008000
    buffer_store_dwordx4 v[36:39], v5, s[32:35], s66 offen sc1
    s_add_u32 s66, s68, 16384
    s_waitcnt vmcnt(0)
    v_mov_b32 v4, s53
    s_mov_b64 exec, 1
    buffer_store_dword v4, off, s[32:35], s66 sc1
    s_mov_b64 exec, -1
    s_branch ROLES
NOBUILD:
    s_cmp_ge_u32 s30, 29
    s_cbranch_scc1 BW_6
    s_lshl_b32 s66, s29, 2
    s_add_u32 s66, s66, 163520
    v_mov_b32 v12, s66
    v_mov_b32 v13, 1
    ds_write_b32 v12, v13
BW_6:
    s_lshl_b32 s69, s28, 12
    s_add_u32 s69, s69, 262144
    v_and_b32 v46, 0x7c, v3
    v_lshlrev_b32 v46, 5, v46
    buffer_load_dword v44, v46, s[32:35], s69 offen sc1
    s_mov_b32 s58, 0
    s_waitcnt vmcnt(0)
    s_branch HC_8
HL_7:
    buffer_load_dword v44, v46, s[32:35], s69 offen sc1
    s_add_u32 s58, s58, 1
    s_waitcnt vmcnt(0)
HC_8:
    v_xor_b32 v44, s53, v44
    v_cmp_lt_u32 vcc, 15, v44
    v_and_b32 v45, 1, v44
    v_cmp_ne_u32 s[64:65], 0, v45
    s_nop 1
    s_or_b64 vcc, vcc, s[64:65]
    s_cbranch_vccz HD_9
    s_cmp_lt_u32 s58, s57
    s_cbranch_scc1 HL_7
    s_mov_b32 s57, 0
HD_9:
    s_lshl_b32 s69, s54, 1
    v_cmp_ne_u32 vcc, s69, v44
    s_nop 1
    s_cmp_lg_u64 vcc, 0
    s_cselect_b32 s55, 1, 0
ROLES:
    s_cmp_ge_u32 s30, 29
    s_cbranch_scc1 S_MAIN
BUILT:
    s_cmp_ge_u32 s30, 14
    s_cbranch_scc1 CV_G2
    s_and_b32 s69, s29, 1
    s_lshr_b32 s63, s29, 1
    s_lshl_b32 s63, s63, 2
    s_lshr_b32 s77, 0x2814, s63
    s_and_b32 s77, s77, 15
    s_lshl_b32 s64, s30, 1
    s_add_u32 s64, s64, s69
    s_cmp_ge_u32 s64, 80
    s_cselect_b32 s65, 1, 0
    s_cselect_b32 s63, 80, 0
    s_sub_u32 s64, s64, s63
    s_branch CV_COM
CV_G2:
    s_mov_b32 s69, s31
    s_cmp_eq_u32 s52, 0
    s_cselect_b32 s77, 16, 9
    s_lshl_b32 s64, s30, 2
    s_sub_u32 s64, s64, 28
    s_add_u32 s64, s64, s69
    s_cmp_ge_u32 s64, 80
    s_cselect_b32 s65, 1, 0
    s_cselect_b32 s63, 80, 0
    s_sub_u32 s64, s64, s63
CV_COM:
    s_lshr_b32 s78, s64, 4
    s_mul_i32 s79, s28, 5
    s_add_u32 s78, s78, s79
    s_lshl_b32 s78, s78, 7
    s_add_u32 s78, s78, 8192
    s_lshl_b32 s80, s64, 12
    s_mul_i32 s79, s28, 80
    s_add_u32 s64, s64, s79
    s_and_b32 s66, s64, 0xfffffffe
    s_lshl_b32 s66, s66, 1
    s_load_dword s74, s[14:15], s66
    s_mul_i32 s79, s28, 835584
    s_add_u32 s79, s79, s80
    s_mul_i32 s80, s69, 21248
    s_add_u32 s81, s80, 16640
    s_mov_b32 s68, 0
    s_and_b32 s63, s77, 21
    s_cbranch_scc0 CV_NOLEAD
    s_cmp_lg_u32 s29, 0
    s_cbranch_scc1 CV_NOC
    v_lshlrev_b32 v24, 7, v1
    s_mov_b32 s66, 327680
    buffer_load_dwordx4 v[20:23], v24, s[32:35], s66 offen sc1
CV_NOC:
    s_bitcmp1_b32 s77, 0
    s_cselect_b32 s67, 0xff, -1
    v_and_b32 v16, 31, v1
    v_lshlrev_b32 v16, 2, v16
    v_lshrrev_b32 v17, 5, v1
    v_lshl_add_u32 v16, v17, 13, v16
    s_lshl_b32 s66, s54, 1
    v_mov_b32 v18, s66
    v_cmp_eq_u32 vcc, 0, v17
    s_nop 1
    v_cndmask_b32 v18, 0, v18, vcc
    v_add_u32 v18, s53, v18
    s_mov_b32 s58, 0
CV_POLL:
    buffer_load_dword v19, v16, s[32:35], s78 offen sc1
    s_add_u32 s58, s58, 1
    s_waitcnt vmcnt(0)
    v_cmp_ne_u32 vcc, v18, v19
    s_mov_b32 s66, 0x1400000
    s_nop 0
    s_and_b32 s63, vcc_lo, s67
    s_cbranch_scc0 CV_GOT
    s_mov_b32 s66, 0x2000000
    s_and_b32 s63, vcc_hi, s67
    s_cbranch_scc0 CV_GOT
    s_cmp_lt_u32 s58, s57
    s_cbranch_scc1 CV_POLL
    s_mov_b32 s57, 0
CV_GOT:
    s_add_u32 s66, s66, s79
    s_mov_b32 m0, s81
    s_bitcmp0_b32 s77, 0
    s_cbranch_scc1 CV_P012
    buffer_load_dwordx4 v2, s[32:35], s66 offen offset:3072 sc1 lds
    s_branch CV_NOLEAD
CV_P012:
    buffer_load_dwordx4 v2, s[32:35], s66 offen offset:0 sc1 lds
    buffer_load_dwordx4 v2, s[32:35], s66 offen offset:1024 sc1 lds
    buffer_load_dwordx4 v2, s[32:35], s66 offen offset:2048 sc1 lds
    s_cmp_lg_u32 s29, 0
    s_cbranch_scc1 CV_NOLEAD
    v_xor_b32 v20, s53, v20
    v_xor_b32 v21, s53, v21
    v_xor_b32 v22, s53, v22
    v_xor_b32 v23, s53, v23
    v_or3_b32 v20, v20, v21, v22
    v_or_b32 v20, v20, v23
    v_cmp_ne_u32 vcc, 0, v20
    s_nop 1
    s_cbranch_vccnz CV_NOLEAD
    v_mov_b32 v20, 163328
    v_mov_b32 v21, 1
    ds_write_b32 v20, v21 offset:32
    s_mov_b32 s68, 1
CV_NOLEAD:
    s_lshl_b32 s75, s64, 6
    s_add_u32 s75, s75, 0x700000
    s_lshl_b32 s65, s65, 28
    v_and_b32 v16, 15, v1
    v_lshrrev_b32 v17, 4, v1
    v_add_u32 v18, 1, v16
    v_and_b32 v19, 3, v18
    v_mul_u32_u24 v14, 4160, v19
    v_lshrrev_b32 v18, 2, v18
    v_lshl_add_u32 v14, v18, 3, v14
    v_lshl_add_u32 v14, v17, 4, v14
    v_add_u32 v14, s80, v14
    v_lshlrev_b32 v18, 5, v16
    v_lshlrev_b32 v19, 4, v17
    v_sub_u32 v15, v19, v18
    s_add_u32 s66, s81, 480
    v_add_u32 v15, s66, v15
    v_lshl_add_u32 v19, v17, 3, v18
    s_add_u32 s66, s81, 504
    v_sub_u32 v4, s66, v19
    v_and_b32 v19, 1, v17
    v_lshlrev_b32 v19, 3, v19
    v_lshrrev_b32 v18, 1, v16
    v_add_u32 v19, v19, v18
    v_mul_u32_u24 v5, 40960, v19
    v_and_b32 v18, 1, v16
    v_lshl_add_u32 v5, v18, 5, v5
    v_lshrrev_b32 v19, 1, v17
    v_lshl_add_u32 v5, v19, 4, v5
    v_add_u32 v5, s65, v5
    s_waitcnt lgkmcnt(0)
    s_bitcmp1_b32 s64, 0
    s_cbranch_scc1 CV_DHI
    s_lshl_b32 s74, s74, 16
CV_DHI:
    s_and_b32 s74, s74, 0xffff0000
    s_and_b32 s63, s77, 21
    s_cbranch_scc0 CV_RD
    s_waitcnt vmcnt(0)
CV_RD:
    v_mov_b32 v12, 163328
    s_lshl_b32 s67, s29, 2
    v_add_u32 v13, s67, v12
    v_add_u32 v10, 1, s55
    ds_write_b32 v13, v10
    s_bitcmp1_b32 s77, 0
    s_cbranch_scc1 CV_EK
    s_cmp_eq_u32 s77, 8
    s_cbranch_scc1 CV_L1
    s_cmp_lg_u32 s29, 0
    s_cbranch_scc1 CV_CLR
    s_cmp_lg_u32 s68, 0
    s_cbranch_scc1 CV_CLR
    v_lshlrev_b32 v16, 7, v1
    s_mov_b32 s66, 327680
    s_mov_b32 s58, 0
CV_CL:
    buffer_load_dwordx4 v[20:23], v16, s[32:35], s66 offen sc1
    s_add_u32 s58, s58, 1
    s_waitcnt vmcnt(0)
    v_xor_b32 v20, s53, v20
    v_xor_b32 v21, s53, v21
    v_xor_b32 v22, s53, v22
    v_xor_b32 v23, s53, v23
    v_or3_b32 v20, v20, v21, v22
    v_or_b32 v20, v20, v23
    v_cmp_ne_u32 vcc, 0, v20
    s_nop 1
    s_cbranch_vccz CV_CD
    s_cmp_lt_u32 s58, s57
    s_cbranch_scc1 CV_CL
    s_mov_b32 s57, 0
CV_CD:
    ds_write_b32 v12, v10 offset:32
CV_CLR:
    s_cmp_eq_u32 s77, 16
    s_cbranch_scc1 CV_V2
    s_mov_b32 s58, 0
RW_10:
    ds_read_b128 v[16:19], v12 offset:0
    ds_read_b128 v[20:23], v12 offset:16
    s_add_u32 s58, s58, 1
    s_waitcnt lgkmcnt(0)
    v_min3_u32 v16, v16, v17, v18
    v_min3_u32 v20, v20, v21, v22
    v_min3_u32 v16, v16, v19, v23
    v_min_u32 v16, v16, v20
    v_cmp_eq_u32 vcc, 0, v16
    s_nop 1
    s_cbranch_vccz RD_11
    s_cmp_lt_u32 s58, 80000
    s_cbranch_scc1 RW_10
RD_11:
    v_readfirstlane_b32 s55, v22
    s_nop 1
    s_sub_u32 s55, s55, 1
CV_GO:
    s_bitcmp0_b32 s77, 0
    s_cbranch_scc1 CV_I2
CV_EK:
    s_mov_b32 s58, 0
RW_12:
    ds_read_b128 v[16:19], v12 offset:192
    ds_read_b128 v[20:23], v12 offset:208
    s_add_u32 s58, s58, 1
    s_waitcnt lgkmcnt(0)
    v_min3_u32 v16, v16, v17, v18
    v_min3_u32 v20, v20, v21, v22
    v_min3_u32 v16, v16, v19, v23
    v_min_u32 v16, v16, v20
    v_cmp_eq_u32 vcc, 0, v16
    s_nop 1
    s_cbranch_vccz RD_13
    s_cmp_lt_u32 s58, 80000
    s_cbranch_scc1 RW_12
RD_13:
    s_setprio 3
    ds_read_b128 v[32:35], v15 offset:3584
    ds_read_b64 v[64:65], v14 offset:0
    ds_read_b64 v[66:67], v14 offset:8
    ds_read_b128 v[36:39], v15 offset:3072
    ds_read_b64 v[68:69], v14 offset:512
    ds_read_b64 v[70:71], v14 offset:520
    ds_read_b128 v[40:43], v15 offset:3648
    ds_read_b64 v[72:73], v14 offset:64
    ds_read_b64 v[74:75], v14 offset:72
    ds_read_b128 v[44:47], v15 offset:3136
    ds_read_b64 v[76:77], v14 offset:576
    ds_read_b64 v[78:79], v14 offset:584
    ds_read_b128 v[48:51], v15 offset:3712
    ds_read_b64 v[80:81], v14 offset:128
    ds_read_b64 v[82:83], v14 offset:136
    s_waitcnt lgkmcnt(12)
    ds_read_b128 v[52:55], v15 offset:3200
    ds_read_b64 v[84:85], v14 offset:640
    ds_read_b64 v[86:87], v14 offset:648
    s_waitcnt lgkmcnt(12)
    ds_read_b128 v[56:59], v15 offset:3776
    ds_read_b64 v[88:89], v14 offset:192
    ds_read_b64 v[90:91], v14 offset:200
    s_waitcnt lgkmcnt(12)
    ds_read_b128 v[60:63], v15 offset:3264
    v_mfma_f32_16x16x32_bf16 v[16:19], v[64:67], v[32:35], 0
    ds_read_b64 v[92:93], v14 offset:704
    ds_read_b64 v[94:95], v14 offset:712
    v_mfma_f32_16x16x32_bf16 v[20:23], v[64:67], v[36:39], 0
    s_waitcnt lgkmcnt(12)
    ds_read_b64 v[64:65], v14 offset:256
    ds_read_b64 v[66:67], v14 offset:264
    v_mfma_f32_16x16x32_bf16 v[20:23], v[68:71], v[32:35], v[20:23]
    ds_read_b128 v[32:35], v15 offset:3840
    s_waitcnt lgkmcnt(12)
    ds_read_b128 v[36:39], v15 offset:3328
    v_mfma_f32_16x16x32_bf16 v[16:19], v[72:75], v[40:43], v[16:19]
    ds_read_b64 v[68:69], v14 offset:768
    ds_read_b64 v[70:71], v14 offset:776
    v_mfma_f32_16x16x32_bf16 v[20:23], v[72:75], v[44:47], v[20:23]
    s_waitcnt lgkmcnt(12)
    ds_read_b64 v[72:73], v14 offset:320
    ds_read_b64 v[74:75], v14 offset:328
    v_mfma_f32_16x16x32_bf16 v[20:23], v[76:79], v[40:43], v[20:23]
    ds_read_b128 v[40:43], v15 offset:3904
    s_waitcnt lgkmcnt(12)
    ds_read_b128 v[44:47], v15 offset:3392
    v_mfma_f32_16x16x32_bf16 v[16:19], v[80:83], v[48:51], v[16:19]
    ds_read_b64 v[76:77], v14 offset:832
    ds_read_b64 v[78:79], v14 offset:840
    v_mfma_f32_16x16x32_bf16 v[20:23], v[80:83], v[52:55], v[20:23]
    s_waitcnt lgkmcnt(12)
    ds_read_b64 v[80:81], v14 offset:384
    ds_read_b64 v[82:83], v14 offset:392
    v_mfma_f32_16x16x32_bf16 v[20:23], v[84:87], v[48:51], v[20:23]
    ds_read_b128 v[48:51], v15 offset:3968
    s_waitcnt lgkmcnt(12)
    ds_read_b128 v[52:55], v15 offset:3456
    v_mfma_f32_16x16x32_bf16 v[16:19], v[88:91], v[56:59], v[16:19]
    ds_read_b64 v[84:85], v14 offset:896
    ds_read_b64 v[86:87], v14 offset:904
    v_mfma_f32_16x16x32_bf16 v[20:23], v[88:91], v[60:63], v[20:23]
    s_waitcnt lgkmcnt(12)
    ds_read_b64 v[88:89], v14 offset:448
    ds_read_b64 v[90:91], v14 offset:456
    v_mfma_f32_16x16x32_bf16 v[20:23], v[92:95], v[56:59], v[20:23]
    ds_read_b128 v[56:59], v15 offset:4032
    s_waitcnt lgkmcnt(12)
    ds_read_b128 v[60:63], v15 offset:3520
    v_mfma_f32_16x16x32_bf16 v[16:19], v[64:67], v[32:35], v[16:19]
    ds_read_b64 v[92:93], v14 offset:960
    ds_read_b64 v[94:95], v14 offset:968
    v_mfma_f32_16x16x32_bf16 v[20:23], v[64:67], v[36:39], v[20:23]
    v_mfma_f32_16x16x32_bf16 v[20:23], v[68:71], v[32:35], v[20:23]
    v_mfma_f32_16x16x32_bf16 v[16:19], v[72:75], v[40:43], v[16:19]
    s_waitcnt lgkmcnt(14)
    v_mfma_f32_16x16x32_bf16 v[20:23], v[72:75], v[44:47], v[20:23]
    s_waitcnt lgkmcnt(12)
    v_mfma_f32_16x16x32_bf16 v[20:23], v[76:79], v[40:43], v[20:23]
    s_waitcnt lgkmcnt(9)
    v_mfma_f32_16x16x32_bf16 v[16:19], v[80:83], v[48:51], v[16:19]
    s_waitcnt lgkmcnt(8)
    v_mfma_f32_16x16x32_bf16 v[20:23], v[80:83], v[52:55], v[20:23]
    s_waitcnt lgkmcnt(6)
    v_mfma_f32_16x16x32_bf16 v[20:23], v[84:87], v[48:51], v[20:23]
    s_waitcnt lgkmcnt(3)
    v_mfma_f32_16x16x32_bf16 v[16:19], v[88:91], v[56:59], v[16:19]
    s_waitcnt lgkmcnt(2)
    v_mfma_f32_16x16x32_bf16 v[20:23], v[88:91], v[60:63], v[20:23]
    s_waitcnt lgkmcnt(0)
    v_mfma_f32_16x16x32_bf16 v[20:23], v[92:95], v[56:59], v[20:23]
    s_waitcnt lgkmcnt(8)
    s_mov_b32 s58, 0
CC_14:
    ds_read_b32 v10, v12 offset:32
    ds_read_b64 v[96:97], v4 offset:3584
    ds_read_b64 v[98:99], v4 offset:3072
    s_add_u32 s58, s58, 1
    s_waitcnt lgkmcnt(2)
    v_cmp_eq_u32 vcc, 0, v10
    s_nop 1
    s_cbranch_vccz CD_15
    s_cmp_lt_u32 s58, 80000
    s_cbranch_scc1 CC_14
CD_15:
    s_add_u32 s66, s75, 0
    s_waitcnt lgkmcnt(0)
    v_and_b32 v104, s59, v97
    v_lshlrev_b32 v105, 16, v97
    v_and_b32 v106, s59, v96
    v_lshlrev_b32 v107, 16, v96
    v_fmac_f32 v16, s74, v104
    v_fmac_f32 v17, s74, v105
    v_fmac_f32 v18, s74, v106
    v_fmac_f32 v19, s74, v107
    v_cvt_pk_bf16_f32 v108, v16, v17
    v_cvt_pk_bf16_f32 v109, v18, v19
    v_and_b32 v104, s59, v99
    v_lshlrev_b32 v105, 16, v99
    v_and_b32 v106, s59, v98
    v_lshlrev_b32 v107, 16, v98
    v_fmac_f32 v20, s74, v104
    v_fmac_f32 v21, s74, v105
    v_fmac_f32 v22, s74, v106
    v_fmac_f32 v23, s74, v107
    v_cvt_pk_bf16_f32 v110, v20, v21
    v_cvt_pk_bf16_f32 v111, v22, v23
    s_nop 0
    v_permlane16_swap_b32 v108, v110
    v_permlane16_swap_b32 v109, v111
    v_min_u32 v108, -2, v108
    v_min_u32 v109, -2, v109
    v_min_u32 v110, -2, v110
    v_min_u32 v111, -2, v111
    buffer_store_dwordx4 v[108:111], v5, s[32:35], s66 offen sc1
    s_mov_b32 s58, 0
RW_16:
    ds_read_b128 v[16:19], v12 offset:0
    ds_read_b128 v[20:23], v12 offset:16
    s_add_u32 s58, s58, 1
    s_waitcnt lgkmcnt(0)
    v_min3_u32 v16, v16, v17, v18
    v_min3_u32 v20, v20, v21, v22
    v_min3_u32 v16, v16, v19, v23
    v_min_u32 v16, v16, v20
    v_cmp_eq_u32 vcc, 0, v16
    s_nop 1
    s_cbranch_vccz RD_17
    s_cmp_lt_u32 s58, 80000
    s_cbranch_scc1 RW_16
RD_17:
    v_readfirstlane_b32 s55, v22
    s_nop 1
    s_sub_u32 s55, s55, 1
    ds_read_b128 v[40:43], v15 offset:2560
    ds_read_b64 v[64:65], v14 offset:0
    ds_read_b64 v[66:67], v14 offset:8
    ds_read_b128 v[44:47], v15 offset:2048
    ds_read_b128 v[36:39], v15 offset:3072
    ds_read_b64 v[68:69], v14 offset:512
    ds_read_b64 v[70:71], v14 offset:520
    ds_read_b128 v[32:35], v15 offset:3584
    ds_read_b64 v[72:73], v14 offset:1024
    ds_read_b64 v[74:75], v14 offset:1032
    ds_read_b64 v[76:77], v14 offset:1536
    ds_read_b64 v[78:79], v14 offset:1544
    ds_read_b128 v[56:59], v15 offset:2624
    ds_read_b64 v[80:81], v14 offset:64
    ds_read_b64 v[82:83], v14 offset:72
    s_waitcnt lgkmcnt(12)
    ds_read_b128 v[60:63], v15 offset:2112
    ds_read_b128 v[52:55], v15 offset:3136
    ds_read_b64 v[84:85], v14 offset:576
    s_waitcnt lgkmcnt(12)
    ds_read_b64 v[86:87], v14 offset:584
    ds_read_b128 v[48:51], v15 offset:3648
    ds_read_b64 v[88:89], v14 offset:1088
    s_waitcnt lgkmcnt(12)
    ds_read_b64 v[90:91], v14 offset:1096
    v_mov_b32 v16, 0
    v_mov_b32 v17, 0
    v_mov_b32 v18, 0
    v_mov_b32 v19, 0
    v_mov_b32 v20, 0
    v_mov_b32 v21, 0
    v_mov_b32 v22, 0
    v_mov_b32 v23, 0
    s_mov_b32 s63, 0
CL_18:
    v_mfma_f32_16x16x32_bf16 v[16:19], v[64:67], v[40:43], v[16:19]
    s_waitcnt lgkmcnt(12)
    ds_read_b64 v[92:93], v14 offset:1600
    ds_read_b64 v[94:95], v14 offset:1608
    v_mfma_f32_16x16x32_bf16 v[20:23], v[64:67], v[44:47], v[20:23]
    ds_read_b64 v[64:65], v14 offset:128
    s_waitcnt lgkmcnt(12)
    ds_read_b64 v[66:67], v14 offset:136
    v_mfma_f32_16x16x32_bf16 v[16:19], v[68:71], v[36:39], v[16:19]
    ds_read_b128 v[44:47], v15 offset:2176
    v_mfma_f32_16x16x32_bf16 v[20:23], v[68:71], v[40:43], v[20:23]
    ds_read_b128 v[40:43], v15 offset:2688
    s_waitcnt lgkmcnt(12)
    ds_read_b64 v[68:69], v14 offset:640
    v_mfma_f32_16x16x32_bf16 v[16:19], v[72:75], v[32:35], v[16:19]
    ds_read_b64 v[70:71], v14 offset:648
    v_mfma_f32_16x16x32_bf16 v[20:23], v[72:75], v[36:39], v[20:23]
    ds_read_b128 v[36:39], v15 offset:3200
    s_waitcnt lgkmcnt(12)
    ds_read_b64 v[72:73], v14 offset:1152
    v_mfma_f32_16x16x32_bf16 v[20:23], v[76:79], v[32:35], v[20:23]
    ds_read_b64 v[74:75], v14 offset:1160
    ds_read_b128 v[32:35], v15 offset:3712
    v_mfma_f32_16x16x32_bf16 v[16:19], v[80:83], v[56:59], v[16:19]
    s_waitcnt lgkmcnt(12)
    ds_read_b64 v[76:77], v14 offset:1664
    ds_read_b64 v[78:79], v14 offset:1672
    v_mfma_f32_16x16x32_bf16 v[20:23], v[80:83], v[60:63], v[20:23]
    ds_read_b64 v[80:81], v14 offset:192
    s_waitcnt lgkmcnt(12)
    ds_read_b64 v[82:83], v14 offset:200
    v_mfma_f32_16x16x32_bf16 v[16:19], v[84:87], v[52:55], v[16:19]
    ds_read_b128 v[60:63], v15 offset:2240
    v_mfma_f32_16x16x32_bf16 v[20:23], v[84:87], v[56:59], v[20:23]
    ds_read_b128 v[56:59], v15 offset:2752
    s_waitcnt lgkmcnt(12)
    ds_read_b64 v[84:85], v14 offset:704
    v_mfma_f32_16x16x32_bf16 v[16:19], v[88:91], v[48:51], v[16:19]
    ds_read_b64 v[86:87], v14 offset:712
    v_mfma_f32_16x16x32_bf16 v[20:23], v[88:91], v[52:55], v[20:23]
    ds_read_b128 v[52:55], v15 offset:3264
    s_waitcnt lgkmcnt(12)
    ds_read_b64 v[88:89], v14 offset:1216
    v_mfma_f32_16x16x32_bf16 v[20:23], v[92:95], v[48:51], v[20:23]
    ds_read_b64 v[90:91], v14 offset:1224
    ds_read_b128 v[48:51], v15 offset:3776
    v_mfma_f32_16x16x32_bf16 v[16:19], v[64:67], v[40:43], v[16:19]
    s_waitcnt lgkmcnt(12)
    ds_read_b64 v[92:93], v14 offset:1728
    ds_read_b64 v[94:95], v14 offset:1736
    v_mfma_f32_16x16x32_bf16 v[20:23], v[64:67], v[44:47], v[20:23]
    ds_read_b64 v[64:65], v14 offset:256
    s_waitcnt lgkmcnt(12)
    ds_read_b64 v[66:67], v14 offset:264
    v_mfma_f32_16x16x32_bf16 v[16:19], v[68:71], v[36:39], v[16:19]
    ds_read_b128 v[44:47], v15 offset:2304
    v_mfma_f32_16x16x32_bf16 v[20:23], v[68:71], v[40:43], v[20:23]
    ds_read_b128 v[40:43], v15 offset:2816
    s_waitcnt lgkmcnt(12)
    ds_read_b64 v[68:69], v14 offset:768
    v_mfma_f32_16x16x32_bf16 v[16:19], v[72:75], v[32:35], v[16:19]
    ds_read_b64 v[70:71], v14 offset:776
    v_mfma_f32_16x16x32_bf16 v[20:23], v[72:75], v[36:39], v[20:23]
    ds_read_b128 v[36:39], v15 offset:3328
    s_waitcnt lgkmcnt(12)
    ds_read_b64 v[72:73], v14 offset:1280
    v_mfma_f32_16x16x32_bf16 v[20:23], v[76:79], v[32:35], v[20:23]
    ds_read_b64 v[74:75], v14 offset:1288
    ds_read_b128 v[32:35], v15 offset:3840
    v_mfma_f32_16x16x32_bf16 v[16:19], v[80:83], v[56:59], v[16:19]
    s_waitcnt lgkmcnt(12)
    ds_read_b64 v[76:77], v14 offset:1792
    ds_read_b64 v[78:79], v14 offset:1800
    v_mfma_f32_16x16x32_bf16 v[20:23], v[80:83], v[60:63], v[20:23]
    ds_read_b64 v[80:81], v14 offset:320
    s_waitcnt lgkmcnt(12)
    ds_read_b64 v[82:83], v14 offset:328
    v_mfma_f32_16x16x32_bf16 v[16:19], v[84:87], v[52:55], v[16:19]
    ds_read_b128 v[60:63], v15 offset:2368
    v_mfma_f32_16x16x32_bf16 v[20:23], v[84:87], v[56:59], v[20:23]
    ds_read_b128 v[56:59], v15 offset:2880
    s_waitcnt lgkmcnt(12)
    ds_read_b64 v[84:85], v14 offset:832
    v_mfma_f32_16x16x32_bf16 v[16:19], v[88:91], v[48:51], v[16:19]
    ds_read_b64 v[86:87], v14 offset:840
    v_mfma_f32_16x16x32_bf16 v[20:23], v[88:91], v[52:55], v[20:23]
    ds_read_b128 v[52:55], v15 offset:3392
    s_waitcnt lgkmcnt(12)
    ds_read_b64 v[88:89], v14 offset:1344
    v_mfma_f32_16x16x32_bf16 v[20:23], v[92:95], v[48:51], v[20:23]
    ds_read_b64 v[90:91], v14 offset:1352
    ds_read_b128 v[48:51], v15 offset:3904
    v_add_u32 v14, 256, v14
    v_add_u32 v15, 256, v15
    s_add_u32 s63, s63, 1
    s_cmp_lt_u32 s63, 2
    s_cbranch_scc1 CL_18
    v_subrev_u32 v14, 512, v14
    v_subrev_u32 v15, 512, v15
    s_waitcnt lgkmcnt(8)
    s_mov_b32 s58, 0
CC_20:
    ds_read_b32 v10, v12 offset:32
    ds_read_b64 v[96:97], v4 offset:2560
    ds_read_b64 v[98:99], v4 offset:2048
    s_add_u32 s58, s58, 1
    s_waitcnt lgkmcnt(2)
    v_cmp_eq_u32 vcc, 0, v10
    s_nop 1
    s_cbranch_vccz CD_21
    s_cmp_lt_u32 s58, 80000
    s_cbranch_scc1 CC_20
CD_21:
    s_add_u32 s66, s75, 655360
    s_waitcnt lgkmcnt(0)
    v_and_b32 v104, s59, v97
    v_lshlrev_b32 v105, 16, v97
    v_and_b32 v106, s59, v96
    v_lshlrev_b32 v107, 16, v96
    v_fmac_f32 v16, s74, v104
    v_fmac_f32 v17, s74, v105
    v_fmac_f32 v18, s74, v106
    v_fmac_f32 v19, s74, v107
    v_cvt_pk_bf16_f32 v108, v16, v17
    v_cvt_pk_bf16_f32 v109, v18, v19
    v_and_b32 v104, s59, v99
    v_lshlrev_b32 v105, 16, v99
    v_and_b32 v106, s59, v98
    v_lshlrev_b32 v107, 16, v98
    v_fmac_f32 v20, s74, v104
    v_fmac_f32 v21, s74, v105
    v_fmac_f32 v22, s74, v106
    v_fmac_f32 v23, s74, v107
    v_cvt_pk_bf16_f32 v110, v20, v21
    v_cvt_pk_bf16_f32 v111, v22, v23
    s_nop 0
    v_permlane16_swap_b32 v108, v110
    v_permlane16_swap_b32 v109, v111
    v_min_u32 v108, -2, v108
    v_min_u32 v109, -2, v109
    v_min_u32 v110, -2, v110
    v_min_u32 v111, -2, v111
    buffer_store_dwordx4 v[108:111], v5, s[32:35], s66 offen sc1
    s_bitcmp1_b32 s77, 3
    s_cbranch_scc1 CV_L2
CV_I2:
    s_bitcmp0_b32 s77, 1
    s_cbranch_scc1 CV_I3
    ds_read_b128 v[48:51], v15 offset:1536
    ds_read_b64 v[64:65], v14 offset:0
    ds_read_b64 v[66:67], v14 offset:8
    ds_read_b128 v[52:55], v15 offset:1024
    ds_read_b128 v[44:47], v15 offset:2048
    ds_read_b64 v[68:69], v14 offset:512
    ds_read_b64 v[70:71], v14 offset:520
    ds_read_b128 v[40:43], v15 offset:2560
    ds_read_b64 v[72:73], v14 offset:1024
    ds_read_b64 v[74:75], v14 offset:1032
    ds_read_b128 v[36:39], v15 offset:3072
    ds_read_b64 v[76:77], v14 offset:1536
    ds_read_b64 v[78:79], v14 offset:1544
    ds_read_b128 v[32:35], v15 offset:3584
    ds_read_b64 v[80:81], v14 offset:2048
    s_waitcnt lgkmcnt(12)
    ds_read_b64 v[82:83], v14 offset:2056
    v_mov_b32 v16, 0
    v_mov_b32 v17, 0
    v_mov_b32 v18, 0
    v_mov_b32 v19, 0
    v_mov_b32 v20, 0
    v_mov_b32 v21, 0
    v_mov_b32 v22, 0
    v_mov_b32 v23, 0
    s_mov_b32 s63, 0
CL_22:
    s_waitcnt lgkmcnt(12)
    v_mfma_f32_16x16x32_bf16 v[16:19], v[64:67], v[48:51], v[16:19]
    ds_read_b64 v[84:85], v14 offset:2560
    ds_read_b64 v[86:87], v14 offset:2568
    v_mfma_f32_16x16x32_bf16 v[20:23], v[64:67], v[52:55], v[20:23]
    ds_read_b64 v[64:65], v14 offset:64
    s_waitcnt lgkmcnt(12)
    ds_read_b64 v[66:67], v14 offset:72
    v_mfma_f32_16x16x32_bf16 v[16:19], v[68:71], v[44:47], v[16:19]
    ds_read_b128 v[52:55], v15 offset:1088
    v_mfma_f32_16x16x32_bf16 v[20:23], v[68:71], v[48:51], v[20:23]
    ds_read_b128 v[48:51], v15 offset:1600
    s_waitcnt lgkmcnt(12)
    ds_read_b64 v[68:69], v14 offset:576
    v_mfma_f32_16x16x32_bf16 v[16:19], v[72:75], v[40:43], v[16:19]
    ds_read_b64 v[70:71], v14 offset:584
    v_mfma_f32_16x16x32_bf16 v[20:23], v[72:75], v[44:47], v[20:23]
    ds_read_b128 v[44:47], v15 offset:2112
    s_waitcnt lgkmcnt(12)
    ds_read_b64 v[72:73], v14 offset:1088
    v_mfma_f32_16x16x32_bf16 v[16:19], v[76:79], v[36:39], v[16:19]
    ds_read_b64 v[74:75], v14 offset:1096
    v_mfma_f32_16x16x32_bf16 v[20:23], v[76:79], v[40:43], v[20:23]
    ds_read_b128 v[40:43], v15 offset:2624
    s_waitcnt lgkmcnt(12)
    ds_read_b64 v[76:77], v14 offset:1600
    v_mfma_f32_16x16x32_bf16 v[16:19], v[80:83], v[32:35], v[16:19]
    ds_read_b64 v[78:79], v14 offset:1608
    v_mfma_f32_16x16x32_bf16 v[20:23], v[80:83], v[36:39], v[20:23]
    ds_read_b128 v[36:39], v15 offset:3136
    s_waitcnt lgkmcnt(12)
    ds_read_b64 v[80:81], v14 offset:2112
    v_mfma_f32_16x16x32_bf16 v[20:23], v[84:87], v[32:35], v[20:23]
    ds_read_b64 v[82:83], v14 offset:2120
    ds_read_b128 v[32:35], v15 offset:3648
    s_waitcnt lgkmcnt(12)
    v_mfma_f32_16x16x32_bf16 v[16:19], v[64:67], v[48:51], v[16:19]
    ds_read_b64 v[84:85], v14 offset:2624
    ds_read_b64 v[86:87], v14 offset:2632
    v_mfma_f32_16x16x32_bf16 v[20:23], v[64:67], v[52:55], v[20:23]
    ds_read_b64 v[64:65], v14 offset:128
    s_waitcnt lgkmcnt(12)
    ds_read_b64 v[66:67], v14 offset:136
    v_mfma_f32_16x16x32_bf16 v[16:19], v[68:71], v[44:47], v[16:19]
    ds_read_b128 v[52:55], v15 offset:1152
    v_mfma_f32_16x16x32_bf16 v[20:23], v[68:71], v[48:51], v[20:23]
    ds_read_b128 v[48:51], v15 offset:1664
    s_waitcnt lgkmcnt(12)
    ds_read_b64 v[68:69], v14 offset:640
    v_mfma_f32_16x16x32_bf16 v[16:19], v[72:75], v[40:43], v[16:19]
    ds_read_b64 v[70:71], v14 offset:648
    v_mfma_f32_16x16x32_bf16 v[20:23], v[72:75], v[44:47], v[20:23]
    ds_read_b128 v[44:47], v15 offset:2176
    s_waitcnt lgkmcnt(12)
    ds_read_b64 v[72:73], v14 offset:1152
    v_mfma_f32_16x16x32_bf16 v[16:19], v[76:79], v[36:39], v[16:19]
    ds_read_b64 v[74:75], v14 offset:1160
    v_mfma_f32_16x16x32_bf16 v[20:23], v[76:79], v[40:43], v[20:23]
    ds_read_b128 v[40:43], v15 offset:2688
    s_waitcnt lgkmcnt(12)
    ds_read_b64 v[76:77], v14 offset:1664
    v_mfma_f32_16x16x32_bf16 v[16:19], v[80:83], v[32:35], v[16:19]
    ds_read_b64 v[78:79], v14 offset:1672
    v_mfma_f32_16x16x32_bf16 v[20:23], v[80:83], v[36:39], v[20:23]
    ds_read_b128 v[36:39], v15 offset:3200
    s_waitcnt lgkmcnt(12)
    ds_read_b64 v[80:81], v14 offset:2176
    v_mfma_f32_16x16x32_bf16 v[20:23], v[84:87], v[32:35], v[20:23]
    ds_read_b64 v[82:83], v14 offset:2184
    ds_read_b128 v[32:35], v15 offset:3712
    s_waitcnt vmcnt(0)
    ds_write_b32 v13, v10 offset:96
    v_add_u32 v14, 128, v14
    v_add_u32 v15, 128, v15
    s_add_u32 s63, s63, 1
    s_cmp_lt_u32 s63, 4
    s_cbranch_scc1 CL_22
    v_subrev_u32 v14, 512, v14
    v_subrev_u32 v15, 512, v15
    s_waitcnt lgkmcnt(8)
    s_mov_b32 s58, 0
CC_24:
    ds_read_b32 v10, v12 offset:32
    ds_read_b64 v[96:97], v4 offset:1536
    ds_read_b64 v[98:99], v4 offset:1024
    s_add_u32 s58, s58, 1
    s_waitcnt lgkmcnt(2)
    v_cmp_eq_u32 vcc, 0, v10
    s_nop 1
    s_cbranch_vccz CD_25
    s_cmp_lt_u32 s58, 80000
    s_cbranch_scc1 CC_24
CD_25:
    s_add_u32 s66, s75, 1310720
    s_waitcnt lgkmcnt(0)
    v_and_b32 v104, s59, v97
    v_lshlrev_b32 v105, 16, v97
    v_and_b32 v106, s59, v96
    v_lshlrev_b32 v107, 16, v96
    v_fmac_f32 v16, s74, v104
    v_fmac_f32 v17, s74, v105
    v_fmac_f32 v18, s74, v106
    v_fmac_f32 v19, s74, v107
    v_cvt_pk_bf16_f32 v108, v16, v17
    v_cvt_pk_bf16_f32 v109, v18, v19
    v_and_b32 v104, s59, v99
    v_lshlrev_b32 v105, 16, v99
    v_and_b32 v106, s59, v98
    v_lshlrev_b32 v107, 16, v98
    v_fmac_f32 v20, s74, v104
    v_fmac_f32 v21, s74, v105
    v_fmac_f32 v22, s74, v106
    v_fmac_f32 v23, s74, v107
    v_cvt_pk_bf16_f32 v110, v20, v21
    v_cvt_pk_bf16_f32 v111, v22, v23
    s_nop 0
    v_permlane16_swap_b32 v108, v110
    v_permlane16_swap_b32 v109, v111
    v_min_u32 v108, -2, v108
    v_min_u32 v109, -2, v109
    v_min_u32 v110, -2, v110
    v_min_u32 v111, -2, v111
    buffer_store_dwordx4 v[108:111], v5, s[32:35], s66 offen sc1
    v_mov_b32 v10, 1
    ds_write_b32 v13, v10 offset:64
    s_branch G1_HI
CV_I3:
    s_setprio 0
    s_bitcmp0_b32 s77, 2
    s_cbranch_scc1 CV_I4
    ds_read_b128 v[56:59], v15 offset:512
    ds_read_b64 v[64:65], v14 offset:0
    ds_read_b64 v[66:67], v14 offset:8
    ds_read_b128 v[60:63], v15 offset:0
    ds_read_b128 v[52:55], v15 offset:1024
    ds_read_b64 v[68:69], v14 offset:512
    ds_read_b64 v[70:71], v14 offset:520
    ds_read_b128 v[48:51], v15 offset:1536
    ds_read_b64 v[72:73], v14 offset:1024
    ds_read_b64 v[74:75], v14 offset:1032
    ds_read_b128 v[44:47], v15 offset:2048
    ds_read_b64 v[76:77], v14 offset:1536
    ds_read_b64 v[78:79], v14 offset:1544
    ds_read_b128 v[40:43], v15 offset:2560
    ds_read_b64 v[80:81], v14 offset:2048
    s_waitcnt lgkmcnt(12)
    ds_read_b64 v[82:83], v14 offset:2056
    ds_read_b128 v[36:39], v15 offset:3072
    ds_read_b64 v[84:85], v14 offset:2560
    s_waitcnt lgkmcnt(12)
    ds_read_b64 v[86:87], v14 offset:2568
    ds_read_b128 v[32:35], v15 offset:3584
    ds_read_b64 v[88:89], v14 offset:3072
    s_waitcnt lgkmcnt(12)
    ds_read_b64 v[90:91], v14 offset:3080
    v_mov_b32 v16, 0
    v_mov_b32 v17, 0
    v_mov_b32 v18, 0
    v_mov_b32 v19, 0
    v_mov_b32 v20, 0
    v_mov_b32 v21, 0
    v_mov_b32 v22, 0
    v_mov_b32 v23, 0
    s_mov_b32 s63, 0
CL_26:
    v_mfma_f32_16x16x32_bf16 v[16:19], v[64:67], v[56:59], v[16:19]
    s_waitcnt lgkmcnt(12)
    ds_read_b64 v[92:93], v14 offset:3584
    ds_read_b64 v[94:95], v14 offset:3592
    v_mfma_f32_16x16x32_bf16 v[20:23], v[64:67], v[60:63], v[20:23]
    ds_read_b64 v[64:65], v14 offset:64
    s_waitcnt lgkmcnt(12)
    ds_read_b64 v[66:67], v14 offset:72
    v_mfma_f32_16x16x32_bf16 v[16:19], v[68:71], v[52:55], v[16:19]
    ds_read_b128 v[60:63], v15 offset:64
    v_mfma_f32_16x16x32_bf16 v[20:23], v[68:71], v[56:59], v[20:23]
    ds_read_b128 v[56:59], v15 offset:576
    s_waitcnt lgkmcnt(12)
    ds_read_b64 v[68:69], v14 offset:576
    v_mfma_f32_16x16x32_bf16 v[16:19], v[72:75], v[48:51], v[16:19]
    ds_read_b64 v[70:71], v14 offset:584
    v_mfma_f32_16x16x32_bf16 v[20:23], v[72:75], v[52:55], v[20:23]
    ds_read_b128 v[52:55], v15 offset:1088
    s_waitcnt lgkmcnt(12)
    ds_read_b64 v[72:73], v14 offset:1088
    v_mfma_f32_16x16x32_bf16 v[16:19], v[76:79], v[44:47], v[16:19]
    ds_read_b64 v[74:75], v14 offset:1096
    v_mfma_f32_16x16x32_bf16 v[20:23], v[76:79], v[48:51], v[20:23]
    ds_read_b128 v[48:51], v15 offset:1600
    s_waitcnt lgkmcnt(12)
    ds_read_b64 v[76:77], v14 offset:1600
    v_mfma_f32_16x16x32_bf16 v[16:19], v[80:83], v[40:43], v[16:19]
    ds_read_b64 v[78:79], v14 offset:1608
    v_mfma_f32_16x16x32_bf16 v[20:23], v[80:83], v[44:47], v[20:23]
    ds_read_b128 v[44:47], v15 offset:2112
    s_waitcnt lgkmcnt(12)
    ds_read_b64 v[80:81], v14 offset:2112
    v_mfma_f32_16x16x32_bf16 v[16:19], v[84:87], v[36:39], v[16:19]
    ds_read_b64 v[82:83], v14 offset:2120
    v_mfma_f32_16x16x32_bf16 v[20:23], v[84:87], v[40:43], v[20:23]
    ds_read_b128 v[40:43], v15 offset:2624
    s_waitcnt lgkmcnt(12)
    ds_read_b64 v[84:85], v14 offset:2624
    v_mfma_f32_16x16x32_bf16 v[16:19], v[88:91], v[32:35], v[16:19]
    ds_read_b64 v[86:87], v14 offset:2632
    v_mfma_f32_16x16x32_bf16 v[20:23], v[88:91], v[36:39], v[20:23]
    ds_read_b128 v[36:39], v15 offset:3136
    s_waitcnt lgkmcnt(12)
    ds_read_b64 v[88:89], v14 offset:3136
    v_mfma_f32_16x16x32_bf16 v[20:23], v[92:95], v[32:35], v[20:23]
    ds_read_b64 v[90:91], v14 offset:3144
    ds_read_b128 v[32:35], v15 offset:3648
    v_mfma_f32_16x16x32_bf16 v[16:19], v[64:67], v[56:59], v[16:19]
    s_waitcnt lgkmcnt(12)
    ds_read_b64 v[92:93], v14 offset:3648
    ds_read_b64 v[94:95], v14 offset:3656
    v_mfma_f32_16x16x32_bf16 v[20:23], v[64:67], v[60:63], v[20:23]
    ds_read_b64 v[64:65], v14 offset:128
    s_waitcnt lgkmcnt(12)
    ds_read_b64 v[66:67], v14 offset:136
    v_mfma_f32_16x16x32_bf16 v[16:19], v[68:71], v[52:55], v[16:19]
    ds_read_b128 v[60:63], v15 offset:128
    v_mfma_f32_16x16x32_bf16 v[20:23], v[68:71], v[56:59], v[20:23]
    ds_read_b128 v[56:59], v15 offset:640
    s_waitcnt lgkmcnt(12)
    ds_read_b64 v[68:69], v14 offset:640
    v_mfma_f32_16x16x32_bf16 v[16:19], v[72:75], v[48:51], v[16:19]
    ds_read_b64 v[70:71], v14 offset:648
    v_mfma_f32_16x16x32_bf16 v[20:23], v[72:75], v[52:55], v[20:23]
    ds_read_b128 v[52:55], v15 offset:1152
    s_waitcnt lgkmcnt(12)
    ds_read_b64 v[72:73], v14 offset:1152
    v_mfma_f32_16x16x32_bf16 v[16:19], v[76:79], v[44:47], v[16:19]
    ds_read_b64 v[74:75], v14 offset:1160
    v_mfma_f32_16x16x32_bf16 v[20:23], v[76:79], v[48:51], v[20:23]
    ds_read_b128 v[48:51], v15 offset:1664
    s_waitcnt lgkmcnt(12)
    ds_read_b64 v[76:77], v14 offset:1664
    v_mfma_f32_16x16x32_bf16 v[16:19], v[80:83], v[40:43], v[16:19]
    ds_read_b64 v[78:79], v14 offset:1672
    v_mfma_f32_16x16x32_bf16 v[20:23], v[80:83], v[44:47], v[20:23]
    ds_read_b128 v[44:47], v15 offset:2176
    s_waitcnt lgkmcnt(12)
    ds_read_b64 v[80:81], v14 offset:2176
    v_mfma_f32_16x16x32_bf16 v[16:19], v[84:87], v[36:39], v[16:19]
    ds_read_b64 v[82:83], v14 offset:2184
    v_mfma_f32_16x16x32_bf16 v[20:23], v[84:87], v[40:43], v[20:23]
    ds_read_b128 v[40:43], v15 offset:2688
    s_waitcnt lgkmcnt(12)
    ds_read_b64 v[84:85], v14 offset:2688
    v_mfma_f32_16x16x32_bf16 v[16:19], v[88:91], v[32:35], v[16:19]
    ds_read_b64 v[86:87], v14 offset:2696
    v_mfma_f32_16x16x32_bf16 v[20:23], v[88:91], v[36:39], v[20:23]
    ds_read_b128 v[36:39], v15 offset:3200
    s_waitcnt lgkmcnt(12)
    ds_read_b64 v[88:89], v14 offset:3200
    v_mfma_f32_16x16x32_bf16 v[20:23], v[92:95], v[32:35], v[20:23]
    ds_read_b64 v[90:91], v14 offset:3208
    ds_read_b128 v[32:35], v15 offset:3712
    v_add_u32 v14, 128, v14
    v_add_u32 v15, 128, v15
    s_add_u32 s63, s63, 1
    s_cmp_lt_u32 s63, 4
    s_cbranch_scc1 CL_26
    v_subrev_u32 v14, 512, v14
    v_subrev_u32 v15, 512, v15
    s_waitcnt lgkmcnt(8)
    s_mov_b32 s58, 0
CC_28:
    ds_read_b32 v10, v12 offset:32
    ds_read_b64 v[96:97], v4 offset:512
    ds_read_b64 v[98:99], v4 offset:0
    s_add_u32 s58, s58, 1
    s_waitcnt lgkmcnt(2)
    v_cmp_eq_u32 vcc, 0, v10
    s_nop 1
    s_cbranch_vccz CD_29
    s_cmp_lt_u32 s58, 80000
    s_cbranch_scc1 CC_28
CD_29:
    s_add_u32 s66, s75, 1966080
    s_waitcnt lgkmcnt(0)
    v_and_b32 v104, s59, v97
    v_lshlrev_b32 v105, 16, v97
    v_and_b32 v106, s59, v96
    v_lshlrev_b32 v107, 16, v96
    v_fmac_f32 v16, s74, v104
    v_fmac_f32 v17, s74, v105
    v_fmac_f32 v18, s74, v106
    v_fmac_f32 v19, s74, v107
    v_cvt_pk_bf16_f32 v108, v16, v17
    v_cvt_pk_bf16_f32 v109, v18, v19
    v_and_b32 v104, s59, v99
    v_lshlrev_b32 v105, 16, v99
    v_and_b32 v106, s59, v98
    v_lshlrev_b32 v107, 16, v98
    v_fmac_f32 v20, s74, v104
    v_fmac_f32 v21, s74, v105
    v_fmac_f32 v22, s74, v106
    v_fmac_f32 v23, s74, v107
    v_cvt_pk_bf16_f32 v110, v20, v21
    v_cvt_pk_bf16_f32 v111, v22, v23
    s_nop 0
    v_permlane16_swap_b32 v108, v110
    v_permlane16_swap_b32 v109, v111
    v_min_u32 v108, -2, v108
    v_min_u32 v109, -2, v109
    v_min_u32 v110, -2, v110
    v_min_u32 v111, -2, v111
    buffer_store_dwordx4 v[108:111], v5, s[32:35], s66 offen sc1
CV_I4:
    s_bitcmp0_b32 s77, 4
    s_cbranch_scc1 G1_CI
    ds_read_b128 v[48:51], v15 offset:1536
    ds_read_b64 v[64:65], v14 offset:0
    ds_read_b64 v[66:67], v14 offset:8
    ds_read_b128 v[52:55], v15 offset:1024
    ds_read_b128 v[56:59], v15 offset:512
    ds_read_b128 v[60:63], v15 offset:0
    ds_read_b128 v[44:47], v15 offset:2048
    ds_read_b64 v[68:69], v14 offset:512
    ds_read_b64 v[70:71], v14 offset:520
    ds_read_b128 v[40:43], v15 offset:2560
    ds_read_b64 v[72:73], v14 offset:1024
    ds_read_b64 v[74:75], v14 offset:1032
    ds_read_b128 v[36:39], v15 offset:3072
    ds_read_b64 v[76:77], v14 offset:1536
    ds_read_b64 v[78:79], v14 offset:1544
    s_waitcnt lgkmcnt(12)
    ds_read_b128 v[32:35], v15 offset:3584
    ds_read_b64 v[80:81], v14 offset:2048
    ds_read_b64 v[82:83], v14 offset:2056
    s_waitcnt lgkmcnt(12)
    ds_read_b64 v[84:85], v14 offset:2560
    v_mov_b32 v16, 0
    v_mov_b32 v17, 0
    v_mov_b32 v18, 0
    v_mov_b32 v19, 0
    v_mov_b32 v20, 0
    v_mov_b32 v21, 0
    v_mov_b32 v22, 0
    v_mov_b32 v23, 0
    v_mov_b32 v24, 0
    v_mov_b32 v25, 0
    v_mov_b32 v26, 0
    v_mov_b32 v27, 0
    v_mov_b32 v28, 0
    v_mov_b32 v29, 0
    v_mov_b32 v30, 0
    v_mov_b32 v31, 0
    s_mov_b32 s63, 0
CL_30:
    s_waitcnt lgkmcnt(9)
    v_mfma_f32_16x16x32_bf16 v[16:19], v[64:67], v[48:51], v[16:19]
    ds_read_b64 v[86:87], v14 offset:2568
    v_mfma_f32_16x16x32_bf16 v[20:23], v[64:67], v[52:55], v[20:23]
    ds_read_b64 v[88:89], v14 offset:3072
    v_mfma_f32_16x16x32_bf16 v[24:27], v[64:67], v[56:59], v[24:27]
    ds_read_b64 v[90:91], v14 offset:3080
    v_mfma_f32_16x16x32_bf16 v[28:31], v[64:67], v[60:63], v[28:31]
    ds_read_b64 v[64:65], v14 offset:64
    s_waitcnt lgkmcnt(10)
    v_mfma_f32_16x16x32_bf16 v[16:19], v[68:71], v[44:47], v[16:19]
    ds_read_b64 v[66:67], v14 offset:72
    v_mfma_f32_16x16x32_bf16 v[20:23], v[68:71], v[48:51], v[20:23]
    ds_read_b128 v[60:63], v15 offset:64
    v_mfma_f32_16x16x32_bf16 v[24:27], v[68:71], v[52:55], v[24:27]
    ds_read_b64 v[92:93], v14 offset:3584
    v_mfma_f32_16x16x32_bf16 v[28:31], v[68:71], v[56:59], v[28:31]
    ds_read_b128 v[56:59], v15 offset:576
    s_waitcnt lgkmcnt(11)
    v_mfma_f32_16x16x32_bf16 v[16:19], v[72:75], v[40:43], v[16:19]
    ds_read_b64 v[68:69], v14 offset:576
    v_mfma_f32_16x16x32_bf16 v[20:23], v[72:75], v[44:47], v[20:23]
    ds_read_b64 v[70:71], v14 offset:584
    v_mfma_f32_16x16x32_bf16 v[24:27], v[72:75], v[48:51], v[24:27]
    ds_read_b64 v[94:95], v14 offset:3592
    v_mfma_f32_16x16x32_bf16 v[28:31], v[72:75], v[52:55], v[28:31]
    ds_read_b128 v[52:55], v15 offset:1088
    s_waitcnt lgkmcnt(13)
    v_mfma_f32_16x16x32_bf16 v[16:19], v[76:79], v[36:39], v[16:19]
    ds_read_b64 v[72:73], v14 offset:1088
    v_mfma_f32_16x16x32_bf16 v[20:23], v[76:79], v[40:43], v[20:23]
    ds_read_b64 v[74:75], v14 offset:1096
    v_mfma_f32_16x16x32_bf16 v[24:27], v[76:79], v[44:47], v[24:27]
    v_mfma_f32_16x16x32_bf16 v[28:31], v[76:79], v[48:51], v[28:31]
    s_waitcnt lgkmcnt(12)
    ds_read_b128 v[48:51], v15 offset:1600
    v_mfma_f32_16x16x32_bf16 v[16:19], v[80:83], v[32:35], v[16:19]
    ds_read_b64 v[76:77], v14 offset:1600
    v_mfma_f32_16x16x32_bf16 v[20:23], v[80:83], v[36:39], v[20:23]
    ds_read_b64 v[78:79], v14 offset:1608
    v_mfma_f32_16x16x32_bf16 v[24:27], v[80:83], v[40:43], v[24:27]
    v_mfma_f32_16x16x32_bf16 v[28:31], v[80:83], v[44:47], v[28:31]
    s_waitcnt lgkmcnt(12)
    ds_read_b128 v[44:47], v15 offset:2112
    v_mfma_f32_16x16x32_bf16 v[20:23], v[84:87], v[32:35], v[20:23]
    ds_read_b64 v[80:81], v14 offset:2112
    v_mfma_f32_16x16x32_bf16 v[24:27], v[84:87], v[36:39], v[24:27]
    ds_read_b64 v[82:83], v14 offset:2120
    v_mfma_f32_16x16x32_bf16 v[28:31], v[84:87], v[40:43], v[28:31]
    s_waitcnt lgkmcnt(12)
    ds_read_b128 v[40:43], v15 offset:2624
    v_mfma_f32_16x16x32_bf16 v[24:27], v[88:91], v[32:35], v[24:27]
    ds_read_b64 v[84:85], v14 offset:2624
    v_mfma_f32_16x16x32_bf16 v[28:31], v[88:91], v[36:39], v[28:31]
    ds_read_b128 v[36:39], v15 offset:3136
    s_waitcnt lgkmcnt(12)
    v_mfma_f32_16x16x32_bf16 v[28:31], v[92:95], v[32:35], v[28:31]
    ds_read_b128 v[32:35], v15 offset:3648
    s_waitcnt lgkmcnt(9)
    v_mfma_f32_16x16x32_bf16 v[16:19], v[64:67], v[48:51], v[16:19]
    ds_read_b64 v[86:87], v14 offset:2632
    v_mfma_f32_16x16x32_bf16 v[20:23], v[64:67], v[52:55], v[20:23]
    ds_read_b64 v[88:89], v14 offset:3136
    v_mfma_f32_16x16x32_bf16 v[24:27], v[64:67], v[56:59], v[24:27]
    ds_read_b64 v[90:91], v14 offset:3144
    v_mfma_f32_16x16x32_bf16 v[28:31], v[64:67], v[60:63], v[28:31]
    ds_read_b64 v[64:65], v14 offset:128
    s_waitcnt lgkmcnt(10)
    v_mfma_f32_16x16x32_bf16 v[16:19], v[68:71], v[44:47], v[16:19]
    ds_read_b64 v[66:67], v14 offset:136
    v_mfma_f32_16x16x32_bf16 v[20:23], v[68:71], v[48:51], v[20:23]
    ds_read_b128 v[60:63], v15 offset:128
    v_mfma_f32_16x16x32_bf16 v[24:27], v[68:71], v[52:55], v[24:27]
    ds_read_b64 v[92:93], v14 offset:3648
    v_mfma_f32_16x16x32_bf16 v[28:31], v[68:71], v[56:59], v[28:31]
    ds_read_b128 v[56:59], v15 offset:640
    s_waitcnt lgkmcnt(11)
    v_mfma_f32_16x16x32_bf16 v[16:19], v[72:75], v[40:43], v[16:19]
    ds_read_b64 v[68:69], v14 offset:640
    v_mfma_f32_16x16x32_bf16 v[20:23], v[72:75], v[44:47], v[20:23]
    ds_read_b64 v[70:71], v14 offset:648
    v_mfma_f32_16x16x32_bf16 v[24:27], v[72:75], v[48:51], v[24:27]
    ds_read_b64 v[94:95], v14 offset:3656
    v_mfma_f32_16x16x32_bf16 v[28:31], v[72:75], v[52:55], v[28:31]
    ds_read_b128 v[52:55], v15 offset:1152
    s_waitcnt lgkmcnt(13)
    v_mfma_f32_16x16x32_bf16 v[16:19], v[76:79], v[36:39], v[16:19]
    ds_read_b64 v[72:73], v14 offset:1152
    v_mfma_f32_16x16x32_bf16 v[20:23], v[76:79], v[40:43], v[20:23]
    ds_read_b64 v[74:75], v14 offset:1160
    v_mfma_f32_16x16x32_bf16 v[24:27], v[76:79], v[44:47], v[24:27]
    v_mfma_f32_16x16x32_bf16 v[28:31], v[76:79], v[48:51], v[28:31]
    s_waitcnt lgkmcnt(12)
    ds_read_b128 v[48:51], v15 offset:1664
    v_mfma_f32_16x16x32_bf16 v[16:19], v[80:83], v[32:35], v[16:19]
    ds_read_b64 v[76:77], v14 offset:1664
    v_mfma_f32_16x16x32_bf16 v[20:23], v[80:83], v[36:39], v[20:23]
    ds_read_b64 v[78:79], v14 offset:1672
    v_mfma_f32_16x16x32_bf16 v[24:27], v[80:83], v[40:43], v[24:27]
    v_mfma_f32_16x16x32_bf16 v[28:31], v[80:83], v[44:47], v[28:31]
    s_waitcnt lgkmcnt(12)
    ds_read_b128 v[44:47], v15 offset:2176
    v_mfma_f32_16x16x32_bf16 v[20:23], v[84:87], v[32:35], v[20:23]
    ds_read_b64 v[80:81], v14 offset:2176
    v_mfma_f32_16x16x32_bf16 v[24:27], v[84:87], v[36:39], v[24:27]
    ds_read_b64 v[82:83], v14 offset:2184
    v_mfma_f32_16x16x32_bf16 v[28:31], v[84:87], v[40:43], v[28:31]
    s_waitcnt lgkmcnt(12)
    ds_read_b128 v[40:43], v15 offset:2688
    v_mfma_f32_16x16x32_bf16 v[24:27], v[88:91], v[32:35], v[24:27]
    ds_read_b64 v[84:85], v14 offset:2688
    v_mfma_f32_16x16x32_bf16 v[28:31], v[88:91], v[36:39], v[28:31]
    ds_read_b128 v[36:39], v15 offset:3200
    s_waitcnt lgkmcnt(12)
    v_mfma_f32_16x16x32_bf16 v[28:31], v[92:95], v[32:35], v[28:31]
    ds_read_b128 v[32:35], v15 offset:3712
    v_add_u32 v14, 128, v14
    v_add_u32 v15, 128, v15
    s_add_u32 s63, s63, 1
    s_cmp_lt_u32 s63, 4
    s_cbranch_scc1 CL_30
    v_subrev_u32 v14, 512, v14
    v_subrev_u32 v15, 512, v15
    s_waitcnt lgkmcnt(8)
    s_mov_b32 s58, 0
CC_32:
    ds_read_b32 v10, v12 offset:32
    ds_read_b64 v[96:97], v4 offset:1536
    ds_read_b64 v[98:99], v4 offset:1024
    ds_read_b64 v[100:101], v4 offset:512
    ds_read_b64 v[102:103], v4 offset:0
    s_add_u32 s58, s58, 1
    s_waitcnt lgkmcnt(4)
    v_cmp_eq_u32 vcc, 0, v10
    s_nop 1
    s_cbranch_vccz CD_33
    s_cmp_lt_u32 s58, 80000
    s_cbranch_scc1 CC_32
CD_33:
    s_add_u32 s66, s75, 1310720
    s_waitcnt lgkmcnt(2)
    v_and_b32 v104, s59, v97
    v_lshlrev_b32 v105, 16, v97
    v_and_b32 v106, s59, v96
    v_lshlrev_b32 v107, 16, v96
    v_fmac_f32 v16, s74, v104
    v_fmac_f32 v17, s74, v105
    v_fmac_f32 v18, s74, v106
    v_fmac_f32 v19, s74, v107
    v_cvt_pk_bf16_f32 v108, v16, v17
    v_cvt_pk_bf16_f32 v109, v18, v19
    v_and_b32 v104, s59, v99
    v_lshlrev_b32 v105, 16, v99
    v_and_b32 v106, s59, v98
    v_lshlrev_b32 v107, 16, v98
    v_fmac_f32 v20, s74, v104
    v_fmac_f32 v21, s74, v105
    v_fmac_f32 v22, s74, v106
    v_fmac_f32 v23, s74, v107
    v_cvt_pk_bf16_f32 v110, v20, v21
    v_cvt_pk_bf16_f32 v111, v22, v23
    s_nop 0
    v_permlane16_swap_b32 v108, v110
    v_permlane16_swap_b32 v109, v111
    v_min_u32 v108, -2, v108
    v_min_u32 v109, -2, v109
    v_min_u32 v110, -2, v110
    v_min_u32 v111, -2, v111
    buffer_store_dwordx4 v[108:111], v5, s[32:35], s66 offen sc1
    s_add_u32 s66, s75, 1966080
    s_waitcnt lgkmcnt(0)
    v_and_b32 v104, s59, v101
    v_lshlrev_b32 v105, 16, v101
    v_and_b32 v106, s59, v100
    v_lshlrev_b32 v107, 16, v100
    v_fmac_f32 v24, s74, v104
    v_fmac_f32 v25, s74, v105
    v_fmac_f32 v26, s74, v106
    v_fmac_f32 v27, s74, v107
    v_cvt_pk_bf16_f32 v112, v24, v25
    v_cvt_pk_bf16_f32 v113, v26, v27
    v_and_b32 v104, s59, v103
    v_lshlrev_b32 v105, 16, v103
    v_and_b32 v106, s59, v102
    v_lshlrev_b32 v107, 16, v102
    v_fmac_f32 v28, s74, v104
    v_fmac_f32 v29, s74, v105
    v_fmac_f32 v30, s74, v106
    v_fmac_f32 v31, s74, v107
    v_cvt_pk_bf16_f32 v114, v28, v29
    v_cvt_pk_bf16_f32 v115, v30, v31
    s_nop 0
    v_permlane16_swap_b32 v112, v114
    v_permlane16_swap_b32 v113, v115
    v_min_u32 v112, -2, v112
    v_min_u32 v113, -2, v113
    v_min_u32 v114, -2, v114
    v_min_u32 v115, -2, v115
    buffer_store_dwordx4 v[112:115], v5, s[32:35], s66 offen sc1
    v_mov_b32 v10, 1
    ds_write_b32 v13, v10 offset:64
    s_branch G2_CI
CV_V2:
    s_mov_b32 s58, 0
RW_34:
    ds_read_b128 v[16:19], v12 offset:0
    ds_read_b128 v[20:23], v12 offset:16
    s_add_u32 s58, s58, 1
    s_waitcnt lgkmcnt(0)
    v_min3_u32 v16, v16, v17, v18
    v_min3_u32 v20, v20, v21, v22
    v_min3_u32 v16, v16, v19, v23
    v_min_u32 v16, v16, v20
    v_cmp_eq_u32 vcc, 0, v16
    s_nop 1
    s_cbranch_vccz RD_35
    s_cmp_lt_u32 s58, 80000
    s_cbranch_scc1 RW_34
RD_35:
    s_branch CV_GO
CV_L1:
    s_setprio 0
    v_mov_b32 v10, 1
    ds_write_b32 v13, v10 offset:64
    s_mov_b32 s58, 0
RW_36:
    ds_read_b128 v[16:19], v12 offset:0
    ds_read_b128 v[20:23], v12 offset:16
    s_add_u32 s58, s58, 1
    s_waitcnt lgkmcnt(0)
    v_min3_u32 v16, v16, v17, v18
    v_min3_u32 v20, v20, v21, v22
    v_min3_u32 v16, v16, v19, v23
    v_min_u32 v16, v16, v20
    v_cmp_eq_u32 vcc, 0, v16
    s_nop 1
    s_cbranch_vccz RD_37
    s_cmp_lt_u32 s58, 80000
    s_cbranch_scc1 RW_36
RD_37:
    s_sub_u32 s63, s29, 4
    s_lshl_b32 s92, s63, 10
    s_add_u32 s92, s92, 93696
    s_add_u32 s63, s63, 48
    s_mul_i32 s91, s63, 13824
    s_mov_b32 s93, 27648
    s_mov_b32 s63, 34
WS_38:
    s_waitcnt vmcnt(17)
    s_mov_b32 m0, s92
    s_add_u32 s92, s92, 2048
    buffer_load_dwordx4 v8, s[36:39], s91 offen lds
    s_add_u32 s91, s91, s93
    s_sub_u32 s63, s63, 1
    s_cmp_lg_u32 s63, 0
    s_cbranch_scc1 WS_38
    v_mov_b32 v11, 2
    s_sub_u32 s63, s29, 4
    s_lshl_b32 s92, s63, 10
    s_add_u32 s92, s92, 0
    s_add_u32 s63, s63, 116
    s_mul_i32 s91, s63, 13824
    s_mov_b32 s93, 27648
    v_add_u32 v14, s92, v2
    s_waitcnt vmcnt(15)
    buffer_load_dwordx4 v[100:103], v8, s[36:39], s91 offen
    s_add_u32 s91, s91, s93
    s_waitcnt vmcnt(15)
    buffer_load_dwordx4 v[104:107], v8, s[36:39], s91 offen
    s_add_u32 s91, s91, s93
    s_waitcnt vmcnt(15)
    buffer_load_dwordx4 v[108:111], v8, s[36:39], s91 offen
    s_add_u32 s91, s91, s93
    s_waitcnt vmcnt(15)
    buffer_load_dwordx4 v[112:115], v8, s[36:39], s91 offen
    s_add_u32 s91, s91, s93
    s_waitcnt vmcnt(15)
    buffer_load_dwordx4 v[116:119], v8, s[36:39], s91 offen
    s_add_u32 s91, s91, s93
    s_waitcnt vmcnt(15)
    buffer_load_dwordx4 v[120:123], v8, s[36:39], s91 offen
    s_add_u32 s91, s91, s93
    s_waitcnt vmcnt(15)
    buffer_load_dwordx4 v[124:127], v8, s[36:39], s91 offen
    s_add_u32 s91, s91, s93
    s_waitcnt vmcnt(15)
    buffer_load_dwordx4 v[128:131], v8, s[36:39], s91 offen
    s_add_u32 s91, s91, s93
    s_waitcnt vmcnt(15)
    buffer_load_dwordx4 v[132:135], v8, s[36:39], s91 offen
    s_add_u32 s91, s91, s93
    s_waitcnt vmcnt(15)
    buffer_load_dwordx4 v[136:139], v8, s[36:39], s91 offen
    s_add_u32 s91, s91, s93
    s_waitcnt vmcnt(15)
    buffer_load_dwordx4 v[140:143], v8, s[36:39], s91 offen
    s_add_u32 s91, s91, s93
    s_waitcnt vmcnt(15)
    buffer_load_dwordx4 v[144:147], v8, s[36:39], s91 offen
    s_add_u32 s91, s91, s93
    s_waitcnt vmcnt(15)
    buffer_load_dwordx4 v[148:151], v8, s[36:39], s91 offen
    s_add_u32 s91, s91, s93
    s_waitcnt vmcnt(15)
    buffer_load_dwordx4 v[152:155], v8, s[36:39], s91 offen
    s_add_u32 s91, s91, s93
    s_waitcnt vmcnt(15)
    buffer_load_dwordx4 v[156:159], v8, s[36:39], s91 offen
    s_add_u32 s91, s91, s93
    s_waitcnt vmcnt(15)
    ds_write_b32 v13, v10 offset:96
    buffer_load_dwordx4 v[160:163], v8, s[36:39], s91 offen
    s_add_u32 s91, s91, s93
    s_waitcnt vmcnt(15)
    buffer_load_dwordx4 v[164:167], v8, s[36:39], s91 offen
    s_add_u32 s91, s91, s93
    s_waitcnt vmcnt(15)
    buffer_load_dwordx4 v[168:171], v8, s[36:39], s91 offen
    s_add_u32 s91, s91, s93
    s_waitcnt vmcnt(15)
    buffer_load_dwordx4 v[172:175], v8, s[36:39], s91 offen
    s_add_u32 s91, s91, s93
    s_waitcnt vmcnt(15)
    buffer_load_dwordx4 v[176:179], v8, s[36:39], s91 offen
    s_add_u32 s91, s91, s93
    s_waitcnt vmcnt(15)
    buffer_load_dwordx4 v[180:183], v8, s[36:39], s91 offen
    s_add_u32 s91, s91, s93
    s_waitcnt vmcnt(15)
    buffer_load_dwordx4 v[184:187], v8, s[36:39], s91 offen
    s_add_u32 s91, s91, s93
    s_mov_b32 s58, 0
RW_39:
    ds_read_b128 v[16:19], v12 offset:64
    ds_read_b128 v[20:23], v12 offset:80
    s_add_u32 s58, s58, 1
    s_waitcnt lgkmcnt(0)
    v_min3_u32 v16, v16, v17, v18
    v_min3_u32 v20, v20, v21, v22
    v_min3_u32 v16, v16, v19, v23
    v_min_u32 v16, v16, v20
    v_cmp_eq_u32 vcc, 0, v16
    s_nop 1
    s_cbranch_vccz RD_40
    s_cmp_lt_u32 s58, 80000
    s_cbranch_scc1 RW_39
RD_40:
    s_waitcnt vmcnt(21)
    ds_write_b128 v14, v[100:103] offset:0
    s_waitcnt vmcnt(20)
    ds_write_b128 v14, v[104:107] offset:2048
    s_waitcnt vmcnt(19)
    ds_write_b128 v14, v[108:111] offset:4096
    s_waitcnt vmcnt(18)
    ds_write_b128 v14, v[112:115] offset:6144
    s_waitcnt vmcnt(17)
    ds_write_b128 v14, v[116:119] offset:8192
    s_waitcnt vmcnt(16)
    ds_write_b128 v14, v[120:123] offset:10240
    s_waitcnt vmcnt(15)
    ds_write_b128 v14, v[124:127] offset:12288
    s_waitcnt vmcnt(14)
    ds_write_b128 v14, v[128:131] offset:14336
    s_waitcnt vmcnt(13)
    ds_write_b128 v14, v[132:135] offset:16384
    s_waitcnt vmcnt(12)
    ds_write_b128 v14, v[136:139] offset:18432
    s_waitcnt vmcnt(11)
    ds_write_b128 v14, v[140:143] offset:20480
    s_waitcnt vmcnt(10)
    ds_write_b128 v14, v[144:147] offset:22528
    s_waitcnt vmcnt(9)
    ds_write_b128 v14, v[148:151] offset:24576
    s_waitcnt vmcnt(8)
    ds_write_b128 v14, v[152:155] offset:26624
    s_waitcnt vmcnt(7)
    ds_write_b128 v14, v[156:159] offset:28672
    s_waitcnt vmcnt(6)
    ds_write_b128 v14, v[160:163] offset:30720
    s_waitcnt vmcnt(5)
    ds_write_b128 v14, v[164:167] offset:32768
    s_waitcnt vmcnt(4)
    ds_write_b128 v14, v[168:171] offset:34816
    s_waitcnt vmcnt(3)
    ds_write_b128 v14, v[172:175] offset:36864
    s_waitcnt vmcnt(2)
    ds_write_b128 v14, v[176:179] offset:38912
    s_waitcnt vmcnt(1)
    ds_write_b128 v14, v[180:183] offset:44544
    s_waitcnt vmcnt(0)
    ds_write_b128 v14, v[184:187] offset:46592
    ds_write_b32 v13, v11 offset:96
    s_branch G1_HI
CV_L2:
    s_setprio 0
    v_mov_b32 v10, 1
    ds_write_b32 v13, v10 offset:64
    s_sub_u32 s63, s29, 4
    s_lshl_b32 s92, s63, 10
    s_add_u32 s92, s92, 85504
    s_add_u32 s63, s63, 0
    s_mul_i32 s91, s63, 5120
    s_mov_b32 s93, 20480
    s_mov_b32 s63, 19
WS_41:
    s_waitcnt vmcnt(5)
    s_mov_b32 m0, s92
    s_add_u32 s92, s92, 4096
    buffer_load_dwordx4 v8, s[36:39], s91 offen lds
    s_add_u32 s91, s91, s93
    s_sub_u32 s63, s63, 1
    s_cmp_lg_u32 s63, 0
    s_cbranch_scc1 WS_41
    v_mov_b32 v11, 2
    s_mov_b32 s58, 0
RW_42:
    ds_read_b128 v[16:19], v12 offset:64
    ds_read_b128 v[20:23], v12 offset:80
    s_add_u32 s58, s58, 1
    s_waitcnt lgkmcnt(0)
    v_min3_u32 v16, v16, v17, v18
    v_min3_u32 v20, v20, v21, v22
    v_min3_u32 v16, v16, v19, v23
    v_min_u32 v16, v16, v20
    v_cmp_eq_u32 vcc, 0, v16
    s_nop 1
    s_cbranch_vccz RD_43
    s_cmp_lt_u32 s58, 80000
    s_cbranch_scc1 RW_42
RD_43:
    s_sub_u32 s63, s29, 4
    s_lshl_b32 s92, s63, 10
    s_add_u32 s92, s92, 0
    s_add_u32 s63, s63, 76
    s_mul_i32 s91, s63, 5120
    s_mov_b32 s93, 20480
    s_mov_b32 m0, s92
    s_add_u32 s92, s92, 4096
    buffer_load_dwordx4 v8, s[36:39], s91 offen lds
    s_add_u32 s91, s91, s93
    s_mov_b32 m0, s92
    s_add_u32 s92, s92, 4096
    buffer_load_dwordx4 v8, s[36:39], s91 offen lds
    s_add_u32 s91, s91, s93
    s_mov_b32 m0, s92
    s_add_u32 s92, s92, 4096
    buffer_load_dwordx4 v8, s[36:39], s91 offen lds
    s_add_u32 s91, s91, s93
    s_mov_b32 m0, s92
    s_add_u32 s92, s92, 4096
    buffer_load_dwordx4 v8, s[36:39], s91 offen lds
    s_add_u32 s91, s91, s93
    s_mov_b32 m0, s92
    s_add_u32 s92, s92, 4096
    buffer_load_dwordx4 v8, s[36:39], s91 offen lds
    s_add_u32 s91, s91, s93
    s_mov_b32 m0, s92
    s_add_u32 s92, s92, 4096
    buffer_load_dwordx4 v8, s[36:39], s91 offen lds
    s_add_u32 s91, s91, s93
    s_mov_b32 m0, s92
    s_add_u32 s92, s92, 4096
    buffer_load_dwordx4 v8, s[36:39], s91 offen lds
    s_add_u32 s91, s91, s93
    s_mov_b32 m0, s92
    s_add_u32 s92, s92, 4096
    buffer_load_dwordx4 v8, s[36:39], s91 offen lds
    s_add_u32 s91, s91, s93
    s_mov_b32 m0, s92
    s_add_u32 s92, s92, 4096
    buffer_load_dwordx4 v8, s[36:39], s91 offen lds
    s_add_u32 s91, s91, s93
    s_mov_b32 m0, s92
    s_add_u32 s92, s92, 4096
    buffer_load_dwordx4 v8, s[36:39], s91 offen lds
    s_add_u32 s91, s91, s93
    s_mov_b32 m0, s92
    s_add_u32 s92, s92, 4096
    buffer_load_dwordx4 v8, s[36:39], s91 offen lds
    s_add_u32 s91, s91, s93
    s_mov_b32 m0, s92
    s_add_u32 s92, s92, 4096
    buffer_load_dwordx4 v8, s[36:39], s91 offen lds
    s_add_u32 s91, s91, s93
    s_mov_b32 m0, s92
    s_add_u32 s92, s92, 4096
    buffer_load_dwordx4 v8, s[36:39], s91 offen lds
    s_add_u32 s91, s91, s93
    s_mov_b32 m0, s92
    s_add_u32 s92, s92, 4096
    buffer_load_dwordx4 v8, s[36:39], s91 offen lds
    s_add_u32 s91, s91, s93
    s_mov_b32 m0, s92
    s_add_u32 s92, s92, 4096
    buffer_load_dwordx4 v8, s[36:39], s91 offen lds
    s_add_u32 s91, s91, s93
    s_mov_b32 m0, s92
    s_add_u32 s92, s92, 4096
    buffer_load_dwordx4 v8, s[36:39], s91 offen lds
    s_add_u32 s91, s91, s93
    s_mov_b32 m0, s92
    s_add_u32 s92, s92, 4096
    buffer_load_dwordx4 v8, s[36:39], s91 offen lds
    s_add_u32 s91, s91, s93
    s_waitcnt vmcnt(17)
    ds_write_b32 v13, v10 offset:96
    s_waitcnt vmcnt(0)
    ds_write_b32 v13, v11 offset:96
    s_branch G2_HI
G1_CI:
    v_lshrrev_b32 v10, 5, v1
    v_lshlrev_b32 v10, 5, v10
    s_lshl_b32 s67, s31, 6
    s_mov_b32 s48, s18
    s_mov_b32 s49, s19
    s_mov_b32 s50, 3456
    s_mov_b32 s51, 0x20000
    s_lshl_b32 s66, s30, 8
    s_add_u32 s66, s66, s67
    v_add_u32 v10, s66, v10
    buffer_load_dwordx4 v[64:67], v10, s[48:51], 0 offen
    buffer_load_dwordx4 v[68:71], v10, s[48:51], 0 offen offset:16
    s_cmp_eq_u32 s55, 0
    s_cselect_b32 s63, 835584, 0
    s_cselect_b32 s74, 0, 344064
    s_add_u32 s63, s63, s74
    s_mul_i32 s74, s28, s63
    s_cmp_eq_u32 s55, 0
    s_cselect_b32 s63, 0, 8388608
    s_add_u32 s74, s74, s63
    s_lshl_b32 s68, s30, 2
    s_add_u32 s68, s68, s31
    s_lshl_b32 s63, s68, 11
    s_add_u32 s74, s74, s63
    s_add_u32 s74, s74, 0x1400000
    s_lshl_b32 s78, s28, 13
    s_lshl_b32 s63, s68, 2
    s_add_u32 s78, s78, s63
    s_add_u32 s78, s78, 65536
    s_mov_b32 s79, 114688
    v_lshrrev_b32 v16, 5, v1
    v_and_b32 v17, 31, v1
    v_lshlrev_b32 v17, 4, v17
    v_lshl_add_u32 v0, v16, 10, v17
    v_and_b32 v4, 12, v3
    v_add_u32 v4, 163328, v4
    s_and_b32 s66, s29, 3
    s_lshl_b32 s66, s66, 2
    s_add_u32 s66, s66, 163328
    v_mov_b32 v5, s66
    s_lshl_b32 s63, s68, 2
    s_sub_u32 s82, s78, s63
    v_lshlrev_b32 v10, 7, v1
    buffer_load_dword v18, v10, s[32:35], s82 offen sc1
    v_mov_b32 v14, s53
    v_add_u32 v10, 4096, v3
    s_cmp_lg_u32 s55, 0
    s_cbranch_scc1 BS_44
    buffer_store_dword v14, v10, s[32:35], s82 offen offset:0
    buffer_store_dword v14, v10, s[32:35], s82 offen offset:256
    buffer_store_dword v14, v10, s[32:35], s82 offen offset:512
BR_45:
    s_mov_b32 s58, 0
SL_46:
    ds_read_b32 v16, v12 offset:124
    s_add_u32 s58, s58, 1
    s_waitcnt lgkmcnt(0)
    v_cmp_gt_u32 vcc, 1, v16
    s_nop 1
    s_cbranch_vccz SD_48
    s_cmp_lt_u32 s58, 80000
    s_cbranch_scc1 SL_46
SD_48:
    v_add_u32 v10, 44544, v9
    ds_read_b64_tr_b16 v[96:97], v10 offset:0
    ds_read_b64_tr_b16 v[98:99], v10 offset:1024
    ds_read_b64_tr_b16 v[100:101], v10 offset:4096
    ds_read_b64_tr_b16 v[102:103], v10 offset:5120
    ds_read_b64_tr_b16 v[104:105], v10 offset:8192
    ds_read_b64_tr_b16 v[106:107], v10 offset:9216
    ds_read_b64_tr_b16 v[108:109], v10 offset:12288
    ds_read_b64_tr_b16 v[110:111], v10 offset:13312
    s_waitcnt lgkmcnt(6)
    ds_read_b64_tr_b16 v[112:113], v10 offset:16384
    ds_read_b64_tr_b16 v[114:115], v10 offset:17408
    ds_read_b64_tr_b16 v[116:117], v10 offset:20480
    ds_read_b64_tr_b16 v[118:119], v10 offset:21504
    ds_read_b64_tr_b16 v[120:121], v10 offset:24576
    ds_read_b64_tr_b16 v[122:123], v10 offset:25600
    ds_read_b64_tr_b16 v[124:125], v10 offset:28672
    ds_read_b64_tr_b16 v[126:127], v10 offset:29696
    s_waitcnt lgkmcnt(6)
    ds_read_b64_tr_b16 v[128:129], v10 offset:32768
    ds_read_b64_tr_b16 v[130:131], v10 offset:33792
    ds_read_b64_tr_b16 v[132:133], v10 offset:36864
    ds_read_b64_tr_b16 v[134:135], v10 offset:37888
    ds_read_b64_tr_b16 v[136:137], v10 offset:40960
    ds_read_b64_tr_b16 v[138:139], v10 offset:41984
    ds_read_b64_tr_b16 v[140:141], v10 offset:45056
    ds_read_b64_tr_b16 v[142:143], v10 offset:46080
    s_waitcnt lgkmcnt(6)
    s_waitcnt lgkmcnt(0)
    v_mov_b32 v10, 1
    ds_write_b32 v13, v10 offset:64
    v_and_b32 v6, 4, v3
    v_add_u32 v6, 163328, v6
    s_mov_b32 s58, 0
SL_49:
    ds_read_b32 v16, v6 offset:112
    s_add_u32 s58, s58, 1
    s_waitcnt lgkmcnt(0)
    v_cmp_gt_u32 vcc, 1, v16
    s_nop 1
    s_cbranch_vccz SD_51
    s_cmp_lt_u32 s58, 80000
    s_cbranch_scc1 SL_49
SD_51:
    v_add_u32 v10, 93696, v9
    ds_read_b64_tr_b16 v[144:145], v10 offset:0
    ds_read_b64_tr_b16 v[146:147], v10 offset:1024
    ds_read_b64_tr_b16 v[148:149], v10 offset:4096
    ds_read_b64_tr_b16 v[150:151], v10 offset:5120
    ds_read_b64_tr_b16 v[152:153], v10 offset:8192
    ds_read_b64_tr_b16 v[154:155], v10 offset:9216
    ds_read_b64_tr_b16 v[156:157], v10 offset:12288
    ds_read_b64_tr_b16 v[158:159], v10 offset:13312
    s_waitcnt lgkmcnt(6)
    ds_read_b64_tr_b16 v[160:161], v10 offset:16384
    ds_read_b64_tr_b16 v[162:163], v10 offset:17408
    ds_read_b64_tr_b16 v[164:165], v10 offset:20480
    ds_read_b64_tr_b16 v[166:167], v10 offset:21504
    ds_read_b64_tr_b16 v[168:169], v10 offset:24576
    ds_read_b64_tr_b16 v[170:171], v10 offset:25600
    ds_read_b64_tr_b16 v[172:173], v10 offset:28672
    ds_read_b64_tr_b16 v[174:175], v10 offset:29696
    s_waitcnt lgkmcnt(6)
    ds_read_b64_tr_b16 v[176:177], v10 offset:32768
    ds_read_b64_tr_b16 v[178:179], v10 offset:33792
    ds_read_b64_tr_b16 v[180:181], v10 offset:36864
    ds_read_b64_tr_b16 v[182:183], v10 offset:37888
    ds_read_b64_tr_b16 v[184:185], v10 offset:40960
    ds_read_b64_tr_b16 v[186:187], v10 offset:41984
    ds_read_b64_tr_b16 v[188:189], v10 offset:45056
    ds_read_b64_tr_b16 v[190:191], v10 offset:46080
    s_waitcnt lgkmcnt(6)
    ds_read_b64_tr_b16 v[192:193], v10 offset:49152
    ds_read_b64_tr_b16 v[194:195], v10 offset:50176
    ds_read_b64_tr_b16 v[196:197], v10 offset:53248
    ds_read_b64_tr_b16 v[198:199], v10 offset:54272
    ds_read_b64_tr_b16 v[200:201], v10 offset:57344
    ds_read_b64_tr_b16 v[202:203], v10 offset:58368
    ds_read_b64_tr_b16 v[204:205], v10 offset:61440
    ds_read_b64_tr_b16 v[206:207], v10 offset:62464
    s_waitcnt lgkmcnt(6)
    v_add_u32 v10, 0x10000, v10
    ds_read_b64_tr_b16 v[208:209], v10 offset:0
    ds_read_b64_tr_b16 v[210:211], v10 offset:1024
    s_waitcnt lgkmcnt(0)
    s_mov_b32 s58, 0
SL_52:
    ds_read_b32 v16, v6 offset:112
    s_add_u32 s58, s58, 1
    s_waitcnt lgkmcnt(0)
    v_cmp_gt_u32 vcc, 2, v16
    s_nop 1
    s_cbranch_vccz SD_54
    s_cmp_lt_u32 s58, 80000
    s_cbranch_scc1 SL_52
SD_54:
    v_add_u32 v10, 0, v9
    ds_read_b64_tr_b16 v[212:213], v10 offset:0
    ds_read_b64_tr_b16 v[214:215], v10 offset:1024
    ds_read_b64_tr_b16 v[216:217], v10 offset:4096
    ds_read_b64_tr_b16 v[218:219], v10 offset:5120
    ds_read_b64_tr_b16 v[220:221], v10 offset:8192
    ds_read_b64_tr_b16 v[222:223], v10 offset:9216
    ds_read_b64_tr_b16 v[224:225], v10 offset:12288
    ds_read_b64_tr_b16 v[226:227], v10 offset:13312
    s_waitcnt lgkmcnt(6)
    ds_read_b64_tr_b16 v[228:229], v10 offset:16384
    ds_read_b64_tr_b16 v[230:231], v10 offset:17408
    ds_read_b64_tr_b16 v[232:233], v10 offset:20480
    ds_read_b64_tr_b16 v[234:235], v10 offset:21504
    ds_read_b64_tr_b16 v[236:237], v10 offset:24576
    ds_read_b64_tr_b16 v[238:239], v10 offset:25600
    ds_read_b64_tr_b16 v[240:241], v10 offset:28672
    ds_read_b64_tr_b16 v[242:243], v10 offset:29696
    s_waitcnt lgkmcnt(6)
    ds_read_b64_tr_b16 v[244:245], v10 offset:32768
    ds_read_b64_tr_b16 v[246:247], v10 offset:33792
    ds_read_b64_tr_b16 v[248:249], v10 offset:36864
    ds_read_b64_tr_b16 v[250:251], v10 offset:37888
    v_add_u32 v10, 44544, v9
    ds_read_b64_tr_b16 v[252:253], v10 offset:0
    ds_read_b64_tr_b16 v[254:255], v10 offset:1024
    s_waitcnt lgkmcnt(0)
    v_mov_b32 v15, 1
    ds_write_b32 v5, v15 offset:160
    s_waitcnt vmcnt(0)
    v_lshlrev_b32 v48, 16, v64
    v_and_b32 v49, s59, v64
    v_lshlrev_b32 v50, 16, v65
    v_and_b32 v51, s59, v65
    v_lshlrev_b32 v52, 16, v66
    v_and_b32 v53, s59, v66
    v_lshlrev_b32 v54, 16, v67
    v_and_b32 v55, s59, v67
    v_lshlrev_b32 v56, 16, v68
    v_and_b32 v57, s59, v68
    v_lshlrev_b32 v58, 16, v69
    v_and_b32 v59, s59, v69
    v_lshlrev_b32 v60, 16, v70
    v_and_b32 v61, s59, v70
    v_lshlrev_b32 v62, 16, v71
    v_and_b32 v63, s59, v71
    v_mul_f32 v48, s62, v48
    v_mul_f32 v49, s62, v49
    v_mul_f32 v50, s62, v50
    v_mul_f32 v51, s62, v51
    v_mul_f32 v52, s62, v52
    v_mul_f32 v53, s62, v53
    v_mul_f32 v54, s62, v54
    v_mul_f32 v55, s62, v55
    v_mul_f32 v56, s62, v56
    v_mul_f32 v57, s62, v57
    v_mul_f32 v58, s62, v58
    v_mul_f32 v59, s62, v59
    v_mul_f32 v60, s62, v60
    v_mul_f32 v61, s62, v61
    v_mul_f32 v62, s62, v62
    v_mul_f32 v63, s62, v63
    s_mov_b32 s83, s62
    s_mov_b32 s62, 0x409d30fc
    s_mov_b32 s76, 0x10001
    v_mov_b32 v14, s53
    s_lshl_b32 s63, s68, 2
    s_sub_u32 s63, 4096, s63
    v_min_u32 v18, 116, v3
    v_add_u32 v18, s63, v18
    v_cmp_eq_u32 vcc, 0, v3
    v_mov_b32 v11, 0x10000000
    s_nop 0
    v_cndmask_b32_e64 v11, v11, 0, vcc
    v_mov_b32 v17, 1
    s_mov_b32 s56, 0
    s_mov_b32 s81, 0
    s_mov_b32 s80, 2
    s_mov_b32 s84, 1
    v_and_b32 v4, 4, v3
    v_add_u32 v4, 163328, v4
    s_mov_b32 s72, 49152
    s_mov_b32 s75, 40960
    v_add_u32 v6, s72, v2
    s_setprio 2
    s_branch G1_WAIT
G1_SLOW:
    v_add_u32 v15, 1, v15
    ds_write_b32 v5, v15 offset:160
    s_add_u32 s56, s56, 1
    s_waitcnt lgkmcnt(1)
    v_cmp_gt_u32 vcc, s84, v16
    s_nop 1
    s_cbranch_vccnz G1_ALONE
    ds_read_b128 v[28:31], v6 offset:0
    ds_read_b128 v[32:35], v6 offset:1024
    ds_read_b128 v[36:39], v6 offset:2048
    ds_read_b128 v[40:43], v6 offset:3072
    s_nop 0
    ds_write_b32 v5, v15 offset:160
    s_cmp_eq_u32 s56, 15
    s_cbranch_scc1 G1_V2
    s_branch G1_V1
G1_ALONE:
    buffer_load_dword v12, v18, s[32:35], s78 offen sc1
    s_nop 1
    v_fma_f32 v20, v64, v64, s62
    v_fma_f32 v21, v65, v65, s62
    v_fma_f32 v22, v66, v66, s62
    v_fma_f32 v23, v67, v67, s62
    v_fma_f32 v24, v68, v68, s62
    v_fma_f32 v25, v69, v69, s62
    v_fma_f32 v26, v70, v70, s62
    v_fma_f32 v27, v71, v71, s62
    v_mul_f32 v20, v20, v64
    v_mul_f32 v21, v21, v65
    v_mul_f32 v22, v22, v66
    v_mul_f32 v23, v23, v67
    v_mul_f32 v24, v24, v68
    v_mul_f32 v25, v25, v69
    v_mul_f32 v26, v26, v70
    v_mul_f32 v27, v27, v71
    v_exp_f32_e64 v20, -v20
    v_exp_f32_e64 v21, -v21
    v_exp_f32_e64 v22, -v22
    v_exp_f32_e64 v23, -v23
    v_exp_f32_e64 v24, -v24
    v_exp_f32_e64 v25, -v25
    v_exp_f32_e64 v26, -v26
    v_exp_f32_e64 v27, -v27
    v_fma_f32 v20, v20, s83, s83
    v_fma_f32 v21, v21, s83, s83
    v_fma_f32 v22, v22, s83, s83
    v_fma_f32 v23, v23, s83, s83
    v_fma_f32 v24, v24, s83, s83
    v_fma_f32 v25, v25, s83, s83
    v_fma_f32 v26, v26, s83, s83
    v_fma_f32 v27, v27, s83, s83
    v_rcp_f32 v20, v20
    v_rcp_f32 v21, v21
    v_rcp_f32 v22, v22
    v_rcp_f32 v23, v23
    v_rcp_f32 v24, v24
    v_rcp_f32 v25, v25
    v_rcp_f32 v26, v26
    v_rcp_f32 v27, v27
    v_mul_f32 v20, v20, v64
    v_mul_f32 v21, v21, v65
    v_mul_f32 v22, v22, v66
    v_mul_f32 v23, v23, v67
    v_mul_f32 v24, v24, v68
    v_mul_f32 v25, v25, v69
    v_mul_f32 v26, v26, v70
    v_mul_f32 v27, v27, v71
    v_cvt_pk_bf16_f32 v64, v20, v21
    v_cvt_pk_bf16_f32 v65, v22, v23
    v_cvt_pk_bf16_f32 v66, v24, v25
    v_cvt_pk_bf16_f32 v67, v26, v27
    v_bfi_b32 v64, s76, v17, v64
    v_fma_f32 v20, v72, v72, s62
    v_fma_f32 v21, v73, v73, s62
    v_fma_f32 v22, v74, v74, s62
    v_fma_f32 v23, v75, v75, s62
    v_fma_f32 v24, v76, v76, s62
    v_fma_f32 v25, v77, v77, s62
    v_fma_f32 v26, v78, v78, s62
    v_fma_f32 v27, v79, v79, s62
    v_mul_f32 v20, v20, v72
    v_mul_f32 v21, v21, v73
    v_mul_f32 v22, v22, v74
    v_mul_f32 v23, v23, v75
    v_mul_f32 v24, v24, v76
    v_mul_f32 v25, v25, v77
    v_mul_f32 v26, v26, v78
    v_mul_f32 v27, v27, v79
    v_exp_f32_e64 v20, -v20
    v_exp_f32_e64 v21, -v21
    v_exp_f32_e64 v22, -v22
    v_exp_f32_e64 v23, -v23
    v_exp_f32_e64 v24, -v24
    v_exp_f32_e64 v25, -v25
    v_exp_f32_e64 v26, -v26
    v_exp_f32_e64 v27, -v27
    v_fma_f32 v20, v20, s83, s83
    v_fma_f32 v21, v21, s83, s83
    v_fma_f32 v22, v22, s83, s83
    v_fma_f32 v23, v23, s83, s83
    v_fma_f32 v24, v24, s83, s83
    v_fma_f32 v25, v25, s83, s83
    v_fma_f32 v26, v26, s83, s83
    v_fma_f32 v27, v27, s83, s83
    v_rcp_f32 v20, v20
    v_rcp_f32 v21, v21
    v_rcp_f32 v22, v22
    v_rcp_f32 v23, v23
    v_rcp_f32 v24, v24
    v_rcp_f32 v25, v25
    v_rcp_f32 v26, v26
    v_rcp_f32 v27, v27
    v_mul_f32 v20, v20, v72
    v_mul_f32 v21, v21, v73
    v_mul_f32 v22, v22, v74
    v_mul_f32 v23, v23, v75
    v_mul_f32 v24, v24, v76
    v_mul_f32 v25, v25, v77
    v_mul_f32 v26, v26, v78
    v_mul_f32 v27, v27, v79
    v_cvt_pk_bf16_f32 v72, v20, v21
    v_cvt_pk_bf16_f32 v73, v22, v23
    v_cvt_pk_bf16_f32 v74, v24, v25
    v_cvt_pk_bf16_f32 v75, v26, v27
    v_bfi_b32 v72, s76, v17, v72
    s_waitcnt vmcnt(0)
    v_cmp_ne_u32 vcc, v14, v12
    s_nop 1
    s_cbranch_vccnz FS_55
FR_57:
    s_cmp_lg_u32 s55, 0
    s_cbranch_scc1 BS_58
    buffer_store_dwordx4 v[64:67], v0, s[32:35], s74 offen offset:0
    buffer_store_dwordx4 v[72:75], v0, s[32:35], s74 offen offset:512
    buffer_store_dword v14, v11, s[32:35], s78 offen
BR_59:
    s_add_u32 s78, s78, 256
    s_bitcmp1_b32 0x4924, s81
    s_cselect_b32 s63, -229376, s79
    s_cselect_b32 s82, s76, 0
    s_add_u32 s74, s74, s63
    v_xor_b32 v17, s82, v17
    s_add_u32 s81, s81, 1
    s_cmp_eq_u32 s56, 16
    s_cbranch_scc1 G1_END
G1_WAIT:
    s_mov_b32 s58, 0
SL_60:
    ds_read_b32 v16, v4 offset:128
    s_add_u32 s58, s58, 1
    s_waitcnt lgkmcnt(0)
    v_cmp_gt_u32 vcc, s84, v16
    s_nop 1
    s_cbranch_vccz SD_62
    s_cmp_lt_u32 s58, 80000
    s_cbranch_scc1 SL_60
SD_62:
    ds_read_b128 v[28:31], v6 offset:0
    ds_read_b128 v[32:35], v6 offset:1024
    ds_read_b128 v[36:39], v6 offset:2048
    ds_read_b128 v[40:43], v6 offset:3072
G1_B0:
    s_waitcnt lgkmcnt(3)
    v_mfma_f32_32x32x16_bf16 v[80:95], v[96:99], v[28:31], v[48:63]
    ds_read_b128 v[44:47], v6 offset:4096
    s_waitcnt lgkmcnt(3)
    v_mfma_f32_32x32x16_bf16 v[80:95], v[100:103], v[32:35], v[80:95]
    ds_read_b128 v[28:31], v6 offset:5120
    s_waitcnt lgkmcnt(3)
    v_mfma_f32_32x32x16_bf16 v[80:95], v[104:107], v[36:39], v[80:95]
    ds_read_b128 v[32:35], v6 offset:6144
    s_waitcnt lgkmcnt(3)
    v_mfma_f32_32x32x16_bf16 v[80:95], v[108:111], v[40:43], v[80:95]
    ds_read_b128 v[36:39], v6 offset:7168
    s_waitcnt lgkmcnt(3)
    v_mfma_f32_32x32x16_bf16 v[80:95], v[112:115], v[44:47], v[80:95]
    ds_read_b128 v[40:43], v6 offset:8192
    s_waitcnt lgkmcnt(3)
    v_mfma_f32_32x32x16_bf16 v[80:95], v[116:119], v[28:31], v[80:95]
    ds_read_b128 v[44:47], v6 offset:9216
    s_waitcnt lgkmcnt(3)
    v_mfma_f32_32x32x16_bf16 v[80:95], v[120:123], v[32:35], v[80:95]
    ds_read_b128 v[28:31], v6 offset:10240
    s_waitcnt lgkmcnt(3)
    v_mfma_f32_32x32x16_bf16 v[80:95], v[124:127], v[36:39], v[80:95]
    ds_read_b128 v[32:35], v6 offset:11264
    ds_read_b32 v16, v4 offset:128
    s_waitcnt lgkmcnt(4)
    v_mfma_f32_32x32x16_bf16 v[80:95], v[128:131], v[40:43], v[80:95]
    ds_read_b128 v[36:39], v6 offset:12288
    s_waitcnt lgkmcnt(4)
    v_mfma_f32_32x32x16_bf16 v[80:95], v[132:135], v[44:47], v[80:95]
    ds_read_b128 v[40:43], v6 offset:13312
    s_waitcnt lgkmcnt(4)
    v_mfma_f32_32x32x16_bf16 v[80:95], v[136:139], v[28:31], v[80:95]
    s_waitcnt lgkmcnt(2)
    v_cmp_gt_u32 vcc, s80, v16
    s_nop 1
    s_cbranch_vccnz G1_MS0
G1_MR:
    ds_read_b128 v[44:47], v6 offset:14336
    s_cmp_eq_u32 s72, 90112
    s_cselect_b32 s63, -81920, s75
    s_add_u32 s72, s72, s63
    s_add_u32 s84, s80, 1
    s_add_u32 s80, s80, 2
    v_xor_b32 v4, 8, v4
    v_mfma_f32_32x32x16_bf16 v[80:95], v[140:143], v[32:35], v[80:95]
    ds_read_b128 v[28:31], v6 offset:15360
    s_waitcnt lgkmcnt(3)
    v_mfma_f32_32x32x16_bf16 v[80:95], v[144:147], v[36:39], v[80:95]
    ds_read_b128 v[32:35], v6 offset:16384
    s_waitcnt lgkmcnt(3)
    v_mfma_f32_32x32x16_bf16 v[80:95], v[148:151], v[40:43], v[80:95]
    ds_read_b128 v[36:39], v6 offset:17408
    s_waitcnt lgkmcnt(3)
    v_mfma_f32_32x32x16_bf16 v[80:95], v[152:155], v[44:47], v[80:95]
    ds_read_b128 v[40:43], v6 offset:18432
    s_waitcnt lgkmcnt(3)
    v_mfma_f32_32x32x16_bf16 v[80:95], v[156:159], v[28:31], v[80:95]
    ds_read_b128 v[44:47], v6 offset:19456
    s_waitcnt lgkmcnt(3)
    v_mfma_f32_32x32x16_bf16 v[80:95], v[160:163], v[32:35], v[80:95]
    ds_read_b128 v[28:31], v6 offset:20480
    s_waitcnt lgkmcnt(3)
    v_mfma_f32_32x32x16_bf16 v[80:95], v[164:167], v[36:39], v[80:95]
    ds_read_b128 v[32:35], v6 offset:21504
    s_waitcnt lgkmcnt(3)
    v_mfma_f32_32x32x16_bf16 v[80:95], v[168:171], v[40:43], v[80:95]
    ds_read_b128 v[36:39], v6 offset:22528
    s_waitcnt lgkmcnt(3)
    v_mfma_f32_32x32x16_bf16 v[80:95], v[172:175], v[44:47], v[80:95]
    ds_read_b128 v[40:43], v6 offset:23552
    s_waitcnt lgkmcnt(3)
    v_mfma_f32_32x32x16_bf16 v[80:95], v[176:179], v[28:31], v[80:95]
    ds_read_b128 v[44:47], v6 offset:24576
    s_waitcnt lgkmcnt(3)
    v_mfma_f32_32x32x16_bf16 v[80:95], v[180:183], v[32:35], v[80:95]
    ds_read_b128 v[28:31], v6 offset:25600
    s_waitcnt lgkmcnt(3)
    v_mfma_f32_32x32x16_bf16 v[80:95], v[184:187], v[36:39], v[80:95]
    ds_read_b128 v[32:35], v6 offset:26624
    s_waitcnt lgkmcnt(3)
    v_mfma_f32_32x32x16_bf16 v[80:95], v[188:191], v[40:43], v[80:95]
    ds_read_b128 v[36:39], v6 offset:27648
    s_waitcnt lgkmcnt(3)
    v_mfma_f32_32x32x16_bf16 v[80:95], v[192:195], v[44:47], v[80:95]
    ds_read_b128 v[40:43], v6 offset:28672
    s_waitcnt lgkmcnt(3)
    v_mfma_f32_32x32x16_bf16 v[80:95], v[196:199], v[28:31], v[80:95]
    ds_read_b128 v[44:47], v6 offset:29696
    s_waitcnt lgkmcnt(3)
    v_mfma_f32_32x32x16_bf16 v[80:95], v[200:203], v[32:35], v[80:95]
    ds_read_b128 v[28:31], v6 offset:30720
    s_waitcnt lgkmcnt(3)
    v_mfma_f32_32x32x16_bf16 v[80:95], v[204:207], v[36:39], v[80:95]
    ds_read_b128 v[32:35], v6 offset:31744
    s_waitcnt lgkmcnt(3)
    v_mfma_f32_32x32x16_bf16 v[80:95], v[208:211], v[40:43], v[80:95]
    ds_read_b128 v[36:39], v6 offset:32768
    s_waitcnt lgkmcnt(3)
    v_mfma_f32_32x32x16_bf16 v[80:95], v[212:215], v[44:47], v[80:95]
    ds_read_b128 v[40:43], v6 offset:33792
    s_waitcnt lgkmcnt(3)
    v_mfma_f32_32x32x16_bf16 v[80:95], v[216:219], v[28:31], v[80:95]
    ds_read_b128 v[44:47], v6 offset:34816
    s_waitcnt lgkmcnt(3)
    v_mfma_f32_32x32x16_bf16 v[80:95], v[220:223], v[32:35], v[80:95]
    ds_read_b128 v[28:31], v6 offset:35840
    s_waitcnt lgkmcnt(3)
    v_mfma_f32_32x32x16_bf16 v[80:95], v[224:227], v[36:39], v[80:95]
    ds_read_b128 v[32:35], v6 offset:36864
    s_waitcnt lgkmcnt(3)
    v_mfma_f32_32x32x16_bf16 v[80:95], v[228:231], v[40:43], v[80:95]
    ds_read_b128 v[36:39], v6 offset:37888
    ds_read_b32 v16, v4 offset:128
    s_waitcnt lgkmcnt(4)
    v_mfma_f32_32x32x16_bf16 v[80:95], v[232:235], v[44:47], v[80:95]
    ds_read_b128 v[40:43], v6 offset:38912
    s_waitcnt lgkmcnt(4)
    v_mfma_f32_32x32x16_bf16 v[80:95], v[236:239], v[28:31], v[80:95]
    ds_read_b128 v[44:47], v6 offset:39936
    s_waitcnt lgkmcnt(2)
    v_cmp_gt_u32 vcc, s84, v16
    v_add_u32 v6, s72, v2
    s_nop 0
    s_cbranch_vccnz G1_ST0
    v_mfma_f32_32x32x16_bf16 v[80:95], v[240:243], v[32:35], v[80:95]
    ds_read_b128 v[28:31], v6 offset:0
    v_mfma_f32_32x32x16_bf16 v[80:95], v[244:247], v[36:39], v[80:95]
    ds_read_b128 v[32:35], v6 offset:1024
    s_waitcnt lgkmcnt(3)
    v_mfma_f32_32x32x16_bf16 v[80:95], v[248:251], v[40:43], v[80:95]
    ds_read_b128 v[36:39], v6 offset:2048
    s_waitcnt lgkmcnt(3)
    v_mfma_f32_32x32x16_bf16 v[64:79], v[252:255], v[44:47], v[80:95]
    ds_read_b128 v[40:43], v6 offset:3072
    v_add_u32 v15, 1, v15
    ds_write_b32 v5, v15 offset:160
    s_add_u32 s56, s56, 1
    s_cmp_eq_u32 s56, 15
    s_cbranch_scc1 G1_V2
    s_branch G1_V1
G1_V1:
    s_waitcnt lgkmcnt(4)
    v_mfma_f32_32x32x16_bf16 v[80:95], v[96:99], v[28:31], v[48:63]
    ds_read_b128 v[44:47], v6 offset:4096
    s_waitcnt lgkmcnt(4)
    v_mfma_f32_32x32x16_bf16 v[80:95], v[100:103], v[32:35], v[80:95]
    ds_read_b128 v[28:31], v6 offset:5120
    buffer_load_dword v12, v18, s[32:35], s78 offen sc1
    v_fma_f32 v20, v64, v64, s62
    v_fma_f32 v21, v65, v65, s62
    s_waitcnt lgkmcnt(4)
    v_mfma_f32_32x32x16_bf16 v[80:95], v[104:107], v[36:39], v[80:95]
    ds_read_b128 v[32:35], v6 offset:6144
    v_fma_f32 v22, v66, v66, s62
    v_fma_f32 v23, v67, v67, s62
    v_mul_f32 v20, v20, v64
    v_mul_f32 v21, v21, v65
    s_waitcnt lgkmcnt(4)
    v_mfma_f32_32x32x16_bf16 v[80:95], v[108:111], v[40:43], v[80:95]
    ds_read_b128 v[36:39], v6 offset:7168
    v_mul_f32 v22, v22, v66
    v_mul_f32 v23, v23, v67
    v_exp_f32_e64 v20, -v20
    s_waitcnt lgkmcnt(3)
    v_mfma_f32_32x32x16_bf16 v[80:95], v[112:115], v[44:47], v[80:95]
    ds_read_b128 v[40:43], v6 offset:8192
    v_exp_f32_e64 v21, -v21
    v_exp_f32_e64 v22, -v22
    s_waitcnt lgkmcnt(3)
    v_mfma_f32_32x32x16_bf16 v[80:95], v[116:119], v[28:31], v[80:95]
    ds_read_b128 v[44:47], v6 offset:9216
    v_exp_f32_e64 v23, -v23
    v_fma_f32 v20, v20, s83, s83
    s_waitcnt lgkmcnt(3)
    v_mfma_f32_32x32x16_bf16 v[80:95], v[120:123], v[32:35], v[80:95]
    ds_read_b128 v[28:31], v6 offset:10240
    v_fma_f32 v21, v21, s83, s83
    v_fma_f32 v22, v22, s83, s83
    v_fma_f32 v23, v23, s83, s83
    v_rcp_f32 v20, v20
    s_waitcnt lgkmcnt(3)
    v_mfma_f32_32x32x16_bf16 v[80:95], v[124:127], v[36:39], v[80:95]
    ds_read_b128 v[32:35], v6 offset:11264
    ds_read_b32 v16, v4 offset:128
    v_rcp_f32 v21, v21
    v_rcp_f32 v22, v22
    s_waitcnt lgkmcnt(4)
    v_mfma_f32_32x32x16_bf16 v[80:95], v[128:131], v[40:43], v[80:95]
    ds_read_b128 v[36:39], v6 offset:12288
    v_rcp_f32 v23, v23
    v_mul_f32 v20, v20, v64
    s_waitcnt lgkmcnt(4)
    v_mfma_f32_32x32x16_bf16 v[80:95], v[132:135], v[44:47], v[80:95]
    ds_read_b128 v[40:43], v6 offset:13312
    v_mul_f32 v21, v21, v65
    v_mul_f32 v22, v22, v66
    v_mul_f32 v23, v23, v67
    v_cvt_pk_bf16_f32 v64, v20, v21
    s_waitcnt lgkmcnt(4)
    v_mfma_f32_32x32x16_bf16 v[80:95], v[136:139], v[28:31], v[80:95]
    s_waitcnt lgkmcnt(2)
    v_cmp_gt_u32 vcc, s80, v16
    s_nop 1
    s_cbranch_vccnz G1_MS1
    ds_read_b128 v[44:47], v6 offset:14336
    s_cmp_eq_u32 s72, 90112
    s_cselect_b32 s63, -81920, s75
    s_add_u32 s72, s72, s63
    s_add_u32 s84, s80, 1
    s_add_u32 s80, s80, 2
    v_xor_b32 v4, 8, v4
    v_cvt_pk_bf16_f32 v65, v22, v23
    v_fma_f32 v20, v68, v68, s62
    v_fma_f32 v21, v69, v69, s62
    v_fma_f32 v22, v70, v70, s62
    v_mfma_f32_32x32x16_bf16 v[80:95], v[140:143], v[32:35], v[80:95]
    ds_read_b128 v[28:31], v6 offset:15360
    v_fma_f32 v23, v71, v71, s62
    v_mul_f32 v20, v20, v68
    v_mul_f32 v21, v21, v69
    v_mul_f32 v22, v22, v70
    s_waitcnt lgkmcnt(3)
    v_mfma_f32_32x32x16_bf16 v[80:95], v[144:147], v[36:39], v[80:95]
    ds_read_b128 v[32:35], v6 offset:16384
    v_mul_f32 v23, v23, v71
    v_exp_f32_e64 v20, -v20
    s_waitcnt lgkmcnt(3)
    v_mfma_f32_32x32x16_bf16 v[80:95], v[148:151], v[40:43], v[80:95]
    ds_read_b128 v[36:39], v6 offset:17408
    v_exp_f32_e64 v21, -v21
    v_exp_f32_e64 v22, -v22
    s_waitcnt lgkmcnt(3)
    v_mfma_f32_32x32x16_bf16 v[80:95], v[152:155], v[44:47], v[80:95]
    ds_read_b128 v[40:43], v6 offset:18432
    v_exp_f32_e64 v23, -v23
    v_fma_f32 v20, v20, s83, s83
    v_fma_f32 v21, v21, s83, s83
    s_waitcnt lgkmcnt(3)
    v_mfma_f32_32x32x16_bf16 v[80:95], v[156:159], v[28:31], v[80:95]
    ds_read_b128 v[44:47], v6 offset:19456
    v_fma_f32 v22, v22, s83, s83
    v_fma_f32 v23, v23, s83, s83
    v_rcp_f32 v20, v20
    s_waitcnt lgkmcnt(3)
    v_mfma_f32_32x32x16_bf16 v[80:95], v[160:163], v[32:35], v[80:95]
    ds_read_b128 v[28:31], v6 offset:20480
    v_rcp_f32 v21, v21
    v_rcp_f32 v22, v22
    s_waitcnt lgkmcnt(3)
    v_mfma_f32_32x32x16_bf16 v[80:95], v[164:167], v[36:39], v[80:95]
    ds_read_b128 v[32:35], v6 offset:21504
    v_rcp_f32 v23, v23
    v_mul_f32 v20, v20, v68
    v_mul_f32 v21, v21, v69
    s_waitcnt lgkmcnt(3)
    v_mfma_f32_32x32x16_bf16 v[80:95], v[168:171], v[40:43], v[80:95]
    ds_read_b128 v[36:39], v6 offset:22528
    v_mul_f32 v22, v22, v70
    v_mul_f32 v23, v23, v71
    v_cvt_pk_bf16_f32 v66, v20, v21
    v_cvt_pk_bf16_f32 v67, v22, v23
    s_waitcnt lgkmcnt(3)
    v_mfma_f32_32x32x16_bf16 v[80:95], v[172:175], v[44:47], v[80:95]
    ds_read_b128 v[40:43], v6 offset:23552
    v_bfi_b32 v64, s76, v17, v64
    v_fma_f32 v20, v72, v72, s62
    v_fma_f32 v21, v73, v73, s62
    v_fma_f32 v22, v74, v74, s62
    s_waitcnt lgkmcnt(3)
    v_mfma_f32_32x32x16_bf16 v[80:95], v[176:179], v[28:31], v[80:95]
    ds_read_b128 v[44:47], v6 offset:24576
    v_fma_f32 v23, v75, v75, s62
    v_mul_f32 v20, v20, v72
    v_mul_f32 v21, v21, v73
    v_mul_f32 v22, v22, v74
    s_waitcnt lgkmcnt(3)
    v_mfma_f32_32x32x16_bf16 v[80:95], v[180:183], v[32:35], v[80:95]
    ds_read_b128 v[28:31], v6 offset:25600
    v_mul_f32 v23, v23, v75
    v_exp_f32_e64 v20, -v20
    s_waitcnt lgkmcnt(3)
    v_mfma_f32_32x32x16_bf16 v[80:95], v[184:187], v[36:39], v[80:95]
    ds_read_b128 v[32:35], v6 offset:26624
    v_exp_f32_e64 v21, -v21
    v_exp_f32_e64 v22, -v22
    s_waitcnt lgkmcnt(3)
    v_mfma_f32_32x32x16_bf16 v[80:95], v[188:191], v[40:43], v[80:95]
    ds_read_b128 v[36:39], v6 offset:27648
    v_exp_f32_e64 v23, -v23
    v_fma_f32 v20, v20, s83, s83
    v_fma_f32 v21, v21, s83, s83
    s_waitcnt lgkmcnt(3)
    v_mfma_f32_32x32x16_bf16 v[80:95], v[192:195], v[44:47], v[80:95]
    ds_read_b128 v[40:43], v6 offset:28672
    v_fma_f32 v22, v22, s83, s83
    v_fma_f32 v23, v23, s83, s83
    v_rcp_f32 v20, v20
    s_waitcnt lgkmcnt(3)
    v_mfma_f32_32x32x16_bf16 v[80:95], v[196:199], v[28:31], v[80:95]
    ds_read_b128 v[44:47], v6 offset:29696
    v_rcp_f32 v21, v21
    v_rcp_f32 v22, v22
    s_waitcnt lgkmcnt(3)
    v_mfma_f32_32x32x16_bf16 v[80:95], v[200:203], v[32:35], v[80:95]
    ds_read_b128 v[28:31], v6 offset:30720
    v_rcp_f32 v23, v23
    v_mul_f32 v20, v20, v72
    v_mul_f32 v21, v21, v73
    s_waitcnt lgkmcnt(3)
    v_mfma_f32_32x32x16_bf16 v[80:95], v[204:207], v[36:39], v[80:95]
    ds_read_b128 v[32:35], v6 offset:31744
    v_mul_f32 v22, v22, v74
    v_mul_f32 v23, v23, v75
    v_cvt_pk_bf16_f32 v72, v20, v21
    v_cvt_pk_bf16_f32 v73, v22, v23
    s_waitcnt lgkmcnt(3)
    v_mfma_f32_32x32x16_bf16 v[80:95], v[208:211], v[40:43], v[80:95]
    ds_read_b128 v[36:39], v6 offset:32768
    v_fma_f32 v20, v76, v76, s62
    v_fma_f32 v21, v77, v77, s62
    v_fma_f32 v22, v78, v78, s62
    v_fma_f32 v23, v79, v79, s62
    s_waitcnt lgkmcnt(3)
    v_mfma_f32_32x32x16_bf16 v[80:95], v[212:215], v[44:47], v[80:95]
    ds_read_b128 v[40:43], v6 offset:33792
    v_mul_f32 v20, v20, v76
    v_mul_f32 v21, v21, v77
    v_mul_f32 v22, v22, v78
    v_mul_f32 v23, v23, v79
    s_waitcnt lgkmcnt(3)
    v_mfma_f32_32x32x16_bf16 v[80:95], v[216:219], v[28:31], v[80:95]
    ds_read_b128 v[44:47], v6 offset:34816
    v_exp_f32_e64 v20, -v20
    v_exp_f32_e64 v21, -v21
    s_waitcnt lgkmcnt(3)
    v_mfma_f32_32x32x16_bf16 v[80:95], v[220:223], v[32:35], v[80:95]
    ds_read_b128 v[28:31], v6 offset:35840
    v_exp_f32_e64 v22, -v22
    v_exp_f32_e64 v23, -v23
    s_waitcnt lgkmcnt(3)
    v_mfma_f32_32x32x16_bf16 v[80:95], v[224:227], v[36:39], v[80:95]
    ds_read_b128 v[32:35], v6 offset:36864
    v_fma_f32 v20, v20, s83, s83
    v_fma_f32 v21, v21, s83, s83
    v_fma_f32 v22, v22, s83, s83
    s_waitcnt lgkmcnt(3)
    v_mfma_f32_32x32x16_bf16 v[80:95], v[228:231], v[40:43], v[80:95]
    ds_read_b128 v[36:39], v6 offset:37888
    ds_read_b32 v16, v4 offset:128
    v_fma_f32 v23, v23, s83, s83
    v_rcp_f32 v20, v20
    v_rcp_f32 v21, v21
    s_waitcnt lgkmcnt(4)
    v_mfma_f32_32x32x16_bf16 v[80:95], v[232:235], v[44:47], v[80:95]
    ds_read_b128 v[40:43], v6 offset:38912
    v_rcp_f32 v22, v22
    s_waitcnt lgkmcnt(4)
    v_mfma_f32_32x32x16_bf16 v[80:95], v[236:239], v[28:31], v[80:95]
    ds_read_b128 v[44:47], v6 offset:39936
    v_rcp_f32 v23, v23
    v_mul_f32 v20, v20, v76
    v_mul_f32 v21, v21, v77
    v_mul_f32 v22, v22, v78
    s_waitcnt lgkmcnt(2)
    v_cmp_gt_u32 vcc, s84, v16
    v_add_u32 v6, s72, v2
    s_nop 0
    s_cbranch_vccnz G1_ST1
    v_mfma_f32_32x32x16_bf16 v[80:95], v[240:243], v[32:35], v[80:95]
    ds_read_b128 v[28:31], v6 offset:0
    v_mul_f32 v23, v23, v79
    v_cvt_pk_bf16_f32 v74, v20, v21
    v_cvt_pk_bf16_f32 v75, v22, v23
    v_bfi_b32 v72, s76, v17, v72
    v_mfma_f32_32x32x16_bf16 v[80:95], v[244:247], v[36:39], v[80:95]
    ds_read_b128 v[32:35], v6 offset:1024
    s_waitcnt vmcnt(0)
    v_cmp_ne_u32 vcc, v14, v12
    s_nop 1
    s_cbranch_vccnz FS_63
FR_65:
    s_cmp_lg_u32 s55, 0
    s_cbranch_scc1 BS_66
    buffer_store_dwordx4 v[64:67], v0, s[32:35], s74 offen offset:0
    buffer_store_dwordx4 v[72:75], v0, s[32:35], s74 offen offset:512
    buffer_store_dword v14, v11, s[32:35], s78 offen
BR_67:
    s_waitcnt lgkmcnt(3)
    v_mfma_f32_32x32x16_bf16 v[80:95], v[248:251], v[40:43], v[80:95]
    ds_read_b128 v[36:39], v6 offset:2048
    s_add_u32 s78, s78, 256
    s_bitcmp1_b32 0x4924, s81
    s_cselect_b32 s63, -229376, s79
    s_cselect_b32 s82, s76, 0
    s_add_u32 s74, s74, s63
    v_xor_b32 v17, s82, v17
    s_add_u32 s81, s81, 1
    s_waitcnt lgkmcnt(3)
    v_mfma_f32_32x32x16_bf16 v[64:79], v[252:255], v[44:47], v[80:95]
    ds_read_b128 v[40:43], v6 offset:3072
    v_add_u32 v15, 1, v15
    ds_write_b32 v5, v15 offset:160
    s_add_u32 s56, s56, 1
    s_cmp_eq_u32 s56, 15
    s_cbranch_scc1 G1_V2
    s_branch G1_V1
G1_V2:
    s_waitcnt lgkmcnt(4)
    v_mfma_f32_32x32x16_bf16 v[80:95], v[96:99], v[28:31], v[48:63]
    ds_read_b128 v[44:47], v6 offset:4096
    s_waitcnt lgkmcnt(4)
    v_mfma_f32_32x32x16_bf16 v[80:95], v[100:103], v[32:35], v[80:95]
    ds_read_b128 v[28:31], v6 offset:5120
    buffer_load_dword v12, v18, s[32:35], s78 offen sc1
    v_fma_f32 v20, v64, v64, s62
    v_fma_f32 v21, v65, v65, s62
    v_fma_f32 v22, v66, v66, s62
    v_fma_f32 v23, v67, v67, s62
    s_waitcnt lgkmcnt(4)
    v_mfma_f32_32x32x16_bf16 v[80:95], v[104:107], v[36:39], v[80:95]
    ds_read_b128 v[32:35], v6 offset:6144
    v_mul_f32 v20, v20, v64
    v_mul_f32 v21, v21, v65
    v_mul_f32 v22, v22, v66
    v_mul_f32 v23, v23, v67
    v_exp_f32_e64 v20, -v20
    s_waitcnt lgkmcnt(4)
    v_mfma_f32_32x32x16_bf16 v[80:95], v[108:111], v[40:43], v[80:95]
    ds_read_b128 v[36:39], v6 offset:7168
    v_exp_f32_e64 v21, -v21
    v_exp_f32_e64 v22, -v22
    v_exp_f32_e64 v23, -v23
    s_waitcnt lgkmcnt(3)
    v_mfma_f32_32x32x16_bf16 v[80:95], v[112:115], v[44:47], v[80:95]
    ds_read_b128 v[40:43], v6 offset:8192
    v_fma_f32 v20, v20, s83, s83
    v_fma_f32 v21, v21, s83, s83
    v_fma_f32 v22, v22, s83, s83
    v_fma_f32 v23, v23, s83, s83
    s_waitcnt lgkmcnt(3)
    v_mfma_f32_32x32x16_bf16 v[80:95], v[116:119], v[28:31], v[80:95]
    ds_read_b128 v[44:47], v6 offset:9216
    v_rcp_f32 v20, v20
    v_rcp_f32 v21, v21
    v_rcp_f32 v22, v22
    s_waitcnt lgkmcnt(3)
    v_mfma_f32_32x32x16_bf16 v[80:95], v[120:123], v[32:35], v[80:95]
    ds_read_b128 v[28:31], v6 offset:10240
    v_rcp_f32 v23, v23
    v_mul_f32 v20, v20, v64
    v_mul_f32 v21, v21, v65
    v_mul_f32 v22, v22, v66
    v_mul_f32 v23, v23, v67
    s_waitcnt lgkmcnt(3)
    v_mfma_f32_32x32x16_bf16 v[80:95], v[124:127], v[36:39], v[80:95]
    ds_read_b128 v[32:35], v6 offset:11264
    ds_read_b32 v16, v4 offset:128
    v_cvt_pk_bf16_f32 v64, v20, v21
    v_cvt_pk_bf16_f32 v65, v22, v23
    v_fma_f32 v20, v68, v68, s62
    v_fma_f32 v21, v69, v69, s62
    v_fma_f32 v22, v70, v70, s62
    v_fma_f32 v23, v71, v71, s62
    s_waitcnt lgkmcnt(4)
    v_mfma_f32_32x32x16_bf16 v[80:95], v[128:131], v[40:43], v[80:95]
    ds_read_b128 v[36:39], v6 offset:12288
    v_mul_f32 v20, v20, v68
    v_mul_f32 v21, v21, v69
    v_mul_f32 v22, v22, v70
    v_mul_f32 v23, v23, v71
    v_exp_f32_e64 v20, -v20
    s_waitcnt lgkmcnt(4)
    v_mfma_f32_32x32x16_bf16 v[80:95], v[132:135], v[44:47], v[80:95]
    ds_read_b128 v[40:43], v6 offset:13312
    v_exp_f32_e64 v21, -v21
    v_exp_f32_e64 v22, -v22
    v_exp_f32_e64 v23, -v23
    s_waitcnt lgkmcnt(4)
    v_mfma_f32_32x32x16_bf16 v[80:95], v[136:139], v[28:31], v[80:95]
    s_waitcnt lgkmcnt(2)
    v_cmp_gt_u32 vcc, s80, v16
    s_nop 1
    s_cbranch_vccnz G1_MS2
    ds_read_b128 v[44:47], v6 offset:14336
    s_cmp_eq_u32 s72, 90112
    s_cselect_b32 s63, -81920, s75
    s_add_u32 s72, s72, s63
    s_add_u32 s84, s80, 1
    s_add_u32 s80, s80, 2
    v_xor_b32 v4, 8, v4
    v_fma_f32 v20, v20, s83, s83
    v_fma_f32 v21, v21, s83, s83
    v_fma_f32 v22, v22, s83, s83
    v_fma_f32 v23, v23, s83, s83
    v_mfma_f32_32x32x16_bf16 v[80:95], v[140:143], v[32:35], v[80:95]
    ds_read_b128 v[28:31], v6 offset:15360
    v_rcp_f32 v20, v20
    v_rcp_f32 v21, v21
    v_rcp_f32 v22, v22
    s_waitcnt lgkmcnt(3)
    v_mfma_f32_32x32x16_bf16 v[80:95], v[144:147], v[36:39], v[80:95]
    ds_read_b128 v[32:35], v6 offset:16384
    v_rcp_f32 v23, v23
    v_mul_f32 v20, v20, v68
    v_mul_f32 v21, v21, v69
    v_mul_f32 v22, v22, v70
    v_mul_f32 v23, v23, v71
    s_waitcnt lgkmcnt(3)
    v_mfma_f32_32x32x16_bf16 v[80:95], v[148:151], v[40:43], v[80:95]
    ds_read_b128 v[36:39], v6 offset:17408
    v_cvt_pk_bf16_f32 v66, v20, v21
    v_cvt_pk_bf16_f32 v67, v22, v23
    v_bfi_b32 v64, s76, v17, v64
    v_fma_f32 v20, v72, v72, s62
    v_fma_f32 v21, v73, v73, s62
    v_fma_f32 v22, v74, v74, s62
    s_waitcnt lgkmcnt(3)
    v_mfma_f32_32x32x16_bf16 v[80:95], v[152:155], v[44:47], v[80:95]
    ds_read_b128 v[40:43], v6 offset:18432
    v_fma_f32 v23, v75, v75, s62
    v_mul_f32 v20, v20, v72
    v_mul_f32 v21, v21, v73
    v_mul_f32 v22, v22, v74
    v_mul_f32 v23, v23, v75
    s_waitcnt lgkmcnt(3)
    v_mfma_f32_32x32x16_bf16 v[80:95], v[156:159], v[28:31], v[80:95]
    ds_read_b128 v[44:47], v6 offset:19456
    v_exp_f32_e64 v20, -v20
    v_exp_f32_e64 v21, -v21
    v_exp_f32_e64 v22, -v22
    s_waitcnt lgkmcnt(3)
    v_mfma_f32_32x32x16_bf16 v[80:95], v[160:163], v[32:35], v[80:95]
    ds_read_b128 v[28:31], v6 offset:20480
    v_exp_f32_e64 v23, -v23
    v_fma_f32 v20, v20, s83, s83
    v_fma_f32 v21, v21, s83, s83
    v_fma_f32 v22, v22, s83, s83
    v_fma_f32 v23, v23, s83, s83
    s_waitcnt lgkmcnt(3)
    v_mfma_f32_32x32x16_bf16 v[80:95], v[164:167], v[36:39], v[80:95]
    ds_read_b128 v[32:35], v6 offset:21504
    v_rcp_f32 v20, v20
    v_rcp_f32 v21, v21
    v_rcp_f32 v22, v22
    s_waitcnt lgkmcnt(3)
    v_mfma_f32_32x32x16_bf16 v[80:95], v[168:171], v[40:43], v[80:95]
    ds_read_b128 v[36:39], v6 offset:22528
    v_rcp_f32 v23, v23
    v_mul_f32 v20, v20, v72
    v_mul_f32 v21, v21, v73
    v_mul_f32 v22, v22, v74
    s_waitcnt lgkmcnt(3)
    v_mfma_f32_32x32x16_bf16 v[80:95], v[172:175], v[44:47], v[80:95]
    ds_read_b128 v[40:43], v6 offset:23552
    v_mul_f32 v23, v23, v75
    v_cvt_pk_bf16_f32 v72, v20, v21
    v_cvt_pk_bf16_f32 v73, v22, v23
    v_fma_f32 v20, v76, v76, s62
    v_fma_f32 v21, v77, v77, s62
    v_fma_f32 v22, v78, v78, s62
    s_waitcnt lgkmcnt(3)
    v_mfma_f32_32x32x16_bf16 v[80:95], v[176:179], v[28:31], v[80:95]
    ds_read_b128 v[44:47], v6 offset:24576
    v_fma_f32 v23, v79, v79, s62
    v_mul_f32 v20, v20, v76
    v_mul_f32 v21, v21, v77
    v_mul_f32 v22, v22, v78
    v_mul_f32 v23, v23, v79
    s_waitcnt lgkmcnt(3)
    v_mfma_f32_32x32x16_bf16 v[80:95], v[180:183], v[32:35], v[80:95]
    ds_read_b128 v[28:31], v6 offset:25600
    v_exp_f32_e64 v20, -v20
    v_exp_f32_e64 v21, -v21
    v_exp_f32_e64 v22, -v22
    s_waitcnt lgkmcnt(3)
    v_mfma_f32_32x32x16_bf16 v[80:95], v[184:187], v[36:39], v[80:95]
    ds_read_b128 v[32:35], v6 offset:26624
    v_exp_f32_e64 v23, -v23
    v_fma_f32 v20, v20, s83, s83
    v_fma_f32 v21, v21, s83, s83
    v_fma_f32 v22, v22, s83, s83
    v_fma_f32 v23, v23, s83, s83
    s_waitcnt lgkmcnt(3)
    v_mfma_f32_32x32x16_bf16 v[80:95], v[188:191], v[40:43], v[80:95]
    ds_read_b128 v[36:39], v6 offset:27648
    v_rcp_f32 v20, v20
    v_rcp_f32 v21, v21
    v_rcp_f32 v22, v22
    s_waitcnt lgkmcnt(3)
    v_mfma_f32_32x32x16_bf16 v[80:95], v[192:195], v[44:47], v[80:95]
    ds_read_b128 v[40:43], v6 offset:28672
    v_rcp_f32 v23, v23
    v_mul_f32 v20, v20, v76
    v_mul_f32 v21, v21, v77
    v_mul_f32 v22, v22, v78
    s_waitcnt lgkmcnt(3)
    v_mfma_f32_32x32x16_bf16 v[80:95], v[196:199], v[28:31], v[80:95]
    ds_read_b128 v[44:47], v6 offset:29696
    v_mul_f32 v23, v23, v79
    v_cvt_pk_bf16_f32 v74, v20, v21
    v_cvt_pk_bf16_f32 v75, v22, v23
    v_bfi_b32 v72, s76, v17, v72
    s_waitcnt lgkmcnt(3)
    v_mfma_f32_32x32x16_bf16 v[80:95], v[200:203], v[32:35], v[80:95]
    ds_read_b128 v[28:31], v6 offset:30720
    s_waitcnt vmcnt(0)
    v_cmp_ne_u32 vcc, v14, v12
    s_nop 1
    s_cbranch_vccnz FS_68
FR_70:
    s_cmp_lg_u32 s55, 0
    s_cbranch_scc1 BS_71
    buffer_store_dwordx4 v[64:67], v0, s[32:35], s74 offen offset:0
    buffer_store_dwordx4 v[72:75], v0, s[32:35], s74 offen offset:512
    buffer_store_dword v14, v11, s[32:35], s78 offen
BR_72:
    s_add_u32 s78, s78, 256
    s_bitcmp1_b32 0x4924, s81
    s_cselect_b32 s63, -229376, s79
    s_cselect_b32 s82, s76, 0
    s_add_u32 s74, s74, s63
    v_xor_b32 v17, s82, v17
    s_add_u32 s81, s81, 1
    s_waitcnt lgkmcnt(3)
    v_mfma_f32_32x32x16_bf16 v[80:95], v[204:207], v[36:39], v[80:95]
    ds_read_b128 v[32:35], v6 offset:31744
    s_waitcnt lgkmcnt(3)
    v_mfma_f32_32x32x16_bf16 v[80:95], v[208:211], v[40:43], v[80:95]
    ds_read_b128 v[36:39], v6 offset:32768
    s_waitcnt lgkmcnt(3)
    v_mfma_f32_32x32x16_bf16 v[80:95], v[212:215], v[44:47], v[80:95]
    ds_read_b128 v[40:43], v6 offset:33792
    s_waitcnt lgkmcnt(3)
    v_mfma_f32_32x32x16_bf16 v[80:95], v[216:219], v[28:31], v[80:95]
    ds_read_b128 v[44:47], v6 offset:34816
    s_waitcnt lgkmcnt(3)
    v_mfma_f32_32x32x16_bf16 v[80:95], v[220:223], v[32:35], v[80:95]
    ds_read_b128 v[28:31], v6 offset:35840
    s_waitcnt lgkmcnt(3)
    v_mfma_f32_32x32x16_bf16 v[80:95], v[224:227], v[36:39], v[80:95]
    ds_read_b128 v[32:35], v6 offset:36864
    s_waitcnt lgkmcnt(3)
    v_mfma_f32_32x32x16_bf16 v[80:95], v[228:231], v[40:43], v[80:95]
    ds_read_b128 v[36:39], v6 offset:37888
    ds_read_b32 v16, v4 offset:128
    s_waitcnt lgkmcnt(4)
    v_mfma_f32_32x32x16_bf16 v[80:95], v[232:235], v[44:47], v[80:95]
    ds_read_b128 v[40:43], v6 offset:38912
    s_waitcnt lgkmcnt(4)
    v_mfma_f32_32x32x16_bf16 v[80:95], v[236:239], v[28:31], v[80:95]
    ds_read_b128 v[44:47], v6 offset:39936
    s_waitcnt lgkmcnt(2)
    v_cmp_gt_u32 vcc, s84, v16
    v_add_u32 v6, s72, v2
    s_branch G1_ST2
G1_END:
    s_endpgm
BS_44:
    buffer_store_dword v14, v10, s[32:35], s82 offen offset:0 sc1
    buffer_store_dword v14, v10, s[32:35], s82 offen offset:256 sc1
    buffer_store_dword v14, v10, s[32:35], s82 offen offset:512 sc1
    s_branch BR_45
FS_55:
    s_mov_b32 s58, 0
FL_56:
    buffer_load_dword v12, v18, s[32:35], s78 offen sc1
    s_add_u32 s58, s58, 1
    s_waitcnt vmcnt(0)
    v_cmp_ne_u32 vcc, v14, v12
    s_nop 1
    s_cbranch_vccz FR_57
    s_cmp_lt_u32 s58, s57
    s_cbranch_scc1 FL_56
    s_mov_b32 s57, 0
    s_branch FR_57
BS_58:
    buffer_store_dwordx4 v[64:67], v0, s[32:35], s74 offen offset:0 sc1
    buffer_store_dwordx4 v[72:75], v0, s[32:35], s74 offen offset:512 sc1
    buffer_store_dword v14, v11, s[32:35], s78 offen sc1
    s_branch BR_59
G1_MS0:
    s_mov_b32 s58, 0
SL_73:
    ds_read_b32 v16, v4 offset:128
    s_add_u32 s58, s58, 1
    s_waitcnt lgkmcnt(0)
    v_cmp_gt_u32 vcc, s80, v16
    s_nop 1
    s_cbranch_vccz G1_MR
    s_cmp_lt_u32 s58, 80000
    s_cbranch_scc1 SL_73
    s_branch G1_MR
G1_ST0:
    v_mfma_f32_32x32x16_bf16 v[80:95], v[240:243], v[32:35], v[80:95]
    v_mfma_f32_32x32x16_bf16 v[80:95], v[244:247], v[36:39], v[80:95]
    ds_read_b32 v16, v4 offset:128
    s_waitcnt lgkmcnt(2)
    v_mfma_f32_32x32x16_bf16 v[80:95], v[248:251], v[40:43], v[80:95]
    s_waitcnt lgkmcnt(1)
    v_mfma_f32_32x32x16_bf16 v[64:79], v[252:255], v[44:47], v[80:95]
    s_branch G1_SLOW
G1_MS1:
    v_cvt_pk_bf16_f32 v65, v22, v23
    v_fma_f32 v20, v68, v68, s62
    v_fma_f32 v21, v69, v69, s62
    v_fma_f32 v22, v70, v70, s62
    v_fma_f32 v23, v71, v71, s62
    v_mul_f32 v20, v20, v68
    v_mul_f32 v21, v21, v69
    v_mul_f32 v22, v22, v70
    v_mul_f32 v23, v23, v71
    v_exp_f32_e64 v20, -v20
    v_exp_f32_e64 v21, -v21
    v_exp_f32_e64 v22, -v22
    v_exp_f32_e64 v23, -v23
    v_fma_f32 v20, v20, s83, s83
    v_fma_f32 v21, v21, s83, s83
    v_fma_f32 v22, v22, s83, s83
    v_fma_f32 v23, v23, s83, s83
    v_rcp_f32 v20, v20
    v_rcp_f32 v21, v21
    v_rcp_f32 v22, v22
    v_rcp_f32 v23, v23
    v_mul_f32 v20, v20, v68
    v_mul_f32 v21, v21, v69
    v_mul_f32 v22, v22, v70
    v_mul_f32 v23, v23, v71
    v_cvt_pk_bf16_f32 v66, v20, v21
    v_cvt_pk_bf16_f32 v67, v22, v23
    v_bfi_b32 v64, s76, v17, v64
    v_fma_f32 v20, v72, v72, s62
    v_fma_f32 v21, v73, v73, s62
    v_fma_f32 v22, v74, v74, s62
    v_fma_f32 v23, v75, v75, s62
    v_mul_f32 v20, v20, v72
    v_mul_f32 v21, v21, v73
    v_mul_f32 v22, v22, v74
    v_mul_f32 v23, v23, v75
    v_exp_f32_e64 v20, -v20
    v_exp_f32_e64 v21, -v21
    v_exp_f32_e64 v22, -v22
    v_exp_f32_e64 v23, -v23
    v_fma_f32 v20, v20, s83, s83
    v_fma_f32 v21, v21, s83, s83
    v_fma_f32 v22, v22, s83, s83
    v_fma_f32 v23, v23, s83, s83
    v_rcp_f32 v20, v20
    v_rcp_f32 v21, v21
    v_rcp_f32 v22, v22
    v_rcp_f32 v23, v23
    v_mul_f32 v20, v20, v72
    v_mul_f32 v21, v21, v73
    v_mul_f32 v22, v22, v74
    v_mul_f32 v23, v23, v75
    v_cvt_pk_bf16_f32 v72, v20, v21
    v_cvt_pk_bf16_f32 v73, v22, v23
    v_fma_f32 v20, v76, v76, s62
    v_fma_f32 v21, v77, v77, s62
    v_fma_f32 v22, v78, v78, s62
    v_fma_f32 v23, v79, v79, s62
    v_mul_f32 v20, v20, v76
    v_mul_f32 v21, v21, v77
    v_mul_f32 v22, v22, v78
    v_mul_f32 v23, v23, v79
    v_exp_f32_e64 v20, -v20
    v_exp_f32_e64 v21, -v21
    v_exp_f32_e64 v22, -v22
    v_exp_f32_e64 v23, -v23
    v_fma_f32 v20, v20, s83, s83
    v_fma_f32 v21, v21, s83, s83
    v_fma_f32 v22, v22, s83, s83
    v_fma_f32 v23, v23, s83, s83
    v_rcp_f32 v20, v20
    v_rcp_f32 v21, v21
    v_rcp_f32 v22, v22
    v_rcp_f32 v23, v23
    v_mul_f32 v20, v20, v76
    v_mul_f32 v21, v21, v77
    v_mul_f32 v22, v22, v78
    v_mul_f32 v23, v23, v79
    v_cvt_pk_bf16_f32 v74, v20, v21
    v_cvt_pk_bf16_f32 v75, v22, v23
    v_bfi_b32 v72, s76, v17, v72
    s_waitcnt vmcnt(0)
    v_cmp_ne_u32 vcc, v14, v12
    s_nop 1
    s_cbranch_vccnz FS_76
FR_78:
    s_cmp_lg_u32 s55, 0
    s_cbranch_scc1 BS_79
    buffer_store_dwordx4 v[64:67], v0, s[32:35], s74 offen offset:0
    buffer_store_dwordx4 v[72:75], v0, s[32:35], s74 offen offset:512
    buffer_store_dword v14, v11, s[32:35], s78 offen
BR_80:
    s_add_u32 s78, s78, 256
    s_bitcmp1_b32 0x4924, s81
    s_cselect_b32 s63, -229376, s79
    s_cselect_b32 s82, s76, 0
    s_add_u32 s74, s74, s63
    v_xor_b32 v17, s82, v17
    s_add_u32 s81, s81, 1
    s_mov_b32 s58, 0
SL_81:
    ds_read_b32 v16, v4 offset:128
    s_add_u32 s58, s58, 1
    s_waitcnt lgkmcnt(0)
    v_cmp_gt_u32 vcc, s80, v16
    s_nop 1
    s_cbranch_vccz G1_MR
    s_cmp_lt_u32 s58, 80000
    s_cbranch_scc1 SL_81
    s_branch G1_MR
G1_ST1:
    v_mfma_f32_32x32x16_bf16 v[80:95], v[240:243], v[32:35], v[80:95]
    v_mul_f32 v23, v23, v79
    v_cvt_pk_bf16_f32 v74, v20, v21
    v_cvt_pk_bf16_f32 v75, v22, v23
    v_bfi_b32 v72, s76, v17, v72
    v_mfma_f32_32x32x16_bf16 v[80:95], v[244:247], v[36:39], v[80:95]
    ds_read_b32 v16, v4 offset:128
    s_waitcnt vmcnt(0)
    v_cmp_ne_u32 vcc, v14, v12
    s_nop 1
    s_cbranch_vccnz FS_84
FR_86:
    s_cmp_lg_u32 s55, 0
    s_cbranch_scc1 BS_87
    buffer_store_dwordx4 v[64:67], v0, s[32:35], s74 offen offset:0
    buffer_store_dwordx4 v[72:75], v0, s[32:35], s74 offen offset:512
    buffer_store_dword v14, v11, s[32:35], s78 offen
BR_88:
    s_add_u32 s78, s78, 256
    s_bitcmp1_b32 0x4924, s81
    s_cselect_b32 s63, -229376, s79
    s_cselect_b32 s82, s76, 0
    s_waitcnt lgkmcnt(2)
    v_mfma_f32_32x32x16_bf16 v[80:95], v[248:251], v[40:43], v[80:95]
    s_add_u32 s74, s74, s63
    v_xor_b32 v17, s82, v17
    s_add_u32 s81, s81, 1
    s_waitcnt lgkmcnt(1)
    v_mfma_f32_32x32x16_bf16 v[64:79], v[252:255], v[44:47], v[80:95]
    s_branch G1_SLOW
FS_63:
    s_mov_b32 s58, 0
FL_64:
    buffer_load_dword v12, v18, s[32:35], s78 offen sc1
    s_add_u32 s58, s58, 1
    s_waitcnt vmcnt(0)
    v_cmp_ne_u32 vcc, v14, v12
    s_nop 1
    s_cbranch_vccz FR_65
    s_cmp_lt_u32 s58, s57
    s_cbranch_scc1 FL_64
    s_mov_b32 s57, 0
    s_branch FR_65
BS_66:
    buffer_store_dwordx4 v[64:67], v0, s[32:35], s74 offen offset:0 sc1
    buffer_store_dwordx4 v[72:75], v0, s[32:35], s74 offen offset:512 sc1
    buffer_store_dword v14, v11, s[32:35], s78 offen sc1
    s_branch BR_67
G1_MS2:
    v_fma_f32 v20, v20, s83, s83
    v_fma_f32 v21, v21, s83, s83
    v_fma_f32 v22, v22, s83, s83
    v_fma_f32 v23, v23, s83, s83
    v_rcp_f32 v20, v20
    v_rcp_f32 v21, v21
    v_rcp_f32 v22, v22
    v_rcp_f32 v23, v23
    v_mul_f32 v20, v20, v68
    v_mul_f32 v21, v21, v69
    v_mul_f32 v22, v22, v70
    v_mul_f32 v23, v23, v71
    v_cvt_pk_bf16_f32 v66, v20, v21
    v_cvt_pk_bf16_f32 v67, v22, v23
    v_bfi_b32 v64, s76, v17, v64
    v_fma_f32 v20, v72, v72, s62
    v_fma_f32 v21, v73, v73, s62
    v_fma_f32 v22, v74, v74, s62
    v_fma_f32 v23, v75, v75, s62
    v_mul_f32 v20, v20, v72
    v_mul_f32 v21, v21, v73
    v_mul_f32 v22, v22, v74
    v_mul_f32 v23, v23, v75
    v_exp_f32_e64 v20, -v20
    v_exp_f32_e64 v21, -v21
    v_exp_f32_e64 v22, -v22
    v_exp_f32_e64 v23, -v23
    v_fma_f32 v20, v20, s83, s83
    v_fma_f32 v21, v21, s83, s83
    v_fma_f32 v22, v22, s83, s83
    v_fma_f32 v23, v23, s83, s83
    v_rcp_f32 v20, v20
    v_rcp_f32 v21, v21
    v_rcp_f32 v22, v22
    v_rcp_f32 v23, v23
    v_mul_f32 v20, v20, v72
    v_mul_f32 v21, v21, v73
    v_mul_f32 v22, v22, v74
    v_mul_f32 v23, v23, v75
    v_cvt_pk_bf16_f32 v72, v20, v21
    v_cvt_pk_bf16_f32 v73, v22, v23
    v_fma_f32 v20, v76, v76, s62
    v_fma_f32 v21, v77, v77, s62
    v_fma_f32 v22, v78, v78, s62
    v_fma_f32 v23, v79, v79, s62
    v_mul_f32 v20, v20, v76
    v_mul_f32 v21, v21, v77
    v_mul_f32 v22, v22, v78
    v_mul_f32 v23, v23, v79
    v_exp_f32_e64 v20, -v20
    v_exp_f32_e64 v21, -v21
    v_exp_f32_e64 v22, -v22
    v_exp_f32_e64 v23, -v23
    v_fma_f32 v20, v20, s83, s83
    v_fma_f32 v21, v21, s83, s83
    v_fma_f32 v22, v22, s83, s83
    v_fma_f32 v23, v23, s83, s83
    v_rcp_f32 v20, v20
    v_rcp_f32 v21, v21
    v_rcp_f32 v22, v22
    v_rcp_f32 v23, v23
    v_mul_f32 v20, v20, v76
    v_mul_f32 v21, v21, v77
    v_mul_f32 v22, v22, v78
    v_mul_f32 v23, v23, v79
    v_cvt_pk_bf16_f32 v74, v20, v21
    v_cvt_pk_bf16_f32 v75, v22, v23
    v_bfi_b32 v72, s76, v17, v72
    s_waitcnt vmcnt(0)
    v_cmp_ne_u32 vcc, v14, v12
    s_nop 1
    s_cbranch_vccnz FS_89
FR_91:
    s_cmp_lg_u32 s55, 0
    s_cbranch_scc1 BS_92
    buffer_store_dwordx4 v[64:67], v0, s[32:35], s74 offen offset:0
    buffer_store_dwordx4 v[72:75], v0, s[32:35], s74 offen offset:512
    buffer_store_dword v14, v11, s[32:35], s78 offen
BR_93:
    s_add_u32 s78, s78, 256
    s_bitcmp1_b32 0x4924, s81
    s_cselect_b32 s63, -229376, s79
    s_cselect_b32 s82, s76, 0
    s_add_u32 s74, s74, s63
    v_xor_b32 v17, s82, v17
    s_add_u32 s81, s81, 1
    s_mov_b32 s58, 0
SL_94:
    ds_read_b32 v16, v4 offset:128
    s_add_u32 s58, s58, 1
    s_waitcnt lgkmcnt(0)
    v_cmp_gt_u32 vcc, s80, v16
    s_nop 1
    s_cbranch_vccz G1_MR
    s_cmp_lt_u32 s58, 80000
    s_cbranch_scc1 SL_94
    s_branch G1_MR
FS_68:
    s_mov_b32 s58, 0
FL_69:
    buffer_load_dword v12, v18, s[32:35], s78 offen sc1
    s_add_u32 s58, s58, 1
    s_waitcnt vmcnt(0)
    v_cmp_ne_u32 vcc, v14, v12
    s_nop 1
    s_cbranch_vccz FR_70
    s_cmp_lt_u32 s58, s57
    s_cbranch_scc1 FL_69
    s_mov_b32 s57, 0
    s_branch FR_70
BS_71:
    buffer_store_dwordx4 v[64:67], v0, s[32:35], s74 offen offset:0 sc1
    buffer_store_dwordx4 v[72:75], v0, s[32:35], s74 offen offset:512 sc1
    buffer_store_dword v14, v11, s[32:35], s78 offen sc1
    s_branch BR_72
G1_ST2:
    v_mfma_f32_32x32x16_bf16 v[80:95], v[240:243], v[32:35], v[80:95]
    v_mfma_f32_32x32x16_bf16 v[80:95], v[244:247], v[36:39], v[80:95]
    ds_read_b32 v16, v4 offset:128
    s_waitcnt lgkmcnt(2)
    v_mfma_f32_32x32x16_bf16 v[80:95], v[248:251], v[40:43], v[80:95]
    s_waitcnt lgkmcnt(1)
    v_mfma_f32_32x32x16_bf16 v[64:79], v[252:255], v[44:47], v[80:95]
    s_branch G1_SLOW
FS_76:
    s_mov_b32 s58, 0
FL_77:
    buffer_load_dword v12, v18, s[32:35], s78 offen sc1
    s_add_u32 s58, s58, 1
    s_waitcnt vmcnt(0)
    v_cmp_ne_u32 vcc, v14, v12
    s_nop 1
    s_cbranch_vccz FR_78
    s_cmp_lt_u32 s58, s57
    s_cbranch_scc1 FL_77
    s_mov_b32 s57, 0
    s_branch FR_78
BS_79:
    buffer_store_dwordx4 v[64:67], v0, s[32:35], s74 offen offset:0 sc1
    buffer_store_dwordx4 v[72:75], v0, s[32:35], s74 offen offset:512 sc1
    buffer_store_dword v14, v11, s[32:35], s78 offen sc1
    s_branch BR_80
FS_84:
    s_mov_b32 s58, 0
FL_85:
    buffer_load_dword v12, v18, s[32:35], s78 offen sc1
    s_add_u32 s58, s58, 1
    s_waitcnt vmcnt(0)
    v_cmp_ne_u32 vcc, v14, v12
    s_nop 1
    s_cbranch_vccz FR_86
    s_cmp_lt_u32 s58, s57
    s_cbranch_scc1 FL_85
    s_mov_b32 s57, 0
    s_branch FR_86
BS_87:
    buffer_store_dwordx4 v[64:67], v0, s[32:35], s74 offen offset:0 sc1
    buffer_store_dwordx4 v[72:75], v0, s[32:35], s74 offen offset:512 sc1
    buffer_store_dword v14, v11, s[32:35], s78 offen sc1
    s_branch BR_88
FS_89:
    s_mov_b32 s58, 0
FL_90:
    buffer_load_dword v12, v18, s[32:35], s78 offen sc1
    s_add_u32 s58, s58, 1
    s_waitcnt vmcnt(0)
    v_cmp_ne_u32 vcc, v14, v12
    s_nop 1
    s_cbranch_vccz FR_91
    s_cmp_lt_u32 s58, s57
    s_cbranch_scc1 FL_90
    s_mov_b32 s57, 0
    s_branch FR_91
BS_92:
    buffer_store_dwordx4 v[64:67], v0, s[32:35], s74 offen offset:0 sc1
    buffer_store_dwordx4 v[72:75], v0, s[32:35], s74 offen offset:512 sc1
    buffer_store_dword v14, v11, s[32:35], s78 offen sc1
    s_branch BR_93
G1_HI:
    s_and_b32 s85, s29, 1
    s_lshl_b32 s72, s85, 10
    s_lshl_b32 s85, s85, 1
    s_lshr_b32 s56, s31, 1
    s_xor_b32 s56, s56, 1
    s_cmp_eq_u32 s55, 0
    s_cselect_b32 s63, 835584, 0
    s_cselect_b32 s74, 0, 344064
    s_add_u32 s63, s63, s74
    s_mul_i32 s74, s28, s63
    s_cmp_eq_u32 s55, 0
    s_cselect_b32 s63, 0, 8388608
    s_add_u32 s74, s74, s63
    s_lshl_b32 s68, s30, 2
    s_add_u32 s68, s68, s85
    s_lshl_b32 s63, s68, 11
    s_add_u32 s74, s74, s63
    s_add_u32 s74, s74, 0x1400000
    s_lshl_b32 s78, s28, 13
    s_lshl_b32 s63, s68, 2
    s_add_u32 s78, s78, s63
    s_add_u32 s78, s78, 65536
    s_mov_b32 s79, 114688
    v_lshrrev_b32 v16, 5, v1
    v_and_b32 v17, 31, v1
    v_lshlrev_b32 v17, 4, v17
    v_lshl_add_u32 v0, v16, 10, v17
    v_and_b32 v4, 12, v3
    v_add_u32 v4, 163328, v4
    s_and_b32 s66, s29, 3
    s_lshl_b32 s66, s66, 2
    s_add_u32 s66, s66, 163328
    v_mov_b32 v5, s66
    v_xor_b32 v5, 8, v5
    s_cmp_eq_u32 s56, 0
    s_cselect_b32 s63, -96, 0
    v_add_u32 v59, s63, v4
    s_lshl_b32 s64, s28, 3
    s_add_u32 s64, s64, s56
    s_mul_i32 s64, s64, 40960
    s_add_u32 s64, s64, s72
    s_mul_i32 s65, s56, 40960
    s_add_u32 s72, s72, 8192
    s_add_u32 s65, s65, 40960
    s_add_u32 s65, s65, s72
    s_mul_i32 s63, s56, 114688
    s_add_u32 s74, s74, s63
    s_add_u32 s64, s64, 0x1000000
    s_lshl_b32 s73, s28, 10
    s_add_u32 s73, s73, 49152
    v_mov_b32 v12, v3
    s_mov_b64 s[94:95], -1
    s_mov_b32 s75, 81920
    s_mov_b32 s79, 229376
    s_mov_b32 s70, -40960
    s_mov_b32 s77, 0x10000
    v_mov_b32 v20, 0x10001
    v_mov_b32 v21, 0x10001
    v_mov_b32 v22, 0x10001
    v_mov_b32 v23, 0x10001
    v_lshlrev_b32 v8, 7, v1
    s_cmp_eq_u32 s55, 0
    s_cselect_b32 s63, 0, 0
    v_cmp_gt_u32 vcc, s63, v1
    v_mov_b32 v10, 0x10000000
    s_nop 0
    v_cndmask_b32 v8, v10, v8, vcc
    s_lshl_b32 s63, s56, 1
    v_add_u32 v15, -2, s63
    s_mov_b32 s80, 1
    s_setprio 0
    v_add_u32 v15, 3, v15
    v_add_u32 v18, s65, v2
G1_HS:
    s_mov_b32 s58, 0
    s_and_b32 s98, s56, 7
    s_lshl_b32 s98, s98, 3
    s_lshr_b64 s[96:97], s[94:95], s98
    s_and_b32 s63, s96, 0xff
    s_cbranch_scc0 G1_HL
G1_HP:
    buffer_load_dword v13, v12, s[32:35], s73 offen sc1
    ds_read_b32 v16, v59 offset:160
    s_add_u32 s58, s58, 1
    s_waitcnt lgkmcnt(0)
    v_cmp_gt_u32 s[82:83], s80, v16
    s_waitcnt vmcnt(0)
    v_cmp_ne_u32 vcc, s53, v13
    s_nop 1
    s_mov_b64 s[94:95], vcc
    s_lshr_b64 s[96:97], s[94:95], s98
    s_and_b32 s63, s96, 0xff
    s_cbranch_scc1 G1_HN
G1_HQ:
    s_cmp_eq_u64 s[82:83], 0
    s_cbranch_scc1 G1_HG
G1_HL:
    s_mov_b32 s58, 0
SL_97:
    ds_read_b32 v16, v59 offset:160
    s_add_u32 s58, s58, 1
    s_waitcnt lgkmcnt(0)
    v_cmp_gt_u32 vcc, s80, v16
    s_nop 1
    s_cbranch_vccz SD_99
    s_cmp_lt_u32 s58, 80000
    s_cbranch_scc1 SL_97
SD_99:
G1_HG:
    s_mov_b32 m0, s65
    s_mov_b32 s84, s64
    buffer_load_dwordx4 v2, s[32:35], s84 offen offset:0 sc1 lds
    buffer_load_dwordx4 v2, s[32:35], s84 offen offset:2048 sc1 lds
    s_add_u32 m0, m0, 4096
    s_add_u32 s84, s84, 4096
    buffer_load_dwordx4 v2, s[32:35], s84 offen offset:0 sc1 lds
    buffer_load_dwordx4 v2, s[32:35], s84 offen offset:2048 sc1 lds
    s_add_u32 m0, m0, 4096
    s_add_u32 s84, s84, 4096
    buffer_load_dwordx4 v2, s[32:35], s84 offen offset:0 sc1 lds
    buffer_load_dwordx4 v2, s[32:35], s84 offen offset:2048 sc1 lds
    s_add_u32 m0, m0, 4096
    s_add_u32 s84, s84, 4096
    buffer_load_dwordx4 v2, s[32:35], s84 offen offset:0 sc1 lds
    buffer_load_dwordx4 v2, s[32:35], s84 offen offset:2048 sc1 lds
    s_add_u32 m0, m0, 4096
    s_add_u32 s84, s84, 4096
    buffer_load_dwordx4 v2, s[32:35], s84 offen offset:0 sc1 lds
    buffer_load_dwordx4 v2, s[32:35], s84 offen offset:2048 sc1 lds
    s_add_u32 m0, m0, 4096
    s_add_u32 s84, s84, 4096
    buffer_load_dwordx4 v2, s[32:35], s84 offen offset:0 sc1 lds
    buffer_load_dwordx4 v2, s[32:35], s84 offen offset:2048 sc1 lds
    s_add_u32 m0, m0, 4096
    s_add_u32 s84, s84, 4096
    buffer_load_dwordx4 v2, s[32:35], s84 offen offset:0 sc1 lds
    buffer_load_dwordx4 v2, s[32:35], s84 offen offset:2048 sc1 lds
    s_add_u32 m0, m0, 4096
    s_add_u32 s84, s84, 4096
    buffer_load_dwordx4 v2, s[32:35], s84 offen offset:0 sc1 lds
    buffer_load_dwordx4 v2, s[32:35], s84 offen offset:2048 sc1 lds
    s_add_u32 m0, m0, 4096
    s_add_u32 s84, s84, 4096
    buffer_load_dwordx4 v2, s[32:35], s84 offen offset:0 sc1 lds
    buffer_load_dwordx4 v2, s[32:35], s84 offen offset:2048 sc1 lds
    s_add_u32 m0, m0, 4096
    s_add_u32 s84, s84, 4096
    buffer_load_dwordx4 v2, s[32:35], s84 offen offset:0 sc1 lds
    buffer_load_dwordx4 v2, s[32:35], s84 offen offset:2048 sc1 lds
    s_mov_b32 s58, 0
    s_waitcnt vmcnt(13)
G1_HCA:
    ds_read_b64 v[24:25], v18 offset:0
    ds_read_b64 v[26:27], v18 offset:2048
    ds_read_b64 v[28:29], v18 offset:4096
    ds_read_b64 v[30:31], v18 offset:6144
    ds_read_b64 v[32:33], v18 offset:8192
    ds_read_b64 v[34:35], v18 offset:10240
    ds_read_b64 v[36:37], v18 offset:12288
    s_waitcnt lgkmcnt(4)
    v_or3_b32 v24, v24, v26, v28
    s_waitcnt lgkmcnt(2)
    v_or3_b32 v24, v24, v30, v32
    s_waitcnt lgkmcnt(0)
    v_or3_b32 v24, v24, v34, v36
    v_and_b32 v24, s77, v24
    v_cmp_ne_u32 vcc, 0, v24
    s_nop 1
    s_cbranch_vccnz G1_HRA
G1_HDA:
    ds_write_b32 v5, v15 offset:128
    s_cmp_ge_u32 s56, 3
    s_cbranch_scc1 G1_HW
    s_nop 0
    s_cmp_lg_u32 s55, 0
    s_cbranch_scc1 BS_100
    buffer_store_dwordx4 v[20:23], v2, s[32:35], s74 offen offset:0
    buffer_store_dwordx4 v[20:23], v2, s[32:35], s74 offen offset:1024
    buffer_store_dwordx4 v[20:23], v2, s[32:35], s74 offen offset:2048
    buffer_store_dwordx4 v[20:23], v2, s[32:35], s74 offen offset:3072
BR_101:
    s_add_u32 s74, s74, s79
G1_HW:
    v_add_u32 v15, 1, v15
    s_waitcnt vmcnt(0)
G1_HCB:
    ds_read_b64 v[24:25], v18 offset:14336
    ds_read_b64 v[26:27], v18 offset:16384
    ds_read_b64 v[28:29], v18 offset:18432
    ds_read_b64 v[30:31], v18 offset:20480
    ds_read_b64 v[32:33], v18 offset:22528
    ds_read_b64 v[34:35], v18 offset:24576
    ds_read_b64 v[36:37], v18 offset:26624
    ds_read_b64 v[38:39], v18 offset:28672
    ds_read_b64 v[40:41], v18 offset:30720
    ds_read_b64 v[42:43], v18 offset:32768
    ds_read_b64 v[44:45], v18 offset:34816
    ds_read_b64 v[46:47], v18 offset:36864
    ds_read_b64 v[48:49], v18 offset:38912
    s_waitcnt lgkmcnt(10)
    v_or3_b32 v24, v24, v26, v28
    s_waitcnt lgkmcnt(8)
    v_or3_b32 v24, v24, v30, v32
    s_waitcnt lgkmcnt(6)
    v_or3_b32 v24, v24, v34, v36
    s_waitcnt lgkmcnt(4)
    v_or3_b32 v24, v24, v38, v40
    s_waitcnt lgkmcnt(2)
    v_or3_b32 v24, v24, v42, v44
    s_waitcnt lgkmcnt(0)
    v_or3_b32 v24, v24, v46, v48
    v_and_b32 v24, s77, v24
    v_cmp_ne_u32 vcc, 0, v24
    s_nop 1
    s_cbranch_vccnz G1_HRB
G1_HDB:
    ds_write_b32 v5, v15 offset:128
    v_mov_b32 v59, v4
    s_add_u32 s80, s56, 1
    s_or_b32 s63, s56, 1
    s_cmp_eq_u32 s63, 7
    s_cselect_b32 s63, -245760, s75
    s_cselect_b32 s77, 1, s77
    s_cselect_b32 s96, 256, 0
    s_cselect_b64 s[94:95], -1, s[94:95]
    s_add_u32 s73, s73, s96
    s_add_u32 s64, s64, s63
    s_cmp_eq_u32 s65, s72
    s_cselect_b32 s63, 81920, s70
    s_add_u32 s65, s65, s63
    s_add_u32 s56, s56, 2
    v_add_u32 v15, 3, v15
    v_add_u32 v18, s65, v2
    s_cmp_lt_u32 s56, 16
    s_cbranch_scc1 G1_HS
    s_endpgm
G1_HN:
    s_cmp_lt_u32 s58, s57
    s_cbranch_scc1 G1_HP
    s_mov_b32 s57, 0
    s_branch G1_HG
G1_HRA:
    s_add_u32 s58, s58, 1
    s_cmp_ge_u32 s58, s57
    s_cbranch_scc1 G1_HDA
    s_mov_b32 m0, s65
    s_mov_b32 s84, s64
    buffer_load_dwordx4 v2, s[32:35], s84 offen offset:0 sc1 lds
    buffer_load_dwordx4 v2, s[32:35], s84 offen offset:2048 sc1 lds
    s_add_u32 m0, m0, 4096
    s_add_u32 s84, s84, 4096
    buffer_load_dwordx4 v2, s[32:35], s84 offen offset:0 sc1 lds
    buffer_load_dwordx4 v2, s[32:35], s84 offen offset:2048 sc1 lds
    s_add_u32 m0, m0, 4096
    s_add_u32 s84, s84, 4096
    buffer_load_dwordx4 v2, s[32:35], s84 offen offset:0 sc1 lds
    buffer_load_dwordx4 v2, s[32:35], s84 offen offset:2048 sc1 lds
    s_add_u32 m0, m0, 4096
    s_add_u32 s84, s84, 4096
    buffer_load_dwordx4 v2, s[32:35], s84 offen offset:0 sc1 lds
    buffer_load_dwordx4 v2, s[32:35], s84 offen offset:2048 sc1 lds
    s_add_u32 m0, m0, 4096
    s_add_u32 s84, s84, 4096
    buffer_load_dwordx4 v2, s[32:35], s84 offen offset:0 sc1 lds
    buffer_load_dwordx4 v2, s[32:35], s84 offen offset:2048 sc1 lds
    s_add_u32 m0, m0, 4096
    s_add_u32 s84, s84, 4096
    buffer_load_dwordx4 v2, s[32:35], s84 offen offset:0 sc1 lds
    buffer_load_dwordx4 v2, s[32:35], s84 offen offset:2048 sc1 lds
    s_add_u32 m0, m0, 4096
    s_add_u32 s84, s84, 4096
    buffer_load_dwordx4 v2, s[32:35], s84 offen offset:0 sc1 lds
    buffer_load_dwordx4 v2, s[32:35], s84 offen offset:2048 sc1 lds
    s_add_u32 m0, m0, 4096
    s_add_u32 s84, s84, 4096
    buffer_load_dwordx4 v2, s[32:35], s84 offen offset:0 sc1 lds
    buffer_load_dwordx4 v2, s[32:35], s84 offen offset:2048 sc1 lds
    s_add_u32 m0, m0, 4096
    s_add_u32 s84, s84, 4096
    buffer_load_dwordx4 v2, s[32:35], s84 offen offset:0 sc1 lds
    buffer_load_dwordx4 v2, s[32:35], s84 offen offset:2048 sc1 lds
    s_add_u32 m0, m0, 4096
    s_add_u32 s84, s84, 4096
    buffer_load_dwordx4 v2, s[32:35], s84 offen offset:0 sc1 lds
    buffer_load_dwordx4 v2, s[32:35], s84 offen offset:2048 sc1 lds
    s_waitcnt vmcnt(0)
    s_branch G1_HCA
BS_100:
    buffer_store_dwordx4 v[20:23], v2, s[32:35], s74 offen offset:0 sc1
    buffer_store_dwordx4 v[20:23], v2, s[32:35], s74 offen offset:1024 sc1
    buffer_store_dwordx4 v[20:23], v2, s[32:35], s74 offen offset:2048 sc1
    buffer_store_dwordx4 v[20:23], v2, s[32:35], s74 offen offset:3072 sc1
    s_branch BR_101
G1_HRB:
    s_add_u32 s58, s58, 1
    s_cmp_ge_u32 s58, s57
    s_cbranch_scc1 G1_HDB
    s_mov_b32 m0, s65
    s_mov_b32 s84, s64
    buffer_load_dwordx4 v2, s[32:35], s84 offen offset:0 sc1 lds
    buffer_load_dwordx4 v2, s[32:35], s84 offen offset:2048 sc1 lds
    s_add_u32 m0, m0, 4096
    s_add_u32 s84, s84, 4096
    buffer_load_dwordx4 v2, s[32:35], s84 offen offset:0 sc1 lds
    buffer_load_dwordx4 v2, s[32:35], s84 offen offset:2048 sc1 lds
    s_add_u32 m0, m0, 4096
    s_add_u32 s84, s84, 4096
    buffer_load_dwordx4 v2, s[32:35], s84 offen offset:0 sc1 lds
    buffer_load_dwordx4 v2, s[32:35], s84 offen offset:2048 sc1 lds
    s_add_u32 m0, m0, 4096
    s_add_u32 s84, s84, 4096
    buffer_load_dwordx4 v2, s[32:35], s84 offen offset:0 sc1 lds
    buffer_load_dwordx4 v2, s[32:35], s84 offen offset:2048 sc1 lds
    s_add_u32 m0, m0, 4096
    s_add_u32 s84, s84, 4096
    buffer_load_dwordx4 v2, s[32:35], s84 offen offset:0 sc1 lds
    buffer_load_dwordx4 v2, s[32:35], s84 offen offset:2048 sc1 lds
    s_add_u32 m0, m0, 4096
    s_add_u32 s84, s84, 4096
    buffer_load_dwordx4 v2, s[32:35], s84 offen offset:0 sc1 lds
    buffer_load_dwordx4 v2, s[32:35], s84 offen offset:2048 sc1 lds
    s_add_u32 m0, m0, 4096
    s_add_u32 s84, s84, 4096
    buffer_load_dwordx4 v2, s[32:35], s84 offen offset:0 sc1 lds
    buffer_load_dwordx4 v2, s[32:35], s84 offen offset:2048 sc1 lds
    s_add_u32 m0, m0, 4096
    s_add_u32 s84, s84, 4096
    buffer_load_dwordx4 v2, s[32:35], s84 offen offset:0 sc1 lds
    buffer_load_dwordx4 v2, s[32:35], s84 offen offset:2048 sc1 lds
    s_add_u32 m0, m0, 4096
    s_add_u32 s84, s84, 4096
    buffer_load_dwordx4 v2, s[32:35], s84 offen offset:0 sc1 lds
    buffer_load_dwordx4 v2, s[32:35], s84 offen offset:2048 sc1 lds
    s_add_u32 m0, m0, 4096
    s_add_u32 s84, s84, 4096
    buffer_load_dwordx4 v2, s[32:35], s84 offen offset:0 sc1 lds
    buffer_load_dwordx4 v2, s[32:35], s84 offen offset:2048 sc1 lds
    s_waitcnt vmcnt(0)
    s_branch G1_HCB
G2_CI:
    v_lshrrev_b32 v10, 5, v1
    v_lshlrev_b32 v10, 5, v10
    s_lshl_b32 s67, s31, 6
    s_mov_b32 s48, s22
    s_mov_b32 s49, s23
    s_mov_b32 s50, 1280
    s_mov_b32 s51, 0x20000
    s_sub_u32 s70, s30, 14
    s_mul_i32 s69, s70, 52
    s_lshr_b32 s69, s69, 8
    s_mul_i32 s63, s69, 5
    s_sub_u32 s70, s70, s63
    s_lshl_b32 s66, s70, 8
    s_lshl_b32 s63, s69, 16
    s_add_u32 s66, s66, s63
    s_add_u32 s66, s66, s67
    v_add_u32 v10, s66, v10
    buffer_load_dwordx4 v[64:67], v10, s[48:51], 0 offen
    buffer_load_dwordx4 v[68:71], v10, s[48:51], 0 offen offset:16
    s_mul_i32 s74, s28, 835584
    s_sub_u32 s70, s30, 14
    s_mul_i32 s69, s70, 52
    s_lshr_b32 s69, s69, 8
    s_mul_i32 s63, s69, 5
    s_sub_u32 s70, s70, s63
    s_mul_i32 s63, s69, 40960
    s_add_u32 s74, s74, s63
    s_lshl_b32 s63, s70, 2
    s_add_u32 s63, s63, s31
    s_lshl_b32 s63, s63, 11
    s_add_u32 s74, s74, s63
    s_add_u32 s74, s74, 0x1454000
    s_sub_u32 s68, s30, 14
    s_lshl_b32 s68, s68, 2
    s_add_u32 s68, s68, s31
    s_lshl_b32 s78, s28, 13
    s_lshl_b32 s63, s68, 2
    s_add_u32 s78, s78, s63
    s_add_u32 s78, s78, 131072
    s_mov_b32 s79, 122880
    v_lshrrev_b32 v16, 5, v1
    v_and_b32 v17, 31, v1
    v_lshlrev_b32 v17, 4, v17
    v_lshl_add_u32 v0, v16, 10, v17
    v_and_b32 v4, 12, v3
    v_add_u32 v4, 163328, v4
    s_and_b32 s66, s29, 3
    s_lshl_b32 s66, s66, 2
    s_add_u32 s66, s66, 163328
    v_mov_b32 v5, s66
    s_lshl_b32 s63, s68, 2
    s_sub_u32 s82, s78, s63
    v_lshlrev_b32 v10, 7, v1
    buffer_load_dword v18, v10, s[32:35], s82 offen sc1
    v_mov_b32 v14, s53
    v_add_u32 v10, 4096, v3
    s_cmp_lg_u32 s55, 0
    s_cbranch_scc1 BS_102
    buffer_store_dword v14, v10, s[32:35], s82 offen offset:0
    buffer_store_dword v14, v10, s[32:35], s82 offen offset:256
    buffer_store_dword v14, v10, s[32:35], s82 offen offset:512
    buffer_store_dword v14, v10, s[32:35], s82 offen offset:768
BR_103:
    s_mov_b32 s58, 0
SL_104:
    ds_read_b32 v16, v4 offset:112
    s_add_u32 s58, s58, 1
    s_waitcnt lgkmcnt(0)
    v_cmp_gt_u32 vcc, 1, v16
    s_nop 1
    s_cbranch_vccz SD_106
    s_cmp_lt_u32 s58, 80000
    s_cbranch_scc1 SL_104
SD_106:
    v_add_u32 v10, 85504, v9
    ds_read_b64_tr_b16 v[112:113], v10 offset:0
    ds_read_b64_tr_b16 v[114:115], v10 offset:1024
    ds_read_b64_tr_b16 v[116:117], v10 offset:4096
    ds_read_b64_tr_b16 v[118:119], v10 offset:5120
    ds_read_b64_tr_b16 v[120:121], v10 offset:8192
    ds_read_b64_tr_b16 v[122:123], v10 offset:9216
    ds_read_b64_tr_b16 v[124:125], v10 offset:12288
    ds_read_b64_tr_b16 v[126:127], v10 offset:13312
    s_waitcnt lgkmcnt(6)
    ds_read_b64_tr_b16 v[128:129], v10 offset:16384
    ds_read_b64_tr_b16 v[130:131], v10 offset:17408
    ds_read_b64_tr_b16 v[132:133], v10 offset:20480
    ds_read_b64_tr_b16 v[134:135], v10 offset:21504
    ds_read_b64_tr_b16 v[136:137], v10 offset:24576
    ds_read_b64_tr_b16 v[138:139], v10 offset:25600
    ds_read_b64_tr_b16 v[140:141], v10 offset:28672
    ds_read_b64_tr_b16 v[142:143], v10 offset:29696
    s_waitcnt lgkmcnt(6)
    ds_read_b64_tr_b16 v[144:145], v10 offset:32768
    ds_read_b64_tr_b16 v[146:147], v10 offset:33792
    ds_read_b64_tr_b16 v[148:149], v10 offset:36864
    ds_read_b64_tr_b16 v[150:151], v10 offset:37888
    ds_read_b64_tr_b16 v[152:153], v10 offset:40960
    ds_read_b64_tr_b16 v[154:155], v10 offset:41984
    ds_read_b64_tr_b16 v[156:157], v10 offset:45056
    ds_read_b64_tr_b16 v[158:159], v10 offset:46080
    s_waitcnt lgkmcnt(6)
    ds_read_b64_tr_b16 v[160:161], v10 offset:49152
    ds_read_b64_tr_b16 v[162:163], v10 offset:50176
    ds_read_b64_tr_b16 v[164:165], v10 offset:53248
    ds_read_b64_tr_b16 v[166:167], v10 offset:54272
    ds_read_b64_tr_b16 v[168:169], v10 offset:57344
    ds_read_b64_tr_b16 v[170:171], v10 offset:58368
    ds_read_b64_tr_b16 v[172:173], v10 offset:61440
    ds_read_b64_tr_b16 v[174:175], v10 offset:62464
    s_waitcnt lgkmcnt(6)
    v_add_u32 v10, 0x10000, v10
    ds_read_b64_tr_b16 v[176:177], v10 offset:0
    ds_read_b64_tr_b16 v[178:179], v10 offset:1024
    ds_read_b64_tr_b16 v[180:181], v10 offset:4096
    ds_read_b64_tr_b16 v[182:183], v10 offset:5120
    ds_read_b64_tr_b16 v[184:185], v10 offset:8192
    ds_read_b64_tr_b16 v[186:187], v10 offset:9216
    s_waitcnt lgkmcnt(0)
    s_mov_b32 s58, 0
SL_107:
    ds_read_b32 v16, v4 offset:112
    s_add_u32 s58, s58, 1
    s_waitcnt lgkmcnt(0)
    v_cmp_gt_u32 vcc, 2, v16
    s_nop 1
    s_cbranch_vccz SD_109
    s_cmp_lt_u32 s58, 80000
    s_cbranch_scc1 SL_107
SD_109:
    v_add_u32 v10, 0, v9
    ds_read_b64_tr_b16 v[188:189], v10 offset:0
    ds_read_b64_tr_b16 v[190:191], v10 offset:1024
    ds_read_b64_tr_b16 v[192:193], v10 offset:4096
    ds_read_b64_tr_b16 v[194:195], v10 offset:5120
    ds_read_b64_tr_b16 v[196:197], v10 offset:8192
    ds_read_b64_tr_b16 v[198:199], v10 offset:9216
    ds_read_b64_tr_b16 v[200:201], v10 offset:12288
    ds_read_b64_tr_b16 v[202:203], v10 offset:13312
    s_waitcnt lgkmcnt(6)
    ds_read_b64_tr_b16 v[204:205], v10 offset:16384
    ds_read_b64_tr_b16 v[206:207], v10 offset:17408
    ds_read_b64_tr_b16 v[208:209], v10 offset:20480
    ds_read_b64_tr_b16 v[210:211], v10 offset:21504
    ds_read_b64_tr_b16 v[212:213], v10 offset:24576
    ds_read_b64_tr_b16 v[214:215], v10 offset:25600
    ds_read_b64_tr_b16 v[216:217], v10 offset:28672
    ds_read_b64_tr_b16 v[218:219], v10 offset:29696
    s_waitcnt lgkmcnt(6)
    ds_read_b64_tr_b16 v[220:221], v10 offset:32768
    ds_read_b64_tr_b16 v[222:223], v10 offset:33792
    ds_read_b64_tr_b16 v[224:225], v10 offset:36864
    ds_read_b64_tr_b16 v[226:227], v10 offset:37888
    ds_read_b64_tr_b16 v[228:229], v10 offset:40960
    ds_read_b64_tr_b16 v[230:231], v10 offset:41984
    ds_read_b64_tr_b16 v[232:233], v10 offset:45056
    ds_read_b64_tr_b16 v[234:235], v10 offset:46080
    s_waitcnt lgkmcnt(6)
    ds_read_b64_tr_b16 v[236:237], v10 offset:49152
    ds_read_b64_tr_b16 v[238:239], v10 offset:50176
    ds_read_b64_tr_b16 v[240:241], v10 offset:53248
    ds_read_b64_tr_b16 v[242:243], v10 offset:54272
    ds_read_b64_tr_b16 v[244:245], v10 offset:57344
    ds_read_b64_tr_b16 v[246:247], v10 offset:58368
    ds_read_b64_tr_b16 v[248:249], v10 offset:61440
    ds_read_b64_tr_b16 v[250:251], v10 offset:62464
    s_waitcnt lgkmcnt(6)
    v_add_u32 v10, 0x10000, v10
    ds_read_b64_tr_b16 v[252:253], v10 offset:0
    ds_read_b64_tr_b16 v[254:255], v10 offset:1024
    s_waitcnt lgkmcnt(0)
    v_mov_b32 v15, 1
    ds_write_b32 v5, v15 offset:160
    v_mov_b32 v96, 0x10001
    v_mov_b32 v97, 0x10001
    v_mov_b32 v98, 0x10001
    v_mov_b32 v99, 0x10001
    v_lshlrev_b32 v8, 7, v1
    s_cmp_eq_u32 s55, 0
    s_cselect_b32 s63, 0, 0
    v_cmp_gt_u32 vcc, s63, v1
    v_mov_b32 v10, 0x10000000
    s_nop 0
    v_cndmask_b32 v8, v10, v8, vcc
    s_waitcnt vmcnt(0)
    v_lshlrev_b32 v48, 16, v64
    v_and_b32 v49, s59, v64
    v_lshlrev_b32 v50, 16, v65
    v_and_b32 v51, s59, v65
    v_lshlrev_b32 v52, 16, v66
    v_and_b32 v53, s59, v66
    v_lshlrev_b32 v54, 16, v67
    v_and_b32 v55, s59, v67
    v_lshlrev_b32 v56, 16, v68
    v_and_b32 v57, s59, v68
    v_lshlrev_b32 v58, 16, v69
    v_and_b32 v59, s59, v69
    v_lshlrev_b32 v60, 16, v70
    v_and_b32 v61, s59, v70
    v_lshlrev_b32 v62, 16, v71
    v_and_b32 v63, s59, v71
    s_mov_b32 s76, 0x10001
    v_mov_b32 v14, s53
    s_mov_b32 s83, 0
    s_mov_b32 s85, 0x10000
    s_lshl_b32 s63, s68, 2
    s_sub_u32 s63, 4096, s63
    v_min_u32 v18, 28, v3
    v_add_u32 v18, s63, v18
    v_cmp_eq_u32 vcc, 0, v3
    v_mov_b32 v11, 0x10000000
    s_nop 0
    v_cndmask_b32_e64 v11, v11, 0, vcc
    v_mov_b32 v17, 1
    s_mov_b32 s56, 0
    s_mov_b32 s81, 0
    s_mov_b32 s80, 2
    s_mov_b32 s84, 1
    v_and_b32 v4, 4, v3
    v_add_u32 v4, 163328, v4
    s_mov_b32 s72, 0
    s_mov_b32 s75, 36864
    v_mov_b32 v6, v2
    s_setprio 2
    s_branch G2_WAIT
G2_SLOW:
    s_add_u32 s56, s56, 1
    s_waitcnt lgkmcnt(0)
    v_cmp_gt_u32 vcc, s84, v16
    s_nop 1
    s_cbranch_vccnz G2_ALONE
    ds_read_b128 v[24:27], v6 offset:0
    ds_read_b128 v[28:31], v6 offset:1024
    ds_read_b128 v[32:35], v6 offset:2048
    ds_read_b128 v[36:39], v6 offset:3072
    ds_read_b128 v[40:43], v6 offset:4096
    s_branch G2_V1
G2_ALONE:
    v_add_u32 v15, 1, v15
    ds_write_b32 v5, v15 offset:160
    ds_read_b32 v16, v4 offset:128
    s_nop 1
    v_cvt_pk_bf16_f32 v64, v64, v65
    v_cvt_pk_bf16_f32 v65, v66, v67
    v_cvt_pk_bf16_f32 v66, v68, v69
    v_cvt_pk_bf16_f32 v67, v70, v71
    v_bfi_b32 v64, s76, v17, v64
    v_bfi_b32 v65, s83, v17, v65
    v_cvt_pk_bf16_f32 v72, v72, v73
    v_cvt_pk_bf16_f32 v73, v74, v75
    v_cvt_pk_bf16_f32 v74, v76, v77
    v_cvt_pk_bf16_f32 v75, v78, v79
    v_bfi_b32 v72, s76, v17, v72
    v_bfi_b32 v73, s83, v17, v73
    s_waitcnt lgkmcnt(0)
    v_cmp_gt_u32 vcc, s84, v16
    s_nop 1
    s_cbranch_vccnz G2_AL2
    ds_read_b128 v[24:27], v6 offset:0
    ds_read_b128 v[28:31], v6 offset:1024
    ds_read_b128 v[32:35], v6 offset:2048
    ds_read_b128 v[36:39], v6 offset:3072
    ds_read_b128 v[40:43], v6 offset:4096
    s_waitcnt vmcnt(0)
    s_cmp_lg_u32 s55, 0
    s_cbranch_scc1 BS_110
    buffer_store_dwordx4 v[64:67], v0, s[32:35], s74 offen offset:0
    buffer_store_dwordx4 v[72:75], v0, s[32:35], s74 offen offset:512
    buffer_store_dword v14, v11, s[32:35], s78 offen
BR_111:
    s_add_u32 s78, s78, 256
    s_bitcmp1_b32 0x8888, s81
    s_cselect_b32 s63, -368640, s79
    s_cselect_b32 s82, 0x10001, 0
    s_cselect_b32 s73, s85, 0
    s_add_u32 s74, s74, s63
    v_xor_b32 v17, s82, v17
    s_add_u32 s81, s81, 1
    s_xor_b32 s85, s85, s82
    s_xor_b32 s76, s76, s73
    s_xor_b32 s83, s83, s73
    s_cmp_eq_u32 s81, 12
    s_cselect_b32 s76, 0, s76
    s_branch G2_B0
G2_AL2:
    s_waitcnt vmcnt(0)
    s_cmp_lg_u32 s55, 0
    s_cbranch_scc1 BS_112
    buffer_store_dwordx4 v[64:67], v0, s[32:35], s74 offen offset:0
    buffer_store_dwordx4 v[72:75], v0, s[32:35], s74 offen offset:512
    buffer_store_dword v14, v11, s[32:35], s78 offen
BR_113:
    s_add_u32 s78, s78, 256
    s_bitcmp1_b32 0x8888, s81
    s_cselect_b32 s63, -368640, s79
    s_cselect_b32 s82, 0x10001, 0
    s_cselect_b32 s73, s85, 0
    s_add_u32 s74, s74, s63
    v_xor_b32 v17, s82, v17
    s_add_u32 s81, s81, 1
    s_xor_b32 s85, s85, s82
    s_xor_b32 s76, s76, s73
    s_xor_b32 s83, s83, s73
    s_cmp_eq_u32 s81, 12
    s_cselect_b32 s76, 0, s76
    s_cmp_eq_u32 s56, 16
    s_cbranch_scc1 G2_END
G2_WAIT:
    s_mov_b32 s58, 0
SL_114:
    ds_read_b32 v16, v4 offset:128
    s_add_u32 s58, s58, 1
    s_waitcnt lgkmcnt(0)
    v_cmp_gt_u32 vcc, s84, v16
    s_nop 1
    s_cbranch_vccz SD_116
    s_cmp_lt_u32 s58, 80000
    s_cbranch_scc1 SL_114
SD_116:
    ds_read_b128 v[24:27], v6 offset:0
    ds_read_b128 v[28:31], v6 offset:1024
    ds_read_b128 v[32:35], v6 offset:2048
    ds_read_b128 v[36:39], v6 offset:3072
    ds_read_b128 v[40:43], v6 offset:4096
G2_B0:
    s_waitcnt lgkmcnt(4)
    v_mfma_f32_32x32x16_bf16 v[80:95], v[112:115], v[24:27], v[48:63]
    ds_read_b128 v[44:47], v6 offset:5120
    s_cmp_lt_u32 s81, 4
    s_cbranch_scc1 WA_117
WR_118:
    s_waitcnt lgkmcnt(4)
    v_mfma_f32_32x32x16_bf16 v[80:95], v[116:119], v[28:31], v[80:95]
    ds_read_b128 v[24:27], v6 offset:6144
    s_waitcnt lgkmcnt(4)
    v_mfma_f32_32x32x16_bf16 v[80:95], v[120:123], v[32:35], v[80:95]
    ds_read_b128 v[28:31], v6 offset:7168
    s_waitcnt lgkmcnt(4)
    v_mfma_f32_32x32x16_bf16 v[80:95], v[124:127], v[36:39], v[80:95]
    ds_read_b128 v[32:35], v6 offset:8192
    s_waitcnt lgkmcnt(4)
    v_mfma_f32_32x32x16_bf16 v[80:95], v[128:131], v[40:43], v[80:95]
    ds_read_b128 v[36:39], v6 offset:9216
    s_waitcnt lgkmcnt(4)
    v_mfma_f32_32x32x16_bf16 v[80:95], v[132:135], v[44:47], v[80:95]
    ds_read_b128 v[40:43], v6 offset:10240
    s_waitcnt lgkmcnt(4)
    v_mfma_f32_32x32x16_bf16 v[80:95], v[136:139], v[24:27], v[80:95]
    ds_read_b128 v[44:47], v6 offset:11264
    ds_read_b32 v16, v4 offset:128
    s_waitcnt lgkmcnt(5)
    v_mfma_f32_32x32x16_bf16 v[80:95], v[140:143], v[28:31], v[80:95]
    ds_read_b128 v[24:27], v6 offset:12288
    s_waitcnt lgkmcnt(5)
    v_mfma_f32_32x32x16_bf16 v[80:95], v[144:147], v[32:35], v[80:95]
    ds_read_b128 v[28:31], v6 offset:13312
    s_waitcnt lgkmcnt(5)
    v_mfma_f32_32x32x16_bf16 v[80:95], v[148:151], v[36:39], v[80:95]
    s_waitcnt lgkmcnt(2)
    v_cmp_gt_u32 vcc, s80, v16
    s_nop 1
    s_cbranch_vccnz G2_MS0
G2_MR:
    ds_read_b128 v[32:35], v6 offset:14336
    s_cmp_eq_u32 s72, 73728
    s_cselect_b32 s63, -73728, s75
    s_add_u32 s72, s72, s63
    s_add_u32 s84, s80, 1
    s_add_u32 s80, s80, 2
    v_xor_b32 v4, 8, v4
    v_mfma_f32_32x32x16_bf16 v[80:95], v[152:155], v[40:43], v[80:95]
    ds_read_b128 v[36:39], v6 offset:15360
    v_mfma_f32_32x32x16_bf16 v[80:95], v[156:159], v[44:47], v[80:95]
    ds_read_b128 v[40:43], v6 offset:16384
    s_waitcnt lgkmcnt(4)
    v_mfma_f32_32x32x16_bf16 v[80:95], v[160:163], v[24:27], v[80:95]
    ds_read_b128 v[44:47], v6 offset:17408
    s_waitcnt lgkmcnt(4)
    v_mfma_f32_32x32x16_bf16 v[80:95], v[164:167], v[28:31], v[80:95]
    ds_read_b128 v[24:27], v6 offset:18432
    s_waitcnt lgkmcnt(4)
    v_mfma_f32_32x32x16_bf16 v[80:95], v[168:171], v[32:35], v[80:95]
    ds_read_b128 v[28:31], v6 offset:19456
    s_waitcnt lgkmcnt(4)
    v_mfma_f32_32x32x16_bf16 v[80:95], v[172:175], v[36:39], v[80:95]
    ds_read_b128 v[32:35], v6 offset:20480
    s_waitcnt lgkmcnt(4)
    v_mfma_f32_32x32x16_bf16 v[80:95], v[176:179], v[40:43], v[80:95]
    ds_read_b128 v[36:39], v6 offset:21504
    s_waitcnt lgkmcnt(4)
    v_mfma_f32_32x32x16_bf16 v[80:95], v[180:183], v[44:47], v[80:95]
    ds_read_b128 v[40:43], v6 offset:22528
    s_waitcnt lgkmcnt(4)
    v_mfma_f32_32x32x16_bf16 v[80:95], v[184:187], v[24:27], v[80:95]
    ds_read_b128 v[44:47], v6 offset:23552
    s_waitcnt lgkmcnt(4)
    v_mfma_f32_32x32x16_bf16 v[80:95], v[188:191], v[28:31], v[80:95]
    ds_read_b128 v[24:27], v6 offset:24576
    s_waitcnt lgkmcnt(4)
    v_mfma_f32_32x32x16_bf16 v[80:95], v[192:195], v[32:35], v[80:95]
    ds_read_b128 v[28:31], v6 offset:25600
    s_waitcnt lgkmcnt(4)
    v_mfma_f32_32x32x16_bf16 v[80:95], v[196:199], v[36:39], v[80:95]
    ds_read_b128 v[32:35], v6 offset:26624
    s_waitcnt lgkmcnt(4)
    v_mfma_f32_32x32x16_bf16 v[80:95], v[200:203], v[40:43], v[80:95]
    ds_read_b128 v[36:39], v6 offset:27648
    s_waitcnt lgkmcnt(4)
    v_mfma_f32_32x32x16_bf16 v[80:95], v[204:207], v[44:47], v[80:95]
    ds_read_b128 v[40:43], v6 offset:28672
    s_waitcnt lgkmcnt(4)
    v_mfma_f32_32x32x16_bf16 v[80:95], v[208:211], v[24:27], v[80:95]
    ds_read_b128 v[44:47], v6 offset:29696
    s_waitcnt lgkmcnt(4)
    v_mfma_f32_32x32x16_bf16 v[80:95], v[212:215], v[28:31], v[80:95]
    ds_read_b128 v[24:27], v6 offset:30720
    s_waitcnt lgkmcnt(4)
    v_mfma_f32_32x32x16_bf16 v[80:95], v[216:219], v[32:35], v[80:95]
    ds_read_b128 v[28:31], v6 offset:31744
    s_waitcnt lgkmcnt(4)
    v_mfma_f32_32x32x16_bf16 v[80:95], v[220:223], v[36:39], v[80:95]
    ds_read_b128 v[32:35], v6 offset:32768
    s_waitcnt lgkmcnt(4)
    v_mfma_f32_32x32x16_bf16 v[80:95], v[224:227], v[40:43], v[80:95]
    ds_read_b128 v[36:39], v6 offset:33792
    ds_read_b32 v16, v4 offset:128
    s_waitcnt lgkmcnt(5)
    v_mfma_f32_32x32x16_bf16 v[80:95], v[228:231], v[44:47], v[80:95]
    ds_read_b128 v[40:43], v6 offset:34816
    s_waitcnt lgkmcnt(5)
    v_mfma_f32_32x32x16_bf16 v[80:95], v[232:235], v[24:27], v[80:95]
    ds_read_b128 v[44:47], v6 offset:35840
    s_waitcnt lgkmcnt(2)
    v_cmp_gt_u32 vcc, s84, v16
    v_add_u32 v6, s72, v2
    s_nop 0
    s_cbranch_vccnz G2_ST0
    v_mfma_f32_32x32x16_bf16 v[80:95], v[236:239], v[28:31], v[80:95]
    ds_read_b128 v[24:27], v6 offset:0
    v_mfma_f32_32x32x16_bf16 v[80:95], v[240:243], v[32:35], v[80:95]
    ds_read_b128 v[28:31], v6 offset:1024
    v_mfma_f32_32x32x16_bf16 v[80:95], v[244:247], v[36:39], v[80:95]
    ds_read_b128 v[32:35], v6 offset:2048
    s_waitcnt lgkmcnt(4)
    v_mfma_f32_32x32x16_bf16 v[80:95], v[248:251], v[40:43], v[80:95]
    ds_read_b128 v[36:39], v6 offset:3072
    s_waitcnt lgkmcnt(4)
    v_mfma_f32_32x32x16_bf16 v[64:79], v[252:255], v[44:47], v[80:95]
    ds_read_b128 v[40:43], v6 offset:4096
    s_add_u32 s56, s56, 1
    s_branch G2_V1
G2_V1:
    s_waitcnt lgkmcnt(4)
    s_nop 0
    v_mfma_f32_32x32x16_bf16 v[80:95], v[112:115], v[24:27], v[48:63]
    ds_read_b128 v[44:47], v6 offset:5120
    s_waitcnt lgkmcnt(4)
    v_mfma_f32_32x32x16_bf16 v[80:95], v[116:119], v[28:31], v[80:95]
    ds_read_b128 v[24:27], v6 offset:6144
    v_cvt_pk_bf16_f32 v64, v64, v65
    v_cvt_pk_bf16_f32 v65, v66, v67
    v_cvt_pk_bf16_f32 v66, v68, v69
    v_cvt_pk_bf16_f32 v67, v70, v71
    v_bfi_b32 v64, s76, v17, v64
    v_bfi_b32 v65, s83, v17, v65
    v_cvt_pk_bf16_f32 v72, v72, v73
    s_waitcnt lgkmcnt(4)
    v_mfma_f32_32x32x16_bf16 v[80:95], v[120:123], v[32:35], v[80:95]
    ds_read_b128 v[28:31], v6 offset:7168
    v_cvt_pk_bf16_f32 v73, v74, v75
    v_cvt_pk_bf16_f32 v74, v76, v77
    v_cvt_pk_bf16_f32 v75, v78, v79
    v_bfi_b32 v72, s76, v17, v72
    v_bfi_b32 v73, s83, v17, v73
    s_waitcnt lgkmcnt(4)
    v_mfma_f32_32x32x16_bf16 v[80:95], v[124:127], v[36:39], v[80:95]
    ds_read_b128 v[32:35], v6 offset:8192
    s_waitcnt vmcnt(0)
    s_cmp_lg_u32 s55, 0
    s_cbranch_scc1 BS_119
    buffer_store_dwordx4 v[64:67], v0, s[32:35], s74 offen offset:0
    buffer_store_dwordx4 v[72:75], v0, s[32:35], s74 offen offset:512
    buffer_store_dword v14, v11, s[32:35], s78 offen
BR_120:
    v_add_u32 v15, 1, v15
    ds_write_b32 v5, v15 offset:160
    s_add_u32 s78, s78, 256
    s_bitcmp1_b32 0x8888, s81
    s_cselect_b32 s63, -368640, s79
    s_cselect_b32 s82, 0x10001, 0
    s_cselect_b32 s73, s85, 0
    s_waitcnt lgkmcnt(5)
    v_mfma_f32_32x32x16_bf16 v[80:95], v[128:131], v[40:43], v[80:95]
    ds_read_b128 v[36:39], v6 offset:9216
    s_add_u32 s74, s74, s63
    v_xor_b32 v17, s82, v17
    s_add_u32 s81, s81, 1
    s_xor_b32 s85, s85, s82
    s_xor_b32 s76, s76, s73
    s_xor_b32 s83, s83, s73
    s_cmp_eq_u32 s81, 12
    s_cselect_b32 s76, 0, s76
    s_cmp_lt_u32 s81, 4
    s_cbranch_scc1 WA_121
WR_122:
    s_waitcnt lgkmcnt(5)
    v_mfma_f32_32x32x16_bf16 v[80:95], v[132:135], v[44:47], v[80:95]
    ds_read_b128 v[40:43], v6 offset:10240
    s_waitcnt lgkmcnt(5)
    v_mfma_f32_32x32x16_bf16 v[80:95], v[136:139], v[24:27], v[80:95]
    ds_read_b128 v[44:47], v6 offset:11264
    ds_read_b32 v16, v4 offset:128
    s_waitcnt lgkmcnt(6)
    v_mfma_f32_32x32x16_bf16 v[80:95], v[140:143], v[28:31], v[80:95]
    ds_read_b128 v[24:27], v6 offset:12288
    s_waitcnt lgkmcnt(6)
    v_mfma_f32_32x32x16_bf16 v[80:95], v[144:147], v[32:35], v[80:95]
    ds_read_b128 v[28:31], v6 offset:13312
    s_waitcnt lgkmcnt(5)
    v_mfma_f32_32x32x16_bf16 v[80:95], v[148:151], v[36:39], v[80:95]
    s_waitcnt lgkmcnt(2)
    v_cmp_gt_u32 vcc, s80, v16
    s_nop 1
    s_cbranch_vccnz G2_MS1
    ds_read_b128 v[32:35], v6 offset:14336
    s_cmp_eq_u32 s72, 73728
    s_cselect_b32 s63, -73728, s75
    s_add_u32 s72, s72, s63
    s_add_u32 s84, s80, 1
    s_add_u32 s80, s80, 2
    v_xor_b32 v4, 8, v4
    v_mfma_f32_32x32x16_bf16 v[80:95], v[152:155], v[40:43], v[80:95]
    ds_read_b128 v[36:39], v6 offset:15360
    v_mfma_f32_32x32x16_bf16 v[80:95], v[156:159], v[44:47], v[80:95]
    ds_read_b128 v[40:43], v6 offset:16384
    s_waitcnt lgkmcnt(4)
    v_mfma_f32_32x32x16_bf16 v[80:95], v[160:163], v[24:27], v[80:95]
    ds_read_b128 v[44:47], v6 offset:17408
    s_waitcnt lgkmcnt(4)
    v_mfma_f32_32x32x16_bf16 v[80:95], v[164:167], v[28:31], v[80:95]
    ds_read_b128 v[24:27], v6 offset:18432
    s_waitcnt lgkmcnt(4)
    v_mfma_f32_32x32x16_bf16 v[80:95], v[168:171], v[32:35], v[80:95]
    ds_read_b128 v[28:31], v6 offset:19456
    s_waitcnt lgkmcnt(4)
    v_mfma_f32_32x32x16_bf16 v[80:95], v[172:175], v[36:39], v[80:95]
    ds_read_b128 v[32:35], v6 offset:20480
    s_waitcnt lgkmcnt(4)
    v_mfma_f32_32x32x16_bf16 v[80:95], v[176:179], v[40:43], v[80:95]
    ds_read_b128 v[36:39], v6 offset:21504
    s_waitcnt lgkmcnt(4)
    v_mfma_f32_32x32x16_bf16 v[80:95], v[180:183], v[44:47], v[80:95]
    ds_read_b128 v[40:43], v6 offset:22528
    s_waitcnt lgkmcnt(4)
    v_mfma_f32_32x32x16_bf16 v[80:95], v[184:187], v[24:27], v[80:95]
    ds_read_b128 v[44:47], v6 offset:23552
    s_waitcnt lgkmcnt(4)
    v_mfma_f32_32x32x16_bf16 v[80:95], v[188:191], v[28:31], v[80:95]
    ds_read_b128 v[24:27], v6 offset:24576
    s_waitcnt lgkmcnt(4)
    v_mfma_f32_32x32x16_bf16 v[80:95], v[192:195], v[32:35], v[80:95]
    ds_read_b128 v[28:31], v6 offset:25600
    s_waitcnt lgkmcnt(4)
    v_mfma_f32_32x32x16_bf16 v[80:95], v[196:199], v[36:39], v[80:95]
    ds_read_b128 v[32:35], v6 offset:26624
    s_waitcnt lgkmcnt(4)
    v_mfma_f32_32x32x16_bf16 v[80:95], v[200:203], v[40:43], v[80:95]
    ds_read_b128 v[36:39], v6 offset:27648
    s_waitcnt lgkmcnt(4)
    v_mfma_f32_32x32x16_bf16 v[80:95], v[204:207], v[44:47], v[80:95]
    ds_read_b128 v[40:43], v6 offset:28672
    s_waitcnt lgkmcnt(4)
    v_mfma_f32_32x32x16_bf16 v[80:95], v[208:211], v[24:27], v[80:95]
    ds_read_b128 v[44:47], v6 offset:29696
    s_waitcnt lgkmcnt(4)
    v_mfma_f32_32x32x16_bf16 v[80:95], v[212:215], v[28:31], v[80:95]
    ds_read_b128 v[24:27], v6 offset:30720
    s_waitcnt lgkmcnt(4)
    v_mfma_f32_32x32x16_bf16 v[80:95], v[216:219], v[32:35], v[80:95]
    ds_read_b128 v[28:31], v6 offset:31744
    s_waitcnt lgkmcnt(4)
    v_mfma_f32_32x32x16_bf16 v[80:95], v[220:223], v[36:39], v[80:95]
    ds_read_b128 v[32:35], v6 offset:32768
    s_waitcnt lgkmcnt(4)
    v_mfma_f32_32x32x16_bf16 v[80:95], v[224:227], v[40:43], v[80:95]
    ds_read_b128 v[36:39], v6 offset:33792
    ds_read_b32 v16, v4 offset:128
    s_waitcnt lgkmcnt(5)
    v_mfma_f32_32x32x16_bf16 v[80:95], v[228:231], v[44:47], v[80:95]
    ds_read_b128 v[40:43], v6 offset:34816
    s_waitcnt lgkmcnt(5)
    v_mfma_f32_32x32x16_bf16 v[80:95], v[232:235], v[24:27], v[80:95]
    ds_read_b128 v[44:47], v6 offset:35840
    s_waitcnt lgkmcnt(2)
    v_cmp_gt_u32 vcc, s84, v16
    v_add_u32 v6, s72, v2
    s_nop 0
    s_cbranch_vccnz G2_ST1
    v_mfma_f32_32x32x16_bf16 v[80:95], v[236:239], v[28:31], v[80:95]
    ds_read_b128 v[24:27], v6 offset:0
    v_mfma_f32_32x32x16_bf16 v[80:95], v[240:243], v[32:35], v[80:95]
    ds_read_b128 v[28:31], v6 offset:1024
    v_mfma_f32_32x32x16_bf16 v[80:95], v[244:247], v[36:39], v[80:95]
    ds_read_b128 v[32:35], v6 offset:2048
    s_waitcnt lgkmcnt(4)
    v_mfma_f32_32x32x16_bf16 v[80:95], v[248:251], v[40:43], v[80:95]
    ds_read_b128 v[36:39], v6 offset:3072
    s_waitcnt lgkmcnt(4)
    v_mfma_f32_32x32x16_bf16 v[64:79], v[252:255], v[44:47], v[80:95]
    ds_read_b128 v[40:43], v6 offset:4096
    s_add_u32 s56, s56, 1
    s_branch G2_V1
G2_END:
    s_endpgm
BS_102:
    buffer_store_dword v14, v10, s[32:35], s82 offen offset:0 sc1
    buffer_store_dword v14, v10, s[32:35], s82 offen offset:256 sc1
    buffer_store_dword v14, v10, s[32:35], s82 offen offset:512 sc1
    buffer_store_dword v14, v10, s[32:35], s82 offen offset:768 sc1
    s_branch BR_103
BS_110:
    buffer_store_dwordx4 v[64:67], v0, s[32:35], s74 offen offset:0 sc1
    buffer_store_dwordx4 v[72:75], v0, s[32:35], s74 offen offset:512 sc1
    buffer_store_dword v14, v11, s[32:35], s78 offen sc1
    s_branch BR_111
BS_112:
    buffer_store_dwordx4 v[64:67], v0, s[32:35], s74 offen offset:0 sc1
    buffer_store_dwordx4 v[72:75], v0, s[32:35], s74 offen offset:512 sc1
    buffer_store_dword v14, v11, s[32:35], s78 offen sc1
    s_branch BR_113
WA_117:
    s_nop 0
    s_cmp_lg_u32 s55, 0
    s_cbranch_scc1 BS_123
    buffer_store_dwordx4 v[96:99], v0, s[32:35], s74 offen offset:0
    buffer_store_dwordx4 v[96:99], v0, s[32:35], s74 offen offset:512
BR_124:
    s_branch WR_118
G2_MS0:
    s_mov_b32 s58, 0
SL_125:
    ds_read_b32 v16, v4 offset:128
    s_add_u32 s58, s58, 1
    s_waitcnt lgkmcnt(0)
    v_cmp_gt_u32 vcc, s80, v16
    s_nop 1
    s_cbranch_vccz G2_MR
    s_cmp_lt_u32 s58, 80000
    s_cbranch_scc1 SL_125
    s_branch G2_MR
G2_ST0:
    v_mfma_f32_32x32x16_bf16 v[80:95], v[236:239], v[28:31], v[80:95]
    v_mfma_f32_32x32x16_bf16 v[80:95], v[240:243], v[32:35], v[80:95]
    v_mfma_f32_32x32x16_bf16 v[80:95], v[244:247], v[36:39], v[80:95]
    ds_read_b32 v16, v4 offset:128
    s_waitcnt lgkmcnt(2)
    v_mfma_f32_32x32x16_bf16 v[80:95], v[248:251], v[40:43], v[80:95]
    s_waitcnt lgkmcnt(1)
    v_mfma_f32_32x32x16_bf16 v[64:79], v[252:255], v[44:47], v[80:95]
    s_branch G2_SLOW
BS_119:
    buffer_store_dwordx4 v[64:67], v0, s[32:35], s74 offen offset:0 sc1
    buffer_store_dwordx4 v[72:75], v0, s[32:35], s74 offen offset:512 sc1
    buffer_store_dword v14, v11, s[32:35], s78 offen sc1
    s_branch BR_120
WA_121:
    s_nop 0
    s_cmp_lg_u32 s55, 0
    s_cbranch_scc1 BS_128
    buffer_store_dwordx4 v[96:99], v0, s[32:35], s74 offen offset:0
    buffer_store_dwordx4 v[96:99], v0, s[32:35], s74 offen offset:512
BR_129:
    s_branch WR_122
G2_MS1:
    s_mov_b32 s58, 0
SL_130:
    ds_read_b32 v16, v4 offset:128
    s_add_u32 s58, s58, 1
    s_waitcnt lgkmcnt(0)
    v_cmp_gt_u32 vcc, s80, v16
    s_nop 1
    s_cbranch_vccz G2_MR
    s_cmp_lt_u32 s58, 80000
    s_cbranch_scc1 SL_130
    s_branch G2_MR
G2_ST1:
    v_mfma_f32_32x32x16_bf16 v[80:95], v[236:239], v[28:31], v[80:95]
    v_mfma_f32_32x32x16_bf16 v[80:95], v[240:243], v[32:35], v[80:95]
    v_mfma_f32_32x32x16_bf16 v[80:95], v[244:247], v[36:39], v[80:95]
    ds_read_b32 v16, v4 offset:128
    s_waitcnt lgkmcnt(2)
    v_mfma_f32_32x32x16_bf16 v[80:95], v[248:251], v[40:43], v[80:95]
    s_waitcnt lgkmcnt(1)
    v_mfma_f32_32x32x16_bf16 v[64:79], v[252:255], v[44:47], v[80:95]
    s_branch G2_SLOW
BS_123:
    buffer_store_dwordx4 v[96:99], v0, s[32:35], s74 offen offset:0 sc1
    buffer_store_dwordx4 v[96:99], v0, s[32:35], s74 offen offset:512 sc1
    s_branch BR_124
BS_128:
    buffer_store_dwordx4 v[96:99], v0, s[32:35], s74 offen offset:0 sc1
    buffer_store_dwordx4 v[96:99], v0, s[32:35], s74 offen offset:512 sc1
    s_branch BR_129
G2_HI:
    s_and_b32 s85, s29, 1
    s_lshl_b32 s72, s85, 10
    s_lshl_b32 s85, s85, 1
    s_lshr_b32 s56, s31, 1
    s_mul_i32 s74, s28, 835584
    s_sub_u32 s70, s30, 14
    s_mul_i32 s69, s70, 52
    s_lshr_b32 s69, s69, 8
    s_mul_i32 s63, s69, 5
    s_sub_u32 s70, s70, s63
    s_mul_i32 s63, s69, 40960
    s_add_u32 s74, s74, s63
    s_lshl_b32 s63, s70, 2
    s_add_u32 s63, s63, s85
    s_lshl_b32 s63, s63, 11
    s_add_u32 s74, s74, s63
    s_add_u32 s74, s74, 0x1454000
    s_sub_u32 s68, s30, 14
    s_lshl_b32 s68, s68, 2
    s_add_u32 s68, s68, s85
    s_lshl_b32 s78, s28, 13
    s_lshl_b32 s63, s68, 2
    s_add_u32 s78, s78, s63
    s_add_u32 s78, s78, 131072
    s_mov_b32 s79, 122880
    v_lshrrev_b32 v16, 5, v1
    v_and_b32 v17, 31, v1
    v_lshlrev_b32 v17, 4, v17
    v_lshl_add_u32 v0, v16, 10, v17
    v_and_b32 v4, 12, v3
    v_add_u32 v4, 163328, v4
    s_and_b32 s66, s29, 3
    s_lshl_b32 s66, s66, 2
    s_add_u32 s66, s66, 163328
    v_mov_b32 v5, s66
    s_lshl_b32 s64, s28, 3
    s_add_u32 s64, s64, s56
    s_mul_i32 s64, s64, 114688
    s_add_u32 s64, s64, s72
    s_mul_i32 s65, s56, 36864
    s_add_u32 s65, s65, s72
    s_mul_i32 s63, s56, 122880
    s_add_u32 s74, s74, s63
    s_cmp_eq_u32 s55, 0
    s_cselect_b32 s63, 835584, 0
    s_cselect_b32 s71, 0, 344064
    s_add_u32 s63, s63, s71
    s_mul_i32 s71, s28, s63
    s_cmp_eq_u32 s55, 0
    s_cselect_b32 s63, 0, 8388608
    s_add_u32 s71, s71, s63
    s_mul_i32 s64, s56, 114688
    s_add_u32 s64, s64, s72
    s_add_u32 s64, s64, s71
    s_mul_i32 s63, s69, 36864
    s_add_u32 s64, s64, s63
    s_add_u32 s64, s64, 0x1400000
    s_lshl_b32 s73, s28, 13
    s_mul_i32 s63, s69, 72
    s_add_u32 s73, s73, s63
    s_add_u32 s73, s73, 65536
    v_min_u32 v12, 68, v3
    s_mul_i32 s63, s56, 256
    s_add_u32 s73, s73, s63
    s_mov_b32 s75, 229376
    s_mov_b32 s79, 245760
    s_mov_b32 s70, -36864
    s_mov_b32 s77, 0x10000
    s_sub_u32 s71, s30, 14
    s_lshl_b32 s63, s71, 2
    s_add_u32 s63, s63, s31
    s_mul_i32 s63, s63, 67
    s_mul_i32 s66, s28, 835584
    s_add_u32 s66, s66, 0x1450000
    v_add_u32 v56, s63, v1
    v_add_u32 v54, 0, v56
    v_min_u32 v54, 3967, v54
    v_lshlrev_b32 v54, 7, v54
    s_cmp_eq_u32 s55, 0
    s_cselect_b32 s63, 64, 0
    v_cmp_gt_u32 vcc, s63, v1
    v_mov_b32 v10, 0x10000000
    s_nop 0
    v_cndmask_b32 v54, v10, v54, vcc
    buffer_load_dword v61, v54, s[32:35], s66 offen
    v_add_u32 v54, 64, v56
    v_min_u32 v54, 3967, v54
    v_lshlrev_b32 v54, 7, v54
    s_cmp_eq_u32 s55, 0
    s_cselect_b32 s63, 3, 0
    v_cmp_gt_u32 vcc, s63, v1
    v_mov_b32 v10, 0x10000000
    s_nop 0
    v_cndmask_b32 v54, v10, v54, vcc
    buffer_load_dword v61, v54, s[32:35], s66 offen
    s_lshl_b32 s71, s71, 1
    s_and_b32 s63, s29, 1
    s_add_u32 s71, s71, s63
    s_lshl_b32 s71, s71, 2
    s_mul_i32 s63, s69, 72
    s_sub_u32 s71, s71, s63
    s_add_u32 s71, s71, 4864
    v_cmp_eq_u32 vcc, 0, v3
    v_mov_b32 v55, 0x10000000
    s_nop 0
    v_cndmask_b32_e64 v55, v55, 0, vcc
    v_add_u32 v55, s71, v55
    v_mov_b32 v54, s53
    v_min_u32 v57, 28, v3
    s_lshl_b32 s81, s28, 13
    s_lshl_b32 s63, s56, 8
    s_add_u32 s81, s81, s63
    s_add_u32 s81, s81, 135168
    s_lshl_b32 s63, s56, 1
    v_add_u32 v15, -2, s63
    s_mov_b32 s80, 1
    s_setprio 0
    v_add_u32 v15, 3, v15
    v_add_u32 v18, s65, v2
G2_HS:
    s_mov_b32 s58, 0
G2_HP:
    buffer_load_dword v13, v12, s[32:35], s73 offen sc1
    ds_read_b32 v16, v4 offset:160
    s_add_u32 s58, s58, 1
    s_waitcnt lgkmcnt(0)
    v_cmp_gt_u32 s[82:83], s80, v16
    s_waitcnt vmcnt(0)
    v_cmp_ne_u32 vcc, s53, v13
    s_nop 1
    s_or_b64 vcc, vcc, s[82:83]
    s_cbranch_vccz G2_HG
    s_cmp_lt_u32 s58, s57
    s_cbranch_scc1 G2_HP
    s_mov_b32 s57, 0
G2_HG:
    s_mov_b32 m0, s65
    s_mov_b32 s84, s64
    buffer_load_dwordx4 v2, s[32:35], s84 offen offset:0 sc1 lds
    buffer_load_dwordx4 v2, s[32:35], s84 offen offset:2048 sc1 lds
    s_add_u32 m0, m0, 4096
    s_add_u32 s84, s84, 4096
    buffer_load_dwordx4 v2, s[32:35], s84 offen offset:0 sc1 lds
    buffer_load_dwordx4 v2, s[32:35], s84 offen offset:2048 sc1 lds
    s_add_u32 m0, m0, 4096
    s_add_u32 s84, s84, 4096
    buffer_load_dwordx4 v2, s[32:35], s84 offen offset:0 sc1 lds
    buffer_load_dwordx4 v2, s[32:35], s84 offen offset:2048 sc1 lds
    s_add_u32 m0, m0, 4096
    s_add_u32 s84, s84, 4096
    buffer_load_dwordx4 v2, s[32:35], s84 offen offset:0 sc1 lds
    buffer_load_dwordx4 v2, s[32:35], s84 offen offset:2048 sc1 lds
    s_add_u32 m0, m0, 4096
    s_add_u32 s84, s84, 4096
    buffer_load_dwordx4 v2, s[32:35], s84 offen offset:0 sc1 lds
    buffer_load_dwordx4 v2, s[32:35], s84 offen offset:2048 sc1 lds
    s_add_u32 m0, m0, 4096
    s_add_u32 s84, s84, 4096
    buffer_load_dwordx4 v2, s[32:35], s84 offen offset:0 sc1 lds
    buffer_load_dwordx4 v2, s[32:35], s84 offen offset:2048 sc1 lds
    s_add_u32 m0, m0, 4096
    s_add_u32 s84, s84, 4096
    buffer_load_dwordx4 v2, s[32:35], s84 offen offset:0 sc1 lds
    buffer_load_dwordx4 v2, s[32:35], s84 offen offset:2048 sc1 lds
    s_add_u32 m0, m0, 4096
    s_add_u32 s84, s84, 4096
    buffer_load_dwordx4 v2, s[32:35], s84 offen offset:0 sc1 lds
    buffer_load_dwordx4 v2, s[32:35], s84 offen offset:2048 sc1 lds
    s_add_u32 m0, m0, 4096
    s_add_u32 s84, s84, 4096
    buffer_load_dwordx4 v2, s[32:35], s84 offen offset:0 sc1 lds
    buffer_load_dwordx4 v2, s[32:35], s84 offen offset:2048 sc1 lds
    s_mov_b32 s58, 0
    buffer_load_dword v58, v57, s[32:35], s81 offen sc1
    s_waitcnt vmcnt(12)
G2_HCA:
    ds_read_b64 v[24:25], v18 offset:0
    ds_read_b64 v[26:27], v18 offset:2048
    ds_read_b64 v[28:29], v18 offset:4096
    ds_read_b64 v[30:31], v18 offset:6144
    ds_read_b64 v[32:33], v18 offset:8192
    ds_read_b64 v[34:35], v18 offset:10240
    ds_read_b64 v[36:37], v18 offset:12288
    s_waitcnt lgkmcnt(4)
    v_or3_b32 v24, v24, v26, v28
    s_waitcnt lgkmcnt(2)
    v_or3_b32 v24, v24, v30, v32
    s_waitcnt lgkmcnt(0)
    v_or3_b32 v24, v24, v34, v36
    v_and_b32 v24, s77, v24
    v_cmp_ne_u32 vcc, 0, v24
    s_nop 1
    s_cbranch_vccnz G2_HRA
G2_HDA:
    ds_write_b32 v5, v15 offset:128
    v_add_u32 v15, 1, v15
    s_waitcnt vmcnt(0)
G2_HCB:
    ds_read_b64 v[24:25], v18 offset:14336
    ds_read_b64 v[26:27], v18 offset:16384
    ds_read_b64 v[28:29], v18 offset:18432
    ds_read_b64 v[30:31], v18 offset:20480
    ds_read_b64 v[32:33], v18 offset:22528
    ds_read_b64 v[34:35], v18 offset:24576
    ds_read_b64 v[36:37], v18 offset:26624
    ds_read_b64 v[38:39], v18 offset:28672
    ds_read_b64 v[40:41], v18 offset:30720
    ds_read_b64 v[42:43], v18 offset:32768
    ds_read_b64 v[44:45], v18 offset:34816
    s_waitcnt lgkmcnt(8)
    v_or3_b32 v24, v24, v26, v28
    s_waitcnt lgkmcnt(6)
    v_or3_b32 v24, v24, v30, v32
    s_waitcnt lgkmcnt(4)
    v_or3_b32 v24, v24, v34, v36
    s_waitcnt lgkmcnt(2)
    v_or3_b32 v24, v24, v38, v40
    s_waitcnt lgkmcnt(0)
    v_or3_b32 v24, v24, v42, v44
    v_and_b32 v24, s77, v24
    v_cmp_ne_u32 vcc, 0, v24
    s_nop 1
    s_cbranch_vccnz G2_HRB
G2_HDB:
    v_cmp_ne_u32 vcc, s53, v58
    s_nop 1
    s_cbranch_vccnz G2_LK
G2_LE:
    ds_write_b32 v5, v15 offset:128
    s_cmp_ge_u32 s56, 13
    s_cbranch_scc1 G2_HF
    s_cmp_lg_u32 s55, 0
    s_cbranch_scc1 BS_133
    buffer_store_dword v54, v55, s[32:35], s73 offen
BR_134:
G2_HF:
    s_add_u32 s81, s81, 512
    s_add_u32 s73, s73, 512
    s_add_u32 s80, s56, 1
    s_cmp_eq_u32 s65, s72
    s_cselect_b32 s63, s75, -114688
    s_cselect_b32 s66, 73728, s70
    s_add_u32 s64, s64, s63
    s_add_u32 s65, s65, s66
    s_add_u32 s56, s56, 2
    s_bitcmp1_b32 0x38e38, s56
    s_cselect_b32 s77, 1, 0x10000
    v_add_u32 v15, 3, v15
    v_add_u32 v18, s65, v2
    s_cmp_lt_u32 s56, 16
    s_cbranch_scc1 G2_HS
    s_endpgm
G2_HRA:
    s_add_u32 s58, s58, 1
    s_cmp_ge_u32 s58, s57
    s_cbranch_scc1 G2_HDA
    s_mov_b32 m0, s65
    s_mov_b32 s84, s64
    buffer_load_dwordx4 v2, s[32:35], s84 offen offset:0 sc1 lds
    buffer_load_dwordx4 v2, s[32:35], s84 offen offset:2048 sc1 lds
    s_add_u32 m0, m0, 4096
    s_add_u32 s84, s84, 4096
    buffer_load_dwordx4 v2, s[32:35], s84 offen offset:0 sc1 lds
    buffer_load_dwordx4 v2, s[32:35], s84 offen offset:2048 sc1 lds
    s_add_u32 m0, m0, 4096
    s_add_u32 s84, s84, 4096
    buffer_load_dwordx4 v2, s[32:35], s84 offen offset:0 sc1 lds
    buffer_load_dwordx4 v2, s[32:35], s84 offen offset:2048 sc1 lds
    s_add_u32 m0, m0, 4096
    s_add_u32 s84, s84, 4096
    buffer_load_dwordx4 v2, s[32:35], s84 offen offset:0 sc1 lds
    buffer_load_dwordx4 v2, s[32:35], s84 offen offset:2048 sc1 lds
    s_add_u32 m0, m0, 4096
    s_add_u32 s84, s84, 4096
    buffer_load_dwordx4 v2, s[32:35], s84 offen offset:0 sc1 lds
    buffer_load_dwordx4 v2, s[32:35], s84 offen offset:2048 sc1 lds
    s_add_u32 m0, m0, 4096
    s_add_u32 s84, s84, 4096
    buffer_load_dwordx4 v2, s[32:35], s84 offen offset:0 sc1 lds
    buffer_load_dwordx4 v2, s[32:35], s84 offen offset:2048 sc1 lds
    s_add_u32 m0, m0, 4096
    s_add_u32 s84, s84, 4096
    buffer_load_dwordx4 v2, s[32:35], s84 offen offset:0 sc1 lds
    buffer_load_dwordx4 v2, s[32:35], s84 offen offset:2048 sc1 lds
    s_add_u32 m0, m0, 4096
    s_add_u32 s84, s84, 4096
    buffer_load_dwordx4 v2, s[32:35], s84 offen offset:0 sc1 lds
    buffer_load_dwordx4 v2, s[32:35], s84 offen offset:2048 sc1 lds
    s_add_u32 m0, m0, 4096
    s_add_u32 s84, s84, 4096
    buffer_load_dwordx4 v2, s[32:35], s84 offen offset:0 sc1 lds
    buffer_load_dwordx4 v2, s[32:35], s84 offen offset:2048 sc1 lds
    s_waitcnt vmcnt(0)
    s_branch G2_HCA
G2_LK:
    s_mov_b32 s58, 0
G2_LL:
    buffer_load_dword v58, v57, s[32:35], s81 offen sc1
    s_add_u32 s58, s58, 1
    s_waitcnt vmcnt(0)
    v_cmp_ne_u32 vcc, s53, v58
    s_nop 1
    s_cbranch_vccz G2_LE
    s_cmp_lt_u32 s58, s57
    s_cbranch_scc1 G2_LL
    s_mov_b32 s57, 0
    s_branch G2_LE
G2_HRB:
    s_add_u32 s58, s58, 1
    s_cmp_ge_u32 s58, s57
    s_cbranch_scc1 G2_HDB
    s_mov_b32 m0, s65
    s_mov_b32 s84, s64
    buffer_load_dwordx4 v2, s[32:35], s84 offen offset:0 sc1 lds
    buffer_load_dwordx4 v2, s[32:35], s84 offen offset:2048 sc1 lds
    s_add_u32 m0, m0, 4096
    s_add_u32 s84, s84, 4096
    buffer_load_dwordx4 v2, s[32:35], s84 offen offset:0 sc1 lds
    buffer_load_dwordx4 v2, s[32:35], s84 offen offset:2048 sc1 lds
    s_add_u32 m0, m0, 4096
    s_add_u32 s84, s84, 4096
    buffer_load_dwordx4 v2, s[32:35], s84 offen offset:0 sc1 lds
    buffer_load_dwordx4 v2, s[32:35], s84 offen offset:2048 sc1 lds
    s_add_u32 m0, m0, 4096
    s_add_u32 s84, s84, 4096
    buffer_load_dwordx4 v2, s[32:35], s84 offen offset:0 sc1 lds
    buffer_load_dwordx4 v2, s[32:35], s84 offen offset:2048 sc1 lds
    s_add_u32 m0, m0, 4096
    s_add_u32 s84, s84, 4096
    buffer_load_dwordx4 v2, s[32:35], s84 offen offset:0 sc1 lds
    buffer_load_dwordx4 v2, s[32:35], s84 offen offset:2048 sc1 lds
    s_add_u32 m0, m0, 4096
    s_add_u32 s84, s84, 4096
    buffer_load_dwordx4 v2, s[32:35], s84 offen offset:0 sc1 lds
    buffer_load_dwordx4 v2, s[32:35], s84 offen offset:2048 sc1 lds
    s_add_u32 m0, m0, 4096
    s_add_u32 s84, s84, 4096
    buffer_load_dwordx4 v2, s[32:35], s84 offen offset:0 sc1 lds
    buffer_load_dwordx4 v2, s[32:35], s84 offen offset:2048 sc1 lds
    s_add_u32 m0, m0, 4096
    s_add_u32 s84, s84, 4096
    buffer_load_dwordx4 v2, s[32:35], s84 offen offset:0 sc1 lds
    buffer_load_dwordx4 v2, s[32:35], s84 offen offset:2048 sc1 lds
    s_add_u32 m0, m0, 4096
    s_add_u32 s84, s84, 4096
    buffer_load_dwordx4 v2, s[32:35], s84 offen offset:0 sc1 lds
    buffer_load_dwordx4 v2, s[32:35], s84 offen offset:2048 sc1 lds
    s_waitcnt vmcnt(0)
    s_branch G2_HCB
BS_133:
    buffer_store_dword v54, v55, s[32:35], s73 offen sc1
    s_branch BR_134
S_MAIN:
    s_mov_b32 s36, s4
    s_mov_b32 s37, s5
    s_mov_b32 s38, 0x280000
    s_mov_b32 s39, 0x20000
    s_sub_u32 s70, s30, 29
    s_mul_i32 s71, s52, 3
    s_add_u32 s70, s70, s71
    s_and_b32 s71, s70, 1
    s_lshr_b32 s70, s70, 1
    s_mul_i32 s72, s52, 20480
    s_mul_i32 s63, s31, 5120
    s_add_u32 s72, s72, s63
    s_lshl_b32 s73, s70, 8
    s_lshl_b32 s63, s28, 5
    s_add_u32 s73, s73, s63
    s_lshl_b32 s63, s71, 4
    s_add_u32 s73, s73, s63
    s_lshl_b32 s63, s31, 2
    s_add_u32 s73, s73, s63
    s_mul_i32 s73, s73, 1280
    s_movk_i32 s63, 820
    v_add_u32 v10, 0, v1
    v_mul_u32_u24 v11, s63, v10
    v_lshrrev_b32 v11, 16, v11
    v_lshlrev_b32 v11, 1, v11
    v_xor_b32 v10, v10, v11
    v_lshlrev_b32 v16, 4, v10
    v_add_u32 v10, 64, v1
    v_mul_u32_u24 v11, s63, v10
    v_lshrrev_b32 v11, 16, v11
    v_lshlrev_b32 v11, 1, v11
    v_xor_b32 v10, v10, v11
    v_lshlrev_b32 v17, 4, v10
    v_add_u32 v10, 128, v1
    v_mul_u32_u24 v11, s63, v10
    v_lshrrev_b32 v11, 16, v11
    v_lshlrev_b32 v11, 1, v11
    v_xor_b32 v10, v10, v11
    v_lshlrev_b32 v18, 4, v10
    v_add_u32 v10, 192, v1
    v_mul_u32_u24 v11, s63, v10
    v_lshrrev_b32 v11, 16, v11
    v_lshlrev_b32 v11, 1, v11
    v_xor_b32 v10, v10, v11
    v_lshlrev_b32 v19, 4, v10
    v_add_u32 v10, 256, v1
    v_mul_u32_u24 v11, s63, v10
    v_lshrrev_b32 v11, 16, v11
    v_lshlrev_b32 v11, 1, v11
    v_xor_b32 v10, v10, v11
    v_lshlrev_b32 v20, 4, v10
    s_barrier
    s_add_u32 s66, s73, 983040
    s_min_u32 s66, s66, 2616320
    s_add_u32 m0, s72, 40960
    s_nop 0
    buffer_load_dwordx4 v16, s[36:39], s66 offen lds
    s_add_u32 m0, s72, 41984
    s_nop 0
    buffer_load_dwordx4 v17, s[36:39], s66 offen lds
    s_add_u32 m0, s72, 43008
    s_nop 0
    buffer_load_dwordx4 v18, s[36:39], s66 offen lds
    s_add_u32 m0, s72, 44032
    s_nop 0
    buffer_load_dwordx4 v19, s[36:39], s66 offen lds
    s_add_u32 m0, s72, 45056
    s_nop 0
    buffer_load_dwordx4 v20, s[36:39], s66 offen lds
    s_add_u32 s66, s73, 1966080
    s_min_u32 s66, s66, 2616320
    s_add_u32 m0, s72, 81920
    s_nop 0
    buffer_load_dwordx4 v16, s[36:39], s66 offen lds
    s_add_u32 m0, s72, 82944
    s_nop 0
    buffer_load_dwordx4 v17, s[36:39], s66 offen lds
    s_add_u32 m0, s72, 83968
    s_nop 0
    buffer_load_dwordx4 v18, s[36:39], s66 offen lds
    s_add_u32 m0, s72, 84992
    s_nop 0
    buffer_load_dwordx4 v19, s[36:39], s66 offen lds
    s_add_u32 m0, s72, 86016
    s_nop 0
    buffer_load_dwordx4 v20, s[36:39], s66 offen lds
    s_mov_b32 s40, s24
    s_mov_b32 s41, s25
    s_mov_b32 s42, 0x280000
    s_mov_b32 s43, 0x20000
    v_lshrrev_b32 v40, 2, v1
    v_and_b32 v41, 3, v1
    v_lshlrev_b32 v0, 9, v40
    v_lshl_add_u32 v0, v41, 4, v0
    s_lshl_b32 s66, s71, 8
    s_lshl_b32 s67, s31, 6
    s_add_u32 s66, s66, s67
    v_add_u32 v0, s66, v0
    v_add_u32 v34, 40960, v0
    v_add_u32 v35, 81920, v0
    v_lshlrev_b32 v43, 1, v41
    v_xor_b32 v43, v43, v40
    v_mul_u32_u24 v9, 1280, v41
    v_lshl_add_u32 v9, v43, 4, v9
    v_lshrrev_b32 v43, 4, v1
    v_lshl_add_u32 v43, v43, 2, v41
    v_bfe_u32 v44, v1, 2, 2
    v_lshlrev_b32 v44, 1, v44
    s_lshr_b32 s66, s31, 1
    v_add_u32 v44, s66, v44
    v_and_b32 v45, 1, v41
    v_xor_b32 v44, v44, v45
    v_and_b32 v45, 2, v41
    v_lshlrev_b32 v45, 2, v45
    v_xor_b32 v44, v44, v45
    v_lshlrev_b32 v6, 8, v43
    v_lshl_add_u32 v6, v44, 4, v6
    s_and_b32 s66, s31, 1
    s_lshl_b32 s66, s66, 3
    s_mul_i32 s67, s31, 5120
    s_sub_u32 s66, s66, s67
    v_add_u32 v6, s66, v6
    v_lshrrev_b32 v43, 4, v1
    v_and_b32 v44, 15, v1
    v_and_b32 v45, 1, v43
    v_xor_b32 v44, v44, v45
    v_and_b32 v45, 2, v43
    v_lshlrev_b32 v45, 2, v45
    v_xor_b32 v44, v44, v45
    v_lshrrev_b32 v45, 1, v44
    v_lshl_add_u32 v45, v43, 3, v45
    v_lshlrev_b32 v8, 6, v45
    v_and_b32 v44, 1, v44
    v_lshl_add_u32 v8, v44, 4, v8
    s_lshl_b32 s66, s71, 5
    s_mul_i32 s67, s31, 10240
    s_add_u32 s66, s66, s67
    v_add_u32 v8, s66, v8
    s_mul_i32 s66, s31, 40
    v_add_u32 v43, s66, v1
    v_lshrrev_b32 v44, 1, v43
    v_and_b32 v43, 1, v43
    v_lshlrev_b32 v43, 7, v43
    v_lshl_add_u32 v32, v44, 9, v43
    s_lshl_b32 s66, s71, 8
    v_add_u32 v32, s66, v32
    s_cmp_eq_u32 s55, 0
    s_cselect_b32 s63, 0, 0
    v_cmp_gt_u32 vcc, s63, v1
    v_mov_b32 v10, 0x10000000
    s_nop 0
    v_cndmask_b32 v32, v10, v32, vcc
    v_cmp_eq_u32 vcc, 0, v3
    v_mov_b32 v11, 0x10000000
    s_nop 0
    v_cndmask_b32_e64 v11, v11, 0, vcc
    v_min_u32 v12, 236, v3
    s_lshl_b32 s79, s71, 2
    s_add_u32 s79, s79, s31
    s_lshl_b32 s79, s79, 2
    s_lshl_b32 s63, s28, 10
    s_add_u32 s79, s79, s63
    s_add_u32 s79, s79, 49152
    s_lshl_b32 s66, s29, 2
    s_add_u32 s66, s66, 163328
    v_mov_b32 v29, s66
    s_and_b32 s66, s66, 0xfffffff0
    v_mov_b32 v30, s66
    s_mov_b32 s77, 0x10001
    s_add_u32 s74, s70, 0
    s_add_u32 s75, s72, 0
    v_add_u32 v4, s75, v6
    v_xor_b32 v5, 0x80, v4
    s_lshl_b32 s76, s28, 3
    s_add_u32 s76, s76, s74
    v_add_u32 v28, s75, v2
    s_add_u32 s66, s75, 0
    v_add_u32 v10, s66, v9
    ds_read_b128 v[156:159], v10 offset:0
    ds_read_b128 v[160:163], v10 offset:256
    ds_read_b128 v[164:167], v10 offset:512
    ds_read_b128 v[168:171], v10 offset:768
    ds_read_b128 v[172:175], v10 offset:1024
    s_mov_b64 s[94:95], -1
    s_mov_b64 s[96:97], -1
    s_mov_b64 s[98:99], -1
    s_mov_b64 s[100:101], -1
    s_mov_b64 s[82:83], -1
    s_waitcnt lgkmcnt(0)
    v_lshlrev_b32 v136, 16, v156
    v_and_b32 v137, s59, v156
    v_lshlrev_b32 v138, 16, v157
    v_and_b32 v139, s59, v157
    v_lshlrev_b32 v140, 16, v158
    v_and_b32 v141, s59, v158
    v_lshlrev_b32 v142, 16, v159
    v_and_b32 v143, s59, v159
    v_pk_mul_f32 v[26:27], v[136:137], v[136:137]
    v_pk_add_f32 v[24:25], v[136:137], v[138:139]
    v_pk_fma_f32 v[26:27], v[138:139], v[138:139], v[26:27]
    v_pk_add_f32 v[24:25], v[24:25], v[140:141]
    v_pk_fma_f32 v[26:27], v[140:141], v[140:141], v[26:27]
    v_pk_add_f32 v[24:25], v[24:25], v[142:143]
    v_pk_fma_f32 v[26:27], v[142:143], v[142:143], v[26:27]
    v_lshlrev_b32 v144, 16, v160
    v_and_b32 v145, s59, v160
    v_lshlrev_b32 v146, 16, v161
    v_and_b32 v147, s59, v161
    v_lshlrev_b32 v148, 16, v162
    v_and_b32 v149, s59, v162
    v_lshlrev_b32 v150, 16, v163
    v_and_b32 v151, s59, v163
    v_pk_add_f32 v[24:25], v[24:25], v[144:145]
    v_pk_fma_f32 v[26:27], v[144:145], v[144:145], v[26:27]
    v_pk_add_f32 v[24:25], v[24:25], v[146:147]
    v_pk_fma_f32 v[26:27], v[146:147], v[146:147], v[26:27]
    v_pk_add_f32 v[24:25], v[24:25], v[148:149]
    v_pk_fma_f32 v[26:27], v[148:149], v[148:149], v[26:27]
    v_pk_add_f32 v[24:25], v[24:25], v[150:151]
    v_pk_fma_f32 v[26:27], v[150:151], v[150:151], v[26:27]
    v_lshlrev_b32 v152, 16, v164
    v_and_b32 v153, s59, v164
    v_lshlrev_b32 v154, 16, v165
    v_and_b32 v155, s59, v165
    v_lshlrev_b32 v156, 16, v166
    v_and_b32 v157, s59, v166
    v_lshlrev_b32 v158, 16, v167
    v_and_b32 v159, s59, v167
    v_pk_add_f32 v[24:25], v[24:25], v[152:153]
    v_pk_fma_f32 v[26:27], v[152:153], v[152:153], v[26:27]
    v_pk_add_f32 v[24:25], v[24:25], v[154:155]
    v_pk_fma_f32 v[26:27], v[154:155], v[154:155], v[26:27]
    v_pk_add_f32 v[24:25], v[24:25], v[156:157]
    v_pk_fma_f32 v[26:27], v[156:157], v[156:157], v[26:27]
    v_pk_add_f32 v[24:25], v[24:25], v[158:159]
    v_pk_fma_f32 v[26:27], v[158:159], v[158:159], v[26:27]
    v_lshlrev_b32 v160, 16, v168
    v_and_b32 v161, s59, v168
    v_lshlrev_b32 v162, 16, v169
    v_and_b32 v163, s59, v169
    v_lshlrev_b32 v164, 16, v170
    v_and_b32 v165, s59, v170
    v_lshlrev_b32 v166, 16, v171
    v_and_b32 v167, s59, v171
    v_pk_add_f32 v[24:25], v[24:25], v[160:161]
    v_pk_fma_f32 v[26:27], v[160:161], v[160:161], v[26:27]
    v_pk_add_f32 v[24:25], v[24:25], v[162:163]
    v_pk_fma_f32 v[26:27], v[162:163], v[162:163], v[26:27]
    v_pk_add_f32 v[24:25], v[24:25], v[164:165]
    v_pk_fma_f32 v[26:27], v[164:165], v[164:165], v[26:27]
    v_pk_add_f32 v[24:25], v[24:25], v[166:167]
    v_pk_fma_f32 v[26:27], v[166:167], v[166:167], v[26:27]
    v_lshlrev_b32 v168, 16, v172
    v_and_b32 v169, s59, v172
    v_lshlrev_b32 v170, 16, v173
    v_and_b32 v171, s59, v173
    v_lshlrev_b32 v172, 16, v174
    v_and_b32 v173, s59, v174
    v_lshlrev_b32 v174, 16, v175
    v_and_b32 v175, s59, v175
    v_pk_add_f32 v[24:25], v[24:25], v[168:169]
    v_pk_fma_f32 v[26:27], v[168:169], v[168:169], v[26:27]
    v_pk_add_f32 v[24:25], v[24:25], v[170:171]
    v_pk_fma_f32 v[26:27], v[170:171], v[170:171], v[26:27]
    v_pk_add_f32 v[24:25], v[24:25], v[172:173]
    v_pk_fma_f32 v[26:27], v[172:173], v[172:173], v[26:27]
    v_pk_add_f32 v[24:25], v[24:25], v[174:175]
    v_pk_fma_f32 v[26:27], v[174:175], v[174:175], v[26:27]
    v_add_f32 v24, v24, v25
    v_add_f32 v26, v26, v27
    s_nop 1
    v_permlane32_swap_b32 v24, v26
    v_add_f32 v24, v24, v26
    v_mov_b32 v26, v24
    s_nop 1
    v_permlane16_swap_b32 v24, v26
    v_add_f32 v24, v24, v26
    s_nop 1
    v_add_f32 v24, v24, v24 row_ror:8 row_mask:0xf bank_mask:0xf
    s_nop 1
    v_add_f32 v24, v24, v24 row_ror:4 row_mask:0xf bank_mask:0xf
    v_mul_f32 v24, s60, v24
    v_mov_b32 v26, v24
    s_nop 1
    v_permlane32_swap_b32 v24, v26
    v_fma_f32 v26, -v24, v24, v26
    v_max_f32 v26, 0, v26
    v_add_f32 v14, s61, v26
    v_rsq_f32 v14, v14
    s_nop 0
    v_mul_f32_e64 v15, -v24, v14
    v_pk_fma_f32 v[76:77], v[136:137], v[14:15], v[14:15] op_sel:[0,0,1] op_sel_hi:[1,0,1]
    v_pk_fma_f32 v[78:79], v[138:139], v[14:15], v[14:15] op_sel:[0,0,1] op_sel_hi:[1,0,1]
    v_pk_fma_f32 v[80:81], v[140:141], v[14:15], v[14:15] op_sel:[0,0,1] op_sel_hi:[1,0,1]
    v_pk_fma_f32 v[82:83], v[142:143], v[14:15], v[14:15] op_sel:[0,0,1] op_sel_hi:[1,0,1]
    v_pk_fma_f32 v[84:85], v[144:145], v[14:15], v[14:15] op_sel:[0,0,1] op_sel_hi:[1,0,1]
    v_pk_fma_f32 v[86:87], v[146:147], v[14:15], v[14:15] op_sel:[0,0,1] op_sel_hi:[1,0,1]
    v_pk_fma_f32 v[88:89], v[148:149], v[14:15], v[14:15] op_sel:[0,0,1] op_sel_hi:[1,0,1]
    v_pk_fma_f32 v[90:91], v[150:151], v[14:15], v[14:15] op_sel:[0,0,1] op_sel_hi:[1,0,1]
    v_pk_fma_f32 v[92:93], v[152:153], v[14:15], v[14:15] op_sel:[0,0,1] op_sel_hi:[1,0,1]
    v_pk_fma_f32 v[94:95], v[154:155], v[14:15], v[14:15] op_sel:[0,0,1] op_sel_hi:[1,0,1]
    v_pk_fma_f32 v[96:97], v[156:157], v[14:15], v[14:15] op_sel:[0,0,1] op_sel_hi:[1,0,1]
    v_pk_fma_f32 v[98:99], v[158:159], v[14:15], v[14:15] op_sel:[0,0,1] op_sel_hi:[1,0,1]
    v_pk_fma_f32 v[100:101], v[160:161], v[14:15], v[14:15] op_sel:[0,0,1] op_sel_hi:[1,0,1]
    v_pk_fma_f32 v[102:103], v[162:163], v[14:15], v[14:15] op_sel:[0,0,1] op_sel_hi:[1,0,1]
    v_pk_fma_f32 v[104:105], v[164:165], v[14:15], v[14:15] op_sel:[0,0,1] op_sel_hi:[1,0,1]
    v_pk_fma_f32 v[106:107], v[166:167], v[14:15], v[14:15] op_sel:[0,0,1] op_sel_hi:[1,0,1]
    v_pk_fma_f32 v[108:109], v[168:169], v[14:15], v[14:15] op_sel:[0,0,1] op_sel_hi:[1,0,1]
    v_pk_fma_f32 v[110:111], v[170:171], v[14:15], v[14:15] op_sel:[0,0,1] op_sel_hi:[1,0,1]
    v_pk_fma_f32 v[112:113], v[172:173], v[14:15], v[14:15] op_sel:[0,0,1] op_sel_hi:[1,0,1]
    v_pk_fma_f32 v[114:115], v[174:175], v[14:15], v[14:15] op_sel:[0,0,1] op_sel_hi:[1,0,1]
    v_mov_b32 v36, s77
    s_add_u32 s66, s76, 0
    s_mul_i32 s66, s66, 40960
    s_add_u32 s66, s66, 0x1000000
    buffer_load_dword v33, v32, s[32:35], s66 offen
    s_cmp_lg_u32 s55, 0
    s_cbranch_scc1 BS_135
    buffer_store_dwordx4 v[36:39], v0, s[32:35], s66 offen
    s_add_u32 s66, s66, 8192
    buffer_store_dwordx4 v[36:39], v0, s[32:35], s66 offen
    s_add_u32 s66, s66, 8192
    buffer_store_dwordx4 v[36:39], v0, s[32:35], s66 offen
    s_add_u32 s66, s66, 8192
    buffer_store_dwordx4 v[36:39], v0, s[32:35], s66 offen
    s_add_u32 s66, s66, 8192
    buffer_store_dwordx4 v[36:39], v0, s[32:35], s66 offen
BR_136:
SA_F0:
    s_mov_b32 s58, 0
SA_YL0:
    s_add_u32 s67, s74, 0
    s_min_u32 s67, s67, 7
    s_lshl_b32 s67, s67, 3
    s_add_u32 s67, s67, s28
    s_mul_i32 s67, s67, 40960
    s_add_u32 s67, s67, 0x700000
    s_mov_b64 exec, s[94:95]
    buffer_load_dwordx4 v[116:119], v8, s[32:35], s67 offen offset:0 sc1
    s_mov_b64 exec, s[96:97]
    buffer_load_dwordx4 v[120:123], v8, s[32:35], s67 offen offset:2048 sc1
    s_mov_b64 exec, s[98:99]
    s_add_u32 s67, s67, 4096
    buffer_load_dwordx4 v[124:127], v8, s[32:35], s67 offen offset:0 sc1
    s_mov_b64 exec, s[100:101]
    buffer_load_dwordx4 v[128:131], v8, s[32:35], s67 offen offset:2048 sc1
    s_mov_b64 exec, s[82:83]
    s_add_u32 s67, s67, 4096
    buffer_load_dwordx4 v[132:135], v8, s[32:35], s67 offen offset:0 sc1
    s_add_u32 s58, s58, 1
    s_mov_b64 exec, s[94:95]
    s_waitcnt vmcnt(4)
    v_max3_u32 v10, v116, v117, v118
    ds_write_b128 v28, v[116:119] offset:0
    v_max_u32 v10, v10, v119
    v_cmp_eq_u32 s[94:95], -1, v10
    s_mov_b64 exec, s[96:97]
    s_waitcnt vmcnt(3)
    v_max3_u32 v10, v120, v121, v122
    ds_write_b128 v28, v[120:123] offset:1024
    v_max_u32 v10, v10, v123
    v_cmp_eq_u32 s[96:97], -1, v10
    s_mov_b64 exec, s[98:99]
    s_waitcnt vmcnt(2)
    v_max3_u32 v10, v124, v125, v126
    ds_write_b128 v28, v[124:127] offset:2048
    v_max_u32 v10, v10, v127
    v_cmp_eq_u32 s[98:99], -1, v10
    s_mov_b64 exec, s[100:101]
    s_waitcnt vmcnt(1)
    v_max3_u32 v10, v128, v129, v130
    ds_write_b128 v28, v[128:131] offset:3072
    v_max_u32 v10, v10, v131
    v_cmp_eq_u32 s[100:101], -1, v10
    s_mov_b64 exec, s[82:83]
    s_waitcnt vmcnt(0)
    v_max3_u32 v10, v132, v133, v134
    ds_write_b128 v28, v[132:135] offset:4096
    v_max_u32 v10, v10, v135
    v_cmp_eq_u32 s[82:83], -1, v10
    s_mov_b64 exec, -1
    s_or_b64 s[64:65], s[94:95], s[96:97]
    s_or_b64 s[80:81], s[98:99], s[100:101]
    s_or_b64 s[64:65], s[64:65], s[82:83]
    s_or_b64 s[80:81], s[80:81], s[64:65]
    s_cbranch_scc0 SA_G0
    s_cmp_lt_u32 s58, s57
    s_cbranch_scc1 SA_YL0
    s_mov_b32 s57, 0
SA_G0:
    v_mov_b32 v31, 1
    ds_write_b32 v29, v31
    ds_read_b128 v[116:119], v30
    s_waitcnt lgkmcnt(0)
    v_min_u32 v116, v116, v117
    v_min3_u32 v116, v116, v118, v119
    v_cmp_gt_u32 vcc, v31, v116
    s_nop 1
    s_cbranch_vccnz CS_137
CR_138:
    s_setprio 2
    s_waitcnt vmcnt(0)
    ds_read_b64_tr_b16 v[116:117], v4 offset:0
    ds_read_b64_tr_b16 v[118:119], v5 offset:0
    ds_read_b64_tr_b16 v[120:121], v4 offset:4096
    ds_read_b64_tr_b16 v[122:123], v5 offset:4096
    ds_read_b64_tr_b16 v[124:125], v4 offset:8192
    ds_read_b64_tr_b16 v[126:127], v5 offset:8192
    ds_read_b64_tr_b16 v[128:129], v4 offset:12288
    ds_read_b64_tr_b16 v[130:131], v5 offset:12288
    ds_read_b64_tr_b16 v[132:133], v4 offset:16384
    ds_read_b64_tr_b16 v[134:135], v5 offset:16384
    s_waitcnt lgkmcnt(8)
    v_lshlrev_b32 v36, 16, v116
    v_and_b32 v37, s59, v116
    v_lshlrev_b32 v38, 16, v117
    v_and_b32 v39, s59, v117
    v_lshlrev_b32 v40, 16, v118
    v_and_b32 v41, s59, v118
    v_lshlrev_b32 v42, 16, v119
    v_and_b32 v43, s59, v119
    v_pk_fma_f32 v[136:137], v[76:77], v[36:37], v[136:137]
    v_pk_fma_f32 v[138:139], v[78:79], v[38:39], v[138:139]
    v_pk_fma_f32 v[140:141], v[80:81], v[40:41], v[140:141]
    v_pk_fma_f32 v[142:143], v[82:83], v[42:43], v[142:143]
    v_pk_mul_f32 v[26:27], v[136:137], v[136:137]
    v_pk_add_f32 v[24:25], v[136:137], v[138:139]
    v_pk_fma_f32 v[26:27], v[138:139], v[138:139], v[26:27]
    v_pk_add_f32 v[24:25], v[24:25], v[140:141]
    v_pk_fma_f32 v[26:27], v[140:141], v[140:141], v[26:27]
    v_pk_add_f32 v[24:25], v[24:25], v[142:143]
    v_pk_fma_f32 v[26:27], v[142:143], v[142:143], v[26:27]
    s_waitcnt lgkmcnt(6)
    v_lshlrev_b32 v44, 16, v120
    v_and_b32 v45, s59, v120
    v_lshlrev_b32 v46, 16, v121
    v_and_b32 v47, s59, v121
    v_lshlrev_b32 v48, 16, v122
    v_and_b32 v49, s59, v122
    v_lshlrev_b32 v50, 16, v123
    v_and_b32 v51, s59, v123
    v_pk_fma_f32 v[144:145], v[84:85], v[44:45], v[144:145]
    v_pk_fma_f32 v[146:147], v[86:87], v[46:47], v[146:147]
    v_pk_fma_f32 v[148:149], v[88:89], v[48:49], v[148:149]
    v_pk_fma_f32 v[150:151], v[90:91], v[50:51], v[150:151]
    v_pk_add_f32 v[24:25], v[24:25], v[144:145]
    v_pk_fma_f32 v[26:27], v[144:145], v[144:145], v[26:27]
    v_pk_add_f32 v[24:25], v[24:25], v[146:147]
    v_pk_fma_f32 v[26:27], v[146:147], v[146:147], v[26:27]
    v_pk_add_f32 v[24:25], v[24:25], v[148:149]
    v_pk_fma_f32 v[26:27], v[148:149], v[148:149], v[26:27]
    v_pk_add_f32 v[24:25], v[24:25], v[150:151]
    v_pk_fma_f32 v[26:27], v[150:151], v[150:151], v[26:27]
    s_waitcnt lgkmcnt(4)
    v_lshlrev_b32 v52, 16, v124
    v_and_b32 v53, s59, v124
    v_lshlrev_b32 v54, 16, v125
    v_and_b32 v55, s59, v125
    v_lshlrev_b32 v56, 16, v126
    v_and_b32 v57, s59, v126
    v_lshlrev_b32 v58, 16, v127
    v_and_b32 v59, s59, v127
    v_pk_fma_f32 v[152:153], v[92:93], v[52:53], v[152:153]
    v_pk_fma_f32 v[154:155], v[94:95], v[54:55], v[154:155]
    v_pk_fma_f32 v[156:157], v[96:97], v[56:57], v[156:157]
    v_pk_fma_f32 v[158:159], v[98:99], v[58:59], v[158:159]
    v_pk_add_f32 v[24:25], v[24:25], v[152:153]
    v_pk_fma_f32 v[26:27], v[152:153], v[152:153], v[26:27]
    v_pk_add_f32 v[24:25], v[24:25], v[154:155]
    v_pk_fma_f32 v[26:27], v[154:155], v[154:155], v[26:27]
    v_pk_add_f32 v[24:25], v[24:25], v[156:157]
    v_pk_fma_f32 v[26:27], v[156:157], v[156:157], v[26:27]
    v_pk_add_f32 v[24:25], v[24:25], v[158:159]
    v_pk_fma_f32 v[26:27], v[158:159], v[158:159], v[26:27]
    s_waitcnt lgkmcnt(2)
    v_lshlrev_b32 v60, 16, v128
    v_and_b32 v61, s59, v128
    v_lshlrev_b32 v62, 16, v129
    v_and_b32 v63, s59, v129
    v_lshlrev_b32 v64, 16, v130
    v_and_b32 v65, s59, v130
    v_lshlrev_b32 v66, 16, v131
    v_and_b32 v67, s59, v131
    v_pk_fma_f32 v[160:161], v[100:101], v[60:61], v[160:161]
    v_pk_fma_f32 v[162:163], v[102:103], v[62:63], v[162:163]
    v_pk_fma_f32 v[164:165], v[104:105], v[64:65], v[164:165]
    v_pk_fma_f32 v[166:167], v[106:107], v[66:67], v[166:167]
    v_pk_add_f32 v[24:25], v[24:25], v[160:161]
    v_pk_fma_f32 v[26:27], v[160:161], v[160:161], v[26:27]
    v_pk_add_f32 v[24:25], v[24:25], v[162:163]
    v_pk_fma_f32 v[26:27], v[162:163], v[162:163], v[26:27]
    v_pk_add_f32 v[24:25], v[24:25], v[164:165]
    v_pk_fma_f32 v[26:27], v[164:165], v[164:165], v[26:27]
    v_pk_add_f32 v[24:25], v[24:25], v[166:167]
    v_pk_fma_f32 v[26:27], v[166:167], v[166:167], v[26:27]
    s_waitcnt lgkmcnt(0)
    v_lshlrev_b32 v68, 16, v132
    v_and_b32 v69, s59, v132
    v_lshlrev_b32 v70, 16, v133
    v_and_b32 v71, s59, v133
    v_lshlrev_b32 v72, 16, v134
    v_and_b32 v73, s59, v134
    v_lshlrev_b32 v74, 16, v135
    v_and_b32 v75, s59, v135
    v_pk_fma_f32 v[168:169], v[108:109], v[68:69], v[168:169]
    v_pk_fma_f32 v[170:171], v[110:111], v[70:71], v[170:171]
    v_pk_fma_f32 v[172:173], v[112:113], v[72:73], v[172:173]
    v_pk_fma_f32 v[174:175], v[114:115], v[74:75], v[174:175]
    v_pk_add_f32 v[24:25], v[24:25], v[168:169]
    v_pk_fma_f32 v[26:27], v[168:169], v[168:169], v[26:27]
    v_pk_add_f32 v[24:25], v[24:25], v[170:171]
    v_pk_fma_f32 v[26:27], v[170:171], v[170:171], v[26:27]
    v_pk_add_f32 v[24:25], v[24:25], v[172:173]
    v_pk_fma_f32 v[26:27], v[172:173], v[172:173], v[26:27]
    v_pk_add_f32 v[24:25], v[24:25], v[174:175]
    v_pk_fma_f32 v[26:27], v[174:175], v[174:175], v[26:27]
    v_add_f32 v24, v24, v25
    v_add_f32 v26, v26, v27
    s_nop 1
    v_permlane32_swap_b32 v24, v26
    v_add_f32 v24, v24, v26
    v_mov_b32 v26, v24
    s_nop 1
    v_permlane16_swap_b32 v24, v26
    v_add_f32 v24, v24, v26
    s_nop 1
    v_add_f32 v24, v24, v24 row_ror:8 row_mask:0xf bank_mask:0xf
    s_nop 1
    v_add_f32 v24, v24, v24 row_ror:4 row_mask:0xf bank_mask:0xf
    v_mul_f32 v24, s60, v24
    v_mov_b32 v26, v24
    s_nop 1
    v_permlane32_swap_b32 v24, v26
    v_fma_f32 v26, -v24, v24, v26
    v_max_f32 v26, 0, v26
    v_add_f32 v14, s61, v26
    v_rsq_f32 v14, v14
    s_nop 0
    v_mul_f32 v26, v26, v14
    v_fma_f32 v26, v26, v14, s61
    v_mul_f32 v14, s62, v14
    v_rsq_f32 v26, v26
    s_nop 0
    v_mul_f32 v14, v14, v26
    v_mul_f32_e64 v15, -v24, v14
    s_setprio 3
    s_mul_i32 s66, s76, 40960
    s_add_u32 s66, s66, 0x1000000
    s_lshl_b32 s68, s74, 5
    s_add_u32 s68, s68, s79
    v_mov_b32 v13, s53
    v_pk_fma_f32 v[76:77], v[136:137], v[14:15], v[14:15] op_sel:[0,0,1] op_sel_hi:[1,0,1]
    v_pk_fma_f32 v[78:79], v[138:139], v[14:15], v[14:15] op_sel:[0,0,1] op_sel_hi:[1,0,1]
    v_pk_fma_f32 v[80:81], v[140:141], v[14:15], v[14:15] op_sel:[0,0,1] op_sel_hi:[1,0,1]
    v_pk_fma_f32 v[82:83], v[142:143], v[14:15], v[14:15] op_sel:[0,0,1] op_sel_hi:[1,0,1]
    v_cvt_pk_bf16_f32 v116, v76, v77
    v_cvt_pk_bf16_f32 v117, v78, v79
    v_cvt_pk_bf16_f32 v118, v80, v81
    v_cvt_pk_bf16_f32 v119, v82, v83
    v_bfi_b32 v116, s77, 1, v116
    s_cmp_lg_u32 s55, 0
    s_cbranch_scc1 BS_139
    buffer_store_dwordx4 v[116:119], v0, s[32:35], s66 offen
BR_140:
    s_add_u32 s66, s66, 8192
    v_pk_fma_f32 v[84:85], v[144:145], v[14:15], v[14:15] op_sel:[0,0,1] op_sel_hi:[1,0,1]
    v_pk_fma_f32 v[86:87], v[146:147], v[14:15], v[14:15] op_sel:[0,0,1] op_sel_hi:[1,0,1]
    v_pk_fma_f32 v[88:89], v[148:149], v[14:15], v[14:15] op_sel:[0,0,1] op_sel_hi:[1,0,1]
    v_pk_fma_f32 v[90:91], v[150:151], v[14:15], v[14:15] op_sel:[0,0,1] op_sel_hi:[1,0,1]
    v_cvt_pk_bf16_f32 v120, v84, v85
    v_cvt_pk_bf16_f32 v121, v86, v87
    v_cvt_pk_bf16_f32 v122, v88, v89
    v_cvt_pk_bf16_f32 v123, v90, v91
    v_bfi_b32 v120, s77, 1, v120
    s_cmp_lg_u32 s55, 0
    s_cbranch_scc1 BS_141
    buffer_store_dwordx4 v[120:123], v0, s[32:35], s66 offen
BR_142:
    s_add_u32 s66, s66, 8192
    v_pk_fma_f32 v[92:93], v[152:153], v[14:15], v[14:15] op_sel:[0,0,1] op_sel_hi:[1,0,1]
    v_pk_fma_f32 v[94:95], v[154:155], v[14:15], v[14:15] op_sel:[0,0,1] op_sel_hi:[1,0,1]
    v_pk_fma_f32 v[96:97], v[156:157], v[14:15], v[14:15] op_sel:[0,0,1] op_sel_hi:[1,0,1]
    v_pk_fma_f32 v[98:99], v[158:159], v[14:15], v[14:15] op_sel:[0,0,1] op_sel_hi:[1,0,1]
    v_cvt_pk_bf16_f32 v124, v92, v93
    v_cvt_pk_bf16_f32 v125, v94, v95
    v_cvt_pk_bf16_f32 v126, v96, v97
    v_cvt_pk_bf16_f32 v127, v98, v99
    v_bfi_b32 v124, s77, 1, v124
    s_cmp_lg_u32 s55, 0
    s_cbranch_scc1 BS_143
    buffer_store_dwordx4 v[124:127], v0, s[32:35], s66 offen
BR_144:
    s_add_u32 s66, s66, 8192
    v_pk_fma_f32 v[100:101], v[160:161], v[14:15], v[14:15] op_sel:[0,0,1] op_sel_hi:[1,0,1]
    v_pk_fma_f32 v[102:103], v[162:163], v[14:15], v[14:15] op_sel:[0,0,1] op_sel_hi:[1,0,1]
    v_pk_fma_f32 v[104:105], v[164:165], v[14:15], v[14:15] op_sel:[0,0,1] op_sel_hi:[1,0,1]
    v_pk_fma_f32 v[106:107], v[166:167], v[14:15], v[14:15] op_sel:[0,0,1] op_sel_hi:[1,0,1]
    v_cvt_pk_bf16_f32 v128, v100, v101
    v_cvt_pk_bf16_f32 v129, v102, v103
    v_cvt_pk_bf16_f32 v130, v104, v105
    v_cvt_pk_bf16_f32 v131, v106, v107
    v_bfi_b32 v128, s77, 1, v128
    s_cmp_lg_u32 s55, 0
    s_cbranch_scc1 BS_145
    buffer_store_dwordx4 v[128:131], v0, s[32:35], s66 offen
BR_146:
    s_add_u32 s66, s66, 8192
    v_pk_fma_f32 v[108:109], v[168:169], v[14:15], v[14:15] op_sel:[0,0,1] op_sel_hi:[1,0,1]
    v_pk_fma_f32 v[110:111], v[170:171], v[14:15], v[14:15] op_sel:[0,0,1] op_sel_hi:[1,0,1]
    v_pk_fma_f32 v[112:113], v[172:173], v[14:15], v[14:15] op_sel:[0,0,1] op_sel_hi:[1,0,1]
    v_pk_fma_f32 v[114:115], v[174:175], v[14:15], v[14:15] op_sel:[0,0,1] op_sel_hi:[1,0,1]
    v_cvt_pk_bf16_f32 v132, v108, v109
    v_cvt_pk_bf16_f32 v133, v110, v111
    v_cvt_pk_bf16_f32 v134, v112, v113
    v_cvt_pk_bf16_f32 v135, v114, v115
    v_bfi_b32 v132, s77, 1, v132
    s_cmp_lg_u32 s55, 0
    s_cbranch_scc1 BS_147
    buffer_store_dwordx4 v[132:135], v0, s[32:35], s66 offen
    buffer_store_dword v13, v11, s[32:35], s68 offen offset:0
BR_148:
    s_setprio 0
    s_add_u32 s66, s75, 40960
    v_add_u32 v10, s66, v9
    ds_read_b128 v[196:199], v10 offset:0
    ds_read_b128 v[200:203], v10 offset:256
    ds_read_b128 v[204:207], v10 offset:512
    ds_read_b128 v[208:211], v10 offset:768
    ds_read_b128 v[212:215], v10 offset:1024
    s_add_u32 s67, s74, 3
    s_min_u32 s67, s67, 7
    s_lshl_b32 s67, s67, 3
    s_add_u32 s67, s67, s28
    s_mul_i32 s67, s67, 40960
    s_add_u32 s67, s67, 0x700000
    buffer_load_dwordx4 v[176:179], v8, s[32:35], s67 offen offset:0 sc1
    buffer_load_dwordx4 v[180:183], v8, s[32:35], s67 offen offset:2048 sc1
    s_add_u32 s67, s67, 4096
    buffer_load_dwordx4 v[184:187], v8, s[32:35], s67 offen offset:0 sc1
    buffer_load_dwordx4 v[188:191], v8, s[32:35], s67 offen offset:2048 sc1
    s_add_u32 s67, s67, 4096
    buffer_load_dwordx4 v[192:195], v8, s[32:35], s67 offen offset:0 sc1
    v_mov_b32 v36, s77
    s_add_u32 s66, s76, 3
    s_mul_i32 s66, s66, 40960
    s_add_u32 s66, s66, 0x1000000
    buffer_load_dword v33, v32, s[32:35], s66 offen
    s_cmp_lg_u32 s55, 0
    s_cbranch_scc1 BS_149
    buffer_store_dwordx4 v[36:39], v0, s[32:35], s66 offen
    s_add_u32 s66, s66, 8192
    buffer_store_dwordx4 v[36:39], v0, s[32:35], s66 offen
    s_add_u32 s66, s66, 8192
    buffer_store_dwordx4 v[36:39], v0, s[32:35], s66 offen
    s_add_u32 s66, s66, 8192
    buffer_store_dwordx4 v[36:39], v0, s[32:35], s66 offen
    s_add_u32 s66, s66, 8192
    buffer_store_dwordx4 v[36:39], v0, s[32:35], s66 offen
BR_150:
    s_cmp_lg_u32 s2, 232
    s_cbranch_scc1 SA_E
    s_cmp_lg_u32 s29, 0
    s_cbranch_scc1 SA_E
    s_mov_b32 s66, 0
    v_mov_b32 v13, s53
    s_mov_b64 exec, 1
    buffer_store_dword v13, off, s[32:35], s66 sc1
    s_mov_b64 exec, -1
SA_E:
    s_add_u32 s74, s70, 3
    s_add_u32 s75, s72, 40960
    v_add_u32 v4, s75, v6
    v_xor_b32 v5, 0x80, v4
    s_lshl_b32 s76, s28, 3
    s_add_u32 s76, s76, s74
    v_add_u32 v28, s75, v2
    s_waitcnt vmcnt(10)
    v_max3_u32 v10, v176, v177, v178
    ds_write_b128 v28, v[176:179] offset:0
    v_max_u32 v10, v10, v179
    v_cmp_eq_u32 s[94:95], -1, v10
    s_waitcnt vmcnt(9)
    v_max3_u32 v10, v180, v181, v182
    ds_write_b128 v28, v[180:183] offset:1024
    v_max_u32 v10, v10, v183
    v_cmp_eq_u32 s[96:97], -1, v10
    s_waitcnt vmcnt(8)
    v_max3_u32 v10, v184, v185, v186
    ds_write_b128 v28, v[184:187] offset:2048
    v_max_u32 v10, v10, v187
    v_cmp_eq_u32 s[98:99], -1, v10
    s_waitcnt vmcnt(7)
    v_max3_u32 v10, v188, v189, v190
    ds_write_b128 v28, v[188:191] offset:3072
    v_max_u32 v10, v10, v191
    v_cmp_eq_u32 s[100:101], -1, v10
    s_waitcnt vmcnt(6)
    v_max3_u32 v10, v192, v193, v194
    ds_write_b128 v28, v[192:195] offset:4096
    v_max_u32 v10, v10, v195
    v_cmp_eq_u32 s[82:83], -1, v10
    s_or_b64 s[64:65], s[94:95], s[96:97]
    s_or_b64 s[80:81], s[98:99], s[100:101]
    s_or_b64 s[64:65], s[64:65], s[82:83]
    s_or_b64 s[80:81], s[80:81], s[64:65]
    s_waitcnt lgkmcnt(5)
    v_lshlrev_b32 v176, 16, v196
    v_and_b32 v177, s59, v196
    v_lshlrev_b32 v178, 16, v197
    v_and_b32 v179, s59, v197
    v_lshlrev_b32 v180, 16, v198
    v_and_b32 v181, s59, v198
    v_lshlrev_b32 v182, 16, v199
    v_and_b32 v183, s59, v199
    v_pk_mul_f32 v[26:27], v[176:177], v[176:177]
    v_pk_add_f32 v[24:25], v[176:177], v[178:179]
    v_pk_fma_f32 v[26:27], v[178:179], v[178:179], v[26:27]
    v_pk_add_f32 v[24:25], v[24:25], v[180:181]
    v_pk_fma_f32 v[26:27], v[180:181], v[180:181], v[26:27]
    v_pk_add_f32 v[24:25], v[24:25], v[182:183]
    v_pk_fma_f32 v[26:27], v[182:183], v[182:183], v[26:27]
    v_lshlrev_b32 v184, 16, v200
    v_and_b32 v185, s59, v200
    v_lshlrev_b32 v186, 16, v201
    v_and_b32 v187, s59, v201
    v_lshlrev_b32 v188, 16, v202
    v_and_b32 v189, s59, v202
    v_lshlrev_b32 v190, 16, v203
    v_and_b32 v191, s59, v203
    v_pk_add_f32 v[24:25], v[24:25], v[184:185]
    v_pk_fma_f32 v[26:27], v[184:185], v[184:185], v[26:27]
    v_pk_add_f32 v[24:25], v[24:25], v[186:187]
    v_pk_fma_f32 v[26:27], v[186:187], v[186:187], v[26:27]
    v_pk_add_f32 v[24:25], v[24:25], v[188:189]
    v_pk_fma_f32 v[26:27], v[188:189], v[188:189], v[26:27]
    v_pk_add_f32 v[24:25], v[24:25], v[190:191]
    v_pk_fma_f32 v[26:27], v[190:191], v[190:191], v[26:27]
    v_lshlrev_b32 v192, 16, v204
    v_and_b32 v193, s59, v204
    v_lshlrev_b32 v194, 16, v205
    v_and_b32 v195, s59, v205
    v_lshlrev_b32 v196, 16, v206
    v_and_b32 v197, s59, v206
    v_lshlrev_b32 v198, 16, v207
    v_and_b32 v199, s59, v207
    v_pk_add_f32 v[24:25], v[24:25], v[192:193]
    v_pk_fma_f32 v[26:27], v[192:193], v[192:193], v[26:27]
    v_pk_add_f32 v[24:25], v[24:25], v[194:195]
    v_pk_fma_f32 v[26:27], v[194:195], v[194:195], v[26:27]
    v_pk_add_f32 v[24:25], v[24:25], v[196:197]
    v_pk_fma_f32 v[26:27], v[196:197], v[196:197], v[26:27]
    v_pk_add_f32 v[24:25], v[24:25], v[198:199]
    v_pk_fma_f32 v[26:27], v[198:199], v[198:199], v[26:27]
    v_lshlrev_b32 v200, 16, v208
    v_and_b32 v201, s59, v208
    v_lshlrev_b32 v202, 16, v209
    v_and_b32 v203, s59, v209
    v_lshlrev_b32 v204, 16, v210
    v_and_b32 v205, s59, v210
    v_lshlrev_b32 v206, 16, v211
    v_and_b32 v207, s59, v211
    v_pk_add_f32 v[24:25], v[24:25], v[200:201]
    v_pk_fma_f32 v[26:27], v[200:201], v[200:201], v[26:27]
    v_pk_add_f32 v[24:25], v[24:25], v[202:203]
    v_pk_fma_f32 v[26:27], v[202:203], v[202:203], v[26:27]
    v_pk_add_f32 v[24:25], v[24:25], v[204:205]
    v_pk_fma_f32 v[26:27], v[204:205], v[204:205], v[26:27]
    v_pk_add_f32 v[24:25], v[24:25], v[206:207]
    v_pk_fma_f32 v[26:27], v[206:207], v[206:207], v[26:27]
    v_lshlrev_b32 v208, 16, v212
    v_and_b32 v209, s59, v212
    v_lshlrev_b32 v210, 16, v213
    v_and_b32 v211, s59, v213
    v_lshlrev_b32 v212, 16, v214
    v_and_b32 v213, s59, v214
    v_lshlrev_b32 v214, 16, v215
    v_and_b32 v215, s59, v215
    v_pk_add_f32 v[24:25], v[24:25], v[208:209]
    v_pk_fma_f32 v[26:27], v[208:209], v[208:209], v[26:27]
    v_pk_add_f32 v[24:25], v[24:25], v[210:211]
    v_pk_fma_f32 v[26:27], v[210:211], v[210:211], v[26:27]
    v_pk_add_f32 v[24:25], v[24:25], v[212:213]
    v_pk_fma_f32 v[26:27], v[212:213], v[212:213], v[26:27]
    v_pk_add_f32 v[24:25], v[24:25], v[214:215]
    v_pk_fma_f32 v[26:27], v[214:215], v[214:215], v[26:27]
    v_add_f32 v24, v24, v25
    v_add_f32 v26, v26, v27
    s_nop 1
    v_permlane32_swap_b32 v24, v26
    v_add_f32 v24, v24, v26
    v_mov_b32 v26, v24
    s_nop 1
    v_permlane16_swap_b32 v24, v26
    v_add_f32 v24, v24, v26
    s_nop 1
    v_add_f32 v24, v24, v24 row_ror:8 row_mask:0xf bank_mask:0xf
    s_nop 1
    v_add_f32 v24, v24, v24 row_ror:4 row_mask:0xf bank_mask:0xf
    v_mul_f32 v24, s60, v24
    v_mov_b32 v26, v24
    s_nop 1
    v_permlane32_swap_b32 v24, v26
    v_fma_f32 v26, -v24, v24, v26
    v_max_f32 v26, 0, v26
    v_add_f32 v14, s61, v26
    v_rsq_f32 v14, v14
    s_nop 0
    v_mul_f32_e64 v15, -v24, v14
    v_pk_fma_f32 v[76:77], v[176:177], v[14:15], v[14:15] op_sel:[0,0,1] op_sel_hi:[1,0,1]
    v_pk_fma_f32 v[78:79], v[178:179], v[14:15], v[14:15] op_sel:[0,0,1] op_sel_hi:[1,0,1]
    v_pk_fma_f32 v[80:81], v[180:181], v[14:15], v[14:15] op_sel:[0,0,1] op_sel_hi:[1,0,1]
    v_pk_fma_f32 v[82:83], v[182:183], v[14:15], v[14:15] op_sel:[0,0,1] op_sel_hi:[1,0,1]
    v_pk_fma_f32 v[84:85], v[184:185], v[14:15], v[14:15] op_sel:[0,0,1] op_sel_hi:[1,0,1]
    v_pk_fma_f32 v[86:87], v[186:187], v[14:15], v[14:15] op_sel:[0,0,1] op_sel_hi:[1,0,1]
    v_pk_fma_f32 v[88:89], v[188:189], v[14:15], v[14:15] op_sel:[0,0,1] op_sel_hi:[1,0,1]
    v_pk_fma_f32 v[90:91], v[190:191], v[14:15], v[14:15] op_sel:[0,0,1] op_sel_hi:[1,0,1]
    v_pk_fma_f32 v[92:93], v[192:193], v[14:15], v[14:15] op_sel:[0,0,1] op_sel_hi:[1,0,1]
    v_pk_fma_f32 v[94:95], v[194:195], v[14:15], v[14:15] op_sel:[0,0,1] op_sel_hi:[1,0,1]
    v_pk_fma_f32 v[96:97], v[196:197], v[14:15], v[14:15] op_sel:[0,0,1] op_sel_hi:[1,0,1]
    v_pk_fma_f32 v[98:99], v[198:199], v[14:15], v[14:15] op_sel:[0,0,1] op_sel_hi:[1,0,1]
    v_pk_fma_f32 v[100:101], v[200:201], v[14:15], v[14:15] op_sel:[0,0,1] op_sel_hi:[1,0,1]
    v_pk_fma_f32 v[102:103], v[202:203], v[14:15], v[14:15] op_sel:[0,0,1] op_sel_hi:[1,0,1]
    v_pk_fma_f32 v[104:105], v[204:205], v[14:15], v[14:15] op_sel:[0,0,1] op_sel_hi:[1,0,1]
    v_pk_fma_f32 v[106:107], v[206:207], v[14:15], v[14:15] op_sel:[0,0,1] op_sel_hi:[1,0,1]
    v_pk_fma_f32 v[108:109], v[208:209], v[14:15], v[14:15] op_sel:[0,0,1] op_sel_hi:[1,0,1]
    v_pk_fma_f32 v[110:111], v[210:211], v[14:15], v[14:15] op_sel:[0,0,1] op_sel_hi:[1,0,1]
    v_pk_fma_f32 v[112:113], v[212:213], v[14:15], v[14:15] op_sel:[0,0,1] op_sel_hi:[1,0,1]
    v_pk_fma_f32 v[114:115], v[214:215], v[14:15], v[14:15] op_sel:[0,0,1] op_sel_hi:[1,0,1]
    s_cmp_lg_u64 s[80:81], 0
    s_cbranch_scc1 SA_F1
SA_G1:
    v_mov_b32 v31, 2
    ds_write_b32 v29, v31
    ds_read_b128 v[116:119], v30
    s_waitcnt lgkmcnt(0)
    v_min_u32 v116, v116, v117
    v_min3_u32 v116, v116, v118, v119
    v_cmp_gt_u32 vcc, v31, v116
    s_nop 1
    s_cbranch_vccnz CS_151
CR_152:
    s_setprio 2
    s_waitcnt vmcnt(0)
    ds_read_b64_tr_b16 v[116:117], v4 offset:0
    ds_read_b64_tr_b16 v[118:119], v5 offset:0
    ds_read_b64_tr_b16 v[120:121], v4 offset:4096
    ds_read_b64_tr_b16 v[122:123], v5 offset:4096
    ds_read_b64_tr_b16 v[124:125], v4 offset:8192
    ds_read_b64_tr_b16 v[126:127], v5 offset:8192
    ds_read_b64_tr_b16 v[128:129], v4 offset:12288
    ds_read_b64_tr_b16 v[130:131], v5 offset:12288
    ds_read_b64_tr_b16 v[132:133], v4 offset:16384
    ds_read_b64_tr_b16 v[134:135], v5 offset:16384
    s_waitcnt lgkmcnt(8)
    v_lshlrev_b32 v36, 16, v116
    v_and_b32 v37, s59, v116
    v_lshlrev_b32 v38, 16, v117
    v_and_b32 v39, s59, v117
    v_lshlrev_b32 v40, 16, v118
    v_and_b32 v41, s59, v118
    v_lshlrev_b32 v42, 16, v119
    v_and_b32 v43, s59, v119
    v_pk_fma_f32 v[176:177], v[76:77], v[36:37], v[176:177]
    v_pk_fma_f32 v[178:179], v[78:79], v[38:39], v[178:179]
    v_pk_fma_f32 v[180:181], v[80:81], v[40:41], v[180:181]
    v_pk_fma_f32 v[182:183], v[82:83], v[42:43], v[182:183]
    v_pk_mul_f32 v[26:27], v[176:177], v[176:177]
    v_pk_add_f32 v[24:25], v[176:177], v[178:179]
    v_pk_fma_f32 v[26:27], v[178:179], v[178:179], v[26:27]
    v_pk_add_f32 v[24:25], v[24:25], v[180:181]
    v_pk_fma_f32 v[26:27], v[180:181], v[180:181], v[26:27]
    v_pk_add_f32 v[24:25], v[24:25], v[182:183]
    v_pk_fma_f32 v[26:27], v[182:183], v[182:183], v[26:27]
    s_waitcnt lgkmcnt(6)
    v_lshlrev_b32 v44, 16, v120
    v_and_b32 v45, s59, v120
    v_lshlrev_b32 v46, 16, v121
    v_and_b32 v47, s59, v121
    v_lshlrev_b32 v48, 16, v122
    v_and_b32 v49, s59, v122
    v_lshlrev_b32 v50, 16, v123
    v_and_b32 v51, s59, v123
    v_pk_fma_f32 v[184:185], v[84:85], v[44:45], v[184:185]
    v_pk_fma_f32 v[186:187], v[86:87], v[46:47], v[186:187]
    v_pk_fma_f32 v[188:189], v[88:89], v[48:49], v[188:189]
    v_pk_fma_f32 v[190:191], v[90:91], v[50:51], v[190:191]
    v_pk_add_f32 v[24:25], v[24:25], v[184:185]
    v_pk_fma_f32 v[26:27], v[184:185], v[184:185], v[26:27]
    v_pk_add_f32 v[24:25], v[24:25], v[186:187]
    v_pk_fma_f32 v[26:27], v[186:187], v[186:187], v[26:27]
    v_pk_add_f32 v[24:25], v[24:25], v[188:189]
    v_pk_fma_f32 v[26:27], v[188:189], v[188:189], v[26:27]
    v_pk_add_f32 v[24:25], v[24:25], v[190:191]
    v_pk_fma_f32 v[26:27], v[190:191], v[190:191], v[26:27]
    s_waitcnt lgkmcnt(4)
    v_lshlrev_b32 v52, 16, v124
    v_and_b32 v53, s59, v124
    v_lshlrev_b32 v54, 16, v125
    v_and_b32 v55, s59, v125
    v_lshlrev_b32 v56, 16, v126
    v_and_b32 v57, s59, v126
    v_lshlrev_b32 v58, 16, v127
    v_and_b32 v59, s59, v127
    v_pk_fma_f32 v[192:193], v[92:93], v[52:53], v[192:193]
    v_pk_fma_f32 v[194:195], v[94:95], v[54:55], v[194:195]
    v_pk_fma_f32 v[196:197], v[96:97], v[56:57], v[196:197]
    v_pk_fma_f32 v[198:199], v[98:99], v[58:59], v[198:199]
    v_pk_add_f32 v[24:25], v[24:25], v[192:193]
    v_pk_fma_f32 v[26:27], v[192:193], v[192:193], v[26:27]
    v_pk_add_f32 v[24:25], v[24:25], v[194:195]
    v_pk_fma_f32 v[26:27], v[194:195], v[194:195], v[26:27]
    v_pk_add_f32 v[24:25], v[24:25], v[196:197]
    v_pk_fma_f32 v[26:27], v[196:197], v[196:197], v[26:27]
    v_pk_add_f32 v[24:25], v[24:25], v[198:199]
    v_pk_fma_f32 v[26:27], v[198:199], v[198:199], v[26:27]
    s_waitcnt lgkmcnt(2)
    v_lshlrev_b32 v60, 16, v128
    v_and_b32 v61, s59, v128
    v_lshlrev_b32 v62, 16, v129
    v_and_b32 v63, s59, v129
    v_lshlrev_b32 v64, 16, v130
    v_and_b32 v65, s59, v130
    v_lshlrev_b32 v66, 16, v131
    v_and_b32 v67, s59, v131
    v_pk_fma_f32 v[200:201], v[100:101], v[60:61], v[200:201]
    v_pk_fma_f32 v[202:203], v[102:103], v[62:63], v[202:203]
    v_pk_fma_f32 v[204:205], v[104:105], v[64:65], v[204:205]
    v_pk_fma_f32 v[206:207], v[106:107], v[66:67], v[206:207]
    v_pk_add_f32 v[24:25], v[24:25], v[200:201]
    v_pk_fma_f32 v[26:27], v[200:201], v[200:201], v[26:27]
    v_pk_add_f32 v[24:25], v[24:25], v[202:203]
    v_pk_fma_f32 v[26:27], v[202:203], v[202:203], v[26:27]
    v_pk_add_f32 v[24:25], v[24:25], v[204:205]
    v_pk_fma_f32 v[26:27], v[204:205], v[204:205], v[26:27]
    v_pk_add_f32 v[24:25], v[24:25], v[206:207]
    v_pk_fma_f32 v[26:27], v[206:207], v[206:207], v[26:27]
    s_waitcnt lgkmcnt(0)
    v_lshlrev_b32 v68, 16, v132
    v_and_b32 v69, s59, v132
    v_lshlrev_b32 v70, 16, v133
    v_and_b32 v71, s59, v133
    v_lshlrev_b32 v72, 16, v134
    v_and_b32 v73, s59, v134
    v_lshlrev_b32 v74, 16, v135
    v_and_b32 v75, s59, v135
    v_pk_fma_f32 v[208:209], v[108:109], v[68:69], v[208:209]
    v_pk_fma_f32 v[210:211], v[110:111], v[70:71], v[210:211]
    v_pk_fma_f32 v[212:213], v[112:113], v[72:73], v[212:213]
    v_pk_fma_f32 v[214:215], v[114:115], v[74:75], v[214:215]
    v_pk_add_f32 v[24:25], v[24:25], v[208:209]
    v_pk_fma_f32 v[26:27], v[208:209], v[208:209], v[26:27]
    v_pk_add_f32 v[24:25], v[24:25], v[210:211]
    v_pk_fma_f32 v[26:27], v[210:211], v[210:211], v[26:27]
    v_pk_add_f32 v[24:25], v[24:25], v[212:213]
    v_pk_fma_f32 v[26:27], v[212:213], v[212:213], v[26:27]
    v_pk_add_f32 v[24:25], v[24:25], v[214:215]
    v_pk_fma_f32 v[26:27], v[214:215], v[214:215], v[26:27]
    v_add_f32 v24, v24, v25
    v_add_f32 v26, v26, v27
    s_nop 1
    v_permlane32_swap_b32 v24, v26
    v_add_f32 v24, v24, v26
    v_mov_b32 v26, v24
    s_nop 1
    v_permlane16_swap_b32 v24, v26
    v_add_f32 v24, v24, v26
    s_nop 1
    v_add_f32 v24, v24, v24 row_ror:8 row_mask:0xf bank_mask:0xf
    s_nop 1
    v_add_f32 v24, v24, v24 row_ror:4 row_mask:0xf bank_mask:0xf
    v_mul_f32 v24, s60, v24
    v_mov_b32 v26, v24
    s_nop 1
    v_permlane32_swap_b32 v24, v26
    v_fma_f32 v26, -v24, v24, v26
    v_max_f32 v26, 0, v26
    v_add_f32 v14, s61, v26
    v_rsq_f32 v14, v14
    s_nop 0
    v_mul_f32 v26, v26, v14
    v_fma_f32 v26, v26, v14, s61
    v_mul_f32 v14, s62, v14
    v_rsq_f32 v26, v26
    s_nop 0
    v_mul_f32 v14, v14, v26
    v_mul_f32_e64 v15, -v24, v14
    s_setprio 3
    s_mul_i32 s66, s76, 40960
    s_add_u32 s66, s66, 0x1000000
    s_lshl_b32 s68, s74, 5
    s_add_u32 s68, s68, s79
    v_mov_b32 v13, s53
    v_pk_fma_f32 v[76:77], v[176:177], v[14:15], v[14:15] op_sel:[0,0,1] op_sel_hi:[1,0,1]
    v_pk_fma_f32 v[78:79], v[178:179], v[14:15], v[14:15] op_sel:[0,0,1] op_sel_hi:[1,0,1]
    v_pk_fma_f32 v[80:81], v[180:181], v[14:15], v[14:15] op_sel:[0,0,1] op_sel_hi:[1,0,1]
    v_pk_fma_f32 v[82:83], v[182:183], v[14:15], v[14:15] op_sel:[0,0,1] op_sel_hi:[1,0,1]
    v_cvt_pk_bf16_f32 v116, v76, v77
    v_cvt_pk_bf16_f32 v117, v78, v79
    v_cvt_pk_bf16_f32 v118, v80, v81
    v_cvt_pk_bf16_f32 v119, v82, v83
    v_bfi_b32 v116, s77, 1, v116
    s_cmp_lg_u32 s55, 0
    s_cbranch_scc1 BS_153
    buffer_store_dwordx4 v[116:119], v0, s[32:35], s66 offen
BR_154:
    s_add_u32 s66, s66, 8192
    v_pk_fma_f32 v[84:85], v[184:185], v[14:15], v[14:15] op_sel:[0,0,1] op_sel_hi:[1,0,1]
    v_pk_fma_f32 v[86:87], v[186:187], v[14:15], v[14:15] op_sel:[0,0,1] op_sel_hi:[1,0,1]
    v_pk_fma_f32 v[88:89], v[188:189], v[14:15], v[14:15] op_sel:[0,0,1] op_sel_hi:[1,0,1]
    v_pk_fma_f32 v[90:91], v[190:191], v[14:15], v[14:15] op_sel:[0,0,1] op_sel_hi:[1,0,1]
    v_cvt_pk_bf16_f32 v120, v84, v85
    v_cvt_pk_bf16_f32 v121, v86, v87
    v_cvt_pk_bf16_f32 v122, v88, v89
    v_cvt_pk_bf16_f32 v123, v90, v91
    v_bfi_b32 v120, s77, 1, v120
    s_cmp_lg_u32 s55, 0
    s_cbranch_scc1 BS_155
    buffer_store_dwordx4 v[120:123], v0, s[32:35], s66 offen
BR_156:
    s_add_u32 s66, s66, 8192
    v_pk_fma_f32 v[92:93], v[192:193], v[14:15], v[14:15] op_sel:[0,0,1] op_sel_hi:[1,0,1]
    v_pk_fma_f32 v[94:95], v[194:195], v[14:15], v[14:15] op_sel:[0,0,1] op_sel_hi:[1,0,1]
    v_pk_fma_f32 v[96:97], v[196:197], v[14:15], v[14:15] op_sel:[0,0,1] op_sel_hi:[1,0,1]
    v_pk_fma_f32 v[98:99], v[198:199], v[14:15], v[14:15] op_sel:[0,0,1] op_sel_hi:[1,0,1]
    v_cvt_pk_bf16_f32 v124, v92, v93
    v_cvt_pk_bf16_f32 v125, v94, v95
    v_cvt_pk_bf16_f32 v126, v96, v97
    v_cvt_pk_bf16_f32 v127, v98, v99
    v_bfi_b32 v124, s77, 1, v124
    s_cmp_lg_u32 s55, 0
    s_cbranch_scc1 BS_157
    buffer_store_dwordx4 v[124:127], v0, s[32:35], s66 offen
BR_158:
    s_add_u32 s66, s66, 8192
    v_pk_fma_f32 v[100:101], v[200:201], v[14:15], v[14:15] op_sel:[0,0,1] op_sel_hi:[1,0,1]
    v_pk_fma_f32 v[102:103], v[202:203], v[14:15], v[14:15] op_sel:[0,0,1] op_sel_hi:[1,0,1]
    v_pk_fma_f32 v[104:105], v[204:205], v[14:15], v[14:15] op_sel:[0,0,1] op_sel_hi:[1,0,1]
    v_pk_fma_f32 v[106:107], v[206:207], v[14:15], v[14:15] op_sel:[0,0,1] op_sel_hi:[1,0,1]
    v_cvt_pk_bf16_f32 v128, v100, v101
    v_cvt_pk_bf16_f32 v129, v102, v103
    v_cvt_pk_bf16_f32 v130, v104, v105
    v_cvt_pk_bf16_f32 v131, v106, v107
    v_bfi_b32 v128, s77, 1, v128
    s_cmp_lg_u32 s55, 0
    s_cbranch_scc1 BS_159
    buffer_store_dwordx4 v[128:131], v0, s[32:35], s66 offen
BR_160:
    s_add_u32 s66, s66, 8192
    v_pk_fma_f32 v[108:109], v[208:209], v[14:15], v[14:15] op_sel:[0,0,1] op_sel_hi:[1,0,1]
    v_pk_fma_f32 v[110:111], v[210:211], v[14:15], v[14:15] op_sel:[0,0,1] op_sel_hi:[1,0,1]
    v_pk_fma_f32 v[112:113], v[212:213], v[14:15], v[14:15] op_sel:[0,0,1] op_sel_hi:[1,0,1]
    v_pk_fma_f32 v[114:115], v[214:215], v[14:15], v[14:15] op_sel:[0,0,1] op_sel_hi:[1,0,1]
    v_cvt_pk_bf16_f32 v132, v108, v109
    v_cvt_pk_bf16_f32 v133, v110, v111
    v_cvt_pk_bf16_f32 v134, v112, v113
    v_cvt_pk_bf16_f32 v135, v114, v115
    v_bfi_b32 v132, s77, 1, v132
    s_cmp_lg_u32 s55, 0
    s_cbranch_scc1 BS_161
    buffer_store_dwordx4 v[132:135], v0, s[32:35], s66 offen
    buffer_store_dword v13, v11, s[32:35], s68 offen offset:0
BR_162:
    s_setprio 0
    s_add_u32 s66, s75, 40960
    v_add_u32 v10, s66, v9
    ds_read_b128 v[236:239], v10 offset:0
    ds_read_b128 v[240:243], v10 offset:256
    ds_read_b128 v[244:247], v10 offset:512
    ds_read_b128 v[248:251], v10 offset:768
    ds_read_b128 v[252:255], v10 offset:1024
    s_add_u32 s67, s74, 3
    s_min_u32 s67, s67, 7
    s_lshl_b32 s67, s67, 3
    s_add_u32 s67, s67, s28
    s_mul_i32 s67, s67, 40960
    s_add_u32 s67, s67, 0x700000
    buffer_load_dwordx4 v[216:219], v8, s[32:35], s67 offen offset:0 sc1
    buffer_load_dwordx4 v[220:223], v8, s[32:35], s67 offen offset:2048 sc1
    s_add_u32 s67, s67, 4096
    buffer_load_dwordx4 v[224:227], v8, s[32:35], s67 offen offset:0 sc1
    buffer_load_dwordx4 v[228:231], v8, s[32:35], s67 offen offset:2048 sc1
    s_add_u32 s67, s67, 4096
    buffer_load_dwordx4 v[232:235], v8, s[32:35], s67 offen offset:0 sc1
    s_cmp_eq_u32 s70, 2
    s_cbranch_scc1 SA_END
    v_mov_b32 v36, s77
    s_add_u32 s66, s76, 3
    s_mul_i32 s66, s66, 40960
    s_add_u32 s66, s66, 0x1000000
    buffer_load_dword v33, v32, s[32:35], s66 offen
    s_cmp_lg_u32 s55, 0
    s_cbranch_scc1 BS_163
    buffer_store_dwordx4 v[36:39], v0, s[32:35], s66 offen
    s_add_u32 s66, s66, 8192
    buffer_store_dwordx4 v[36:39], v0, s[32:35], s66 offen
    s_add_u32 s66, s66, 8192
    buffer_store_dwordx4 v[36:39], v0, s[32:35], s66 offen
    s_add_u32 s66, s66, 8192
    buffer_store_dwordx4 v[36:39], v0, s[32:35], s66 offen
    s_add_u32 s66, s66, 8192
    buffer_store_dwordx4 v[36:39], v0, s[32:35], s66 offen
BR_164:
    s_add_u32 s74, s70, 6
    s_cmp_gt_u32 s74, 7
    s_cbranch_scc1 SA_END
    s_add_u32 s75, s72, 81920
    v_add_u32 v4, s75, v6
    v_xor_b32 v5, 0x80, v4
    s_lshl_b32 s76, s28, 3
    s_add_u32 s76, s76, s74
    v_add_u32 v28, s75, v2
    s_waitcnt vmcnt(10)
    v_max3_u32 v10, v216, v217, v218
    ds_write_b128 v28, v[216:219] offset:0
    v_max_u32 v10, v10, v219
    v_cmp_eq_u32 s[94:95], -1, v10
    s_waitcnt vmcnt(9)
    v_max3_u32 v10, v220, v221, v222
    ds_write_b128 v28, v[220:223] offset:1024
    v_max_u32 v10, v10, v223
    v_cmp_eq_u32 s[96:97], -1, v10
    s_waitcnt vmcnt(8)
    v_max3_u32 v10, v224, v225, v226
    ds_write_b128 v28, v[224:227] offset:2048
    v_max_u32 v10, v10, v227
    v_cmp_eq_u32 s[98:99], -1, v10
    s_waitcnt vmcnt(7)
    v_max3_u32 v10, v228, v229, v230
    ds_write_b128 v28, v[228:231] offset:3072
    v_max_u32 v10, v10, v231
    v_cmp_eq_u32 s[100:101], -1, v10
    s_waitcnt vmcnt(6)
    v_max3_u32 v10, v232, v233, v234
    ds_write_b128 v28, v[232:235] offset:4096
    v_max_u32 v10, v10, v235
    v_cmp_eq_u32 s[82:83], -1, v10
    s_or_b64 s[64:65], s[94:95], s[96:97]
    s_or_b64 s[80:81], s[98:99], s[100:101]
    s_or_b64 s[64:65], s[64:65], s[82:83]
    s_or_b64 s[80:81], s[80:81], s[64:65]
    s_waitcnt lgkmcnt(5)
    v_lshlrev_b32 v216, 16, v236
    v_and_b32 v217, s59, v236
    v_lshlrev_b32 v218, 16, v237
    v_and_b32 v219, s59, v237
    v_lshlrev_b32 v220, 16, v238
    v_and_b32 v221, s59, v238
    v_lshlrev_b32 v222, 16, v239
    v_and_b32 v223, s59, v239
    v_pk_mul_f32 v[26:27], v[216:217], v[216:217]
    v_pk_add_f32 v[24:25], v[216:217], v[218:219]
    v_pk_fma_f32 v[26:27], v[218:219], v[218:219], v[26:27]
    v_pk_add_f32 v[24:25], v[24:25], v[220:221]
    v_pk_fma_f32 v[26:27], v[220:221], v[220:221], v[26:27]
    v_pk_add_f32 v[24:25], v[24:25], v[222:223]
    v_pk_fma_f32 v[26:27], v[222:223], v[222:223], v[26:27]
    v_lshlrev_b32 v224, 16, v240
    v_and_b32 v225, s59, v240
    v_lshlrev_b32 v226, 16, v241
    v_and_b32 v227, s59, v241
    v_lshlrev_b32 v228, 16, v242
    v_and_b32 v229, s59, v242
    v_lshlrev_b32 v230, 16, v243
    v_and_b32 v231, s59, v243
    v_pk_add_f32 v[24:25], v[24:25], v[224:225]
    v_pk_fma_f32 v[26:27], v[224:225], v[224:225], v[26:27]
    v_pk_add_f32 v[24:25], v[24:25], v[226:227]
    v_pk_fma_f32 v[26:27], v[226:227], v[226:227], v[26:27]
    v_pk_add_f32 v[24:25], v[24:25], v[228:229]
    v_pk_fma_f32 v[26:27], v[228:229], v[228:229], v[26:27]
    v_pk_add_f32 v[24:25], v[24:25], v[230:231]
    v_pk_fma_f32 v[26:27], v[230:231], v[230:231], v[26:27]
    v_lshlrev_b32 v232, 16, v244
    v_and_b32 v233, s59, v244
    v_lshlrev_b32 v234, 16, v245
    v_and_b32 v235, s59, v245
    v_lshlrev_b32 v236, 16, v246
    v_and_b32 v237, s59, v246
    v_lshlrev_b32 v238, 16, v247
    v_and_b32 v239, s59, v247
    v_pk_add_f32 v[24:25], v[24:25], v[232:233]
    v_pk_fma_f32 v[26:27], v[232:233], v[232:233], v[26:27]
    v_pk_add_f32 v[24:25], v[24:25], v[234:235]
    v_pk_fma_f32 v[26:27], v[234:235], v[234:235], v[26:27]
    v_pk_add_f32 v[24:25], v[24:25], v[236:237]
    v_pk_fma_f32 v[26:27], v[236:237], v[236:237], v[26:27]
    v_pk_add_f32 v[24:25], v[24:25], v[238:239]
    v_pk_fma_f32 v[26:27], v[238:239], v[238:239], v[26:27]
    v_lshlrev_b32 v240, 16, v248
    v_and_b32 v241, s59, v248
    v_lshlrev_b32 v242, 16, v249
    v_and_b32 v243, s59, v249
    v_lshlrev_b32 v244, 16, v250
    v_and_b32 v245, s59, v250
    v_lshlrev_b32 v246, 16, v251
    v_and_b32 v247, s59, v251
    v_pk_add_f32 v[24:25], v[24:25], v[240:241]
    v_pk_fma_f32 v[26:27], v[240:241], v[240:241], v[26:27]
    v_pk_add_f32 v[24:25], v[24:25], v[242:243]
    v_pk_fma_f32 v[26:27], v[242:243], v[242:243], v[26:27]
    v_pk_add_f32 v[24:25], v[24:25], v[244:245]
    v_pk_fma_f32 v[26:27], v[244:245], v[244:245], v[26:27]
    v_pk_add_f32 v[24:25], v[24:25], v[246:247]
    v_pk_fma_f32 v[26:27], v[246:247], v[246:247], v[26:27]
    v_lshlrev_b32 v248, 16, v252
    v_and_b32 v249, s59, v252
    v_lshlrev_b32 v250, 16, v253
    v_and_b32 v251, s59, v253
    v_lshlrev_b32 v252, 16, v254
    v_and_b32 v253, s59, v254
    v_lshlrev_b32 v254, 16, v255
    v_and_b32 v255, s59, v255
    v_pk_add_f32 v[24:25], v[24:25], v[248:249]
    v_pk_fma_f32 v[26:27], v[248:249], v[248:249], v[26:27]
    v_pk_add_f32 v[24:25], v[24:25], v[250:251]
    v_pk_fma_f32 v[26:27], v[250:251], v[250:251], v[26:27]
    v_pk_add_f32 v[24:25], v[24:25], v[252:253]
    v_pk_fma_f32 v[26:27], v[252:253], v[252:253], v[26:27]
    v_pk_add_f32 v[24:25], v[24:25], v[254:255]
    v_pk_fma_f32 v[26:27], v[254:255], v[254:255], v[26:27]
    v_add_f32 v24, v24, v25
    v_add_f32 v26, v26, v27
    s_nop 1
    v_permlane32_swap_b32 v24, v26
    v_add_f32 v24, v24, v26
    v_mov_b32 v26, v24
    s_nop 1
    v_permlane16_swap_b32 v24, v26
    v_add_f32 v24, v24, v26
    s_nop 1
    v_add_f32 v24, v24, v24 row_ror:8 row_mask:0xf bank_mask:0xf
    s_nop 1
    v_add_f32 v24, v24, v24 row_ror:4 row_mask:0xf bank_mask:0xf
    v_mul_f32 v24, s60, v24
    v_mov_b32 v26, v24
    s_nop 1
    v_permlane32_swap_b32 v24, v26
    v_fma_f32 v26, -v24, v24, v26
    v_max_f32 v26, 0, v26
    v_add_f32 v14, s61, v26
    v_rsq_f32 v14, v14
    s_nop 0
    v_mul_f32_e64 v15, -v24, v14
    v_pk_fma_f32 v[76:77], v[216:217], v[14:15], v[14:15] op_sel:[0,0,1] op_sel_hi:[1,0,1]
    v_pk_fma_f32 v[78:79], v[218:219], v[14:15], v[14:15] op_sel:[0,0,1] op_sel_hi:[1,0,1]
    v_pk_fma_f32 v[80:81], v[220:221], v[14:15], v[14:15] op_sel:[0,0,1] op_sel_hi:[1,0,1]
    v_pk_fma_f32 v[82:83], v[222:223], v[14:15], v[14:15] op_sel:[0,0,1] op_sel_hi:[1,0,1]
    v_pk_fma_f32 v[84:85], v[224:225], v[14:15], v[14:15] op_sel:[0,0,1] op_sel_hi:[1,0,1]
    v_pk_fma_f32 v[86:87], v[226:227], v[14:15], v[14:15] op_sel:[0,0,1] op_sel_hi:[1,0,1]
    v_pk_fma_f32 v[88:89], v[228:229], v[14:15], v[14:15] op_sel:[0,0,1] op_sel_hi:[1,0,1]
    v_pk_fma_f32 v[90:91], v[230:231], v[14:15], v[14:15] op_sel:[0,0,1] op_sel_hi:[1,0,1]
    v_pk_fma_f32 v[92:93], v[232:233], v[14:15], v[14:15] op_sel:[0,0,1] op_sel_hi:[1,0,1]
    v_pk_fma_f32 v[94:95], v[234:235], v[14:15], v[14:15] op_sel:[0,0,1] op_sel_hi:[1,0,1]
    v_pk_fma_f32 v[96:97], v[236:237], v[14:15], v[14:15] op_sel:[0,0,1] op_sel_hi:[1,0,1]
    v_pk_fma_f32 v[98:99], v[238:239], v[14:15], v[14:15] op_sel:[0,0,1] op_sel_hi:[1,0,1]
    v_pk_fma_f32 v[100:101], v[240:241], v[14:15], v[14:15] op_sel:[0,0,1] op_sel_hi:[1,0,1]
    v_pk_fma_f32 v[102:103], v[242:243], v[14:15], v[14:15] op_sel:[0,0,1] op_sel_hi:[1,0,1]
    v_pk_fma_f32 v[104:105], v[244:245], v[14:15], v[14:15] op_sel:[0,0,1] op_sel_hi:[1,0,1]
    v_pk_fma_f32 v[106:107], v[246:247], v[14:15], v[14:15] op_sel:[0,0,1] op_sel_hi:[1,0,1]
    v_pk_fma_f32 v[108:109], v[248:249], v[14:15], v[14:15] op_sel:[0,0,1] op_sel_hi:[1,0,1]
    v_pk_fma_f32 v[110:111], v[250:251], v[14:15], v[14:15] op_sel:[0,0,1] op_sel_hi:[1,0,1]
    v_pk_fma_f32 v[112:113], v[252:253], v[14:15], v[14:15] op_sel:[0,0,1] op_sel_hi:[1,0,1]
    v_pk_fma_f32 v[114:115], v[254:255], v[14:15], v[14:15] op_sel:[0,0,1] op_sel_hi:[1,0,1]
    s_cmp_lg_u64 s[80:81], 0
    s_cbranch_scc1 SA_F2
SA_G2:
    v_mov_b32 v31, 3
    ds_write_b32 v29, v31
    ds_read_b128 v[116:119], v30
    s_waitcnt lgkmcnt(0)
    v_min_u32 v116, v116, v117
    v_min3_u32 v116, v116, v118, v119
    v_cmp_gt_u32 vcc, v31, v116
    s_nop 1
    s_cbranch_vccnz CS_165
CR_166:
    s_setprio 2
    s_waitcnt vmcnt(0)
    ds_read_b64_tr_b16 v[116:117], v4 offset:0
    ds_read_b64_tr_b16 v[118:119], v5 offset:0
    ds_read_b64_tr_b16 v[120:121], v4 offset:4096
    ds_read_b64_tr_b16 v[122:123], v5 offset:4096
    ds_read_b64_tr_b16 v[124:125], v4 offset:8192
    ds_read_b64_tr_b16 v[126:127], v5 offset:8192
    ds_read_b64_tr_b16 v[128:129], v4 offset:12288
    ds_read_b64_tr_b16 v[130:131], v5 offset:12288
    ds_read_b64_tr_b16 v[132:133], v4 offset:16384
    ds_read_b64_tr_b16 v[134:135], v5 offset:16384
    s_waitcnt lgkmcnt(8)
    v_lshlrev_b32 v36, 16, v116
    v_and_b32 v37, s59, v116
    v_lshlrev_b32 v38, 16, v117
    v_and_b32 v39, s59, v117
    v_lshlrev_b32 v40, 16, v118
    v_and_b32 v41, s59, v118
    v_lshlrev_b32 v42, 16, v119
    v_and_b32 v43, s59, v119
    v_pk_fma_f32 v[216:217], v[76:77], v[36:37], v[216:217]
    v_pk_fma_f32 v[218:219], v[78:79], v[38:39], v[218:219]
    v_pk_fma_f32 v[220:221], v[80:81], v[40:41], v[220:221]
    v_pk_fma_f32 v[222:223], v[82:83], v[42:43], v[222:223]
    v_pk_mul_f32 v[26:27], v[216:217], v[216:217]
    v_pk_add_f32 v[24:25], v[216:217], v[218:219]
    v_pk_fma_f32 v[26:27], v[218:219], v[218:219], v[26:27]
    v_pk_add_f32 v[24:25], v[24:25], v[220:221]
    v_pk_fma_f32 v[26:27], v[220:221], v[220:221], v[26:27]
    v_pk_add_f32 v[24:25], v[24:25], v[222:223]
    v_pk_fma_f32 v[26:27], v[222:223], v[222:223], v[26:27]
    s_waitcnt lgkmcnt(6)
    v_lshlrev_b32 v44, 16, v120
    v_and_b32 v45, s59, v120
    v_lshlrev_b32 v46, 16, v121
    v_and_b32 v47, s59, v121
    v_lshlrev_b32 v48, 16, v122
    v_and_b32 v49, s59, v122
    v_lshlrev_b32 v50, 16, v123
    v_and_b32 v51, s59, v123
    v_pk_fma_f32 v[224:225], v[84:85], v[44:45], v[224:225]
    v_pk_fma_f32 v[226:227], v[86:87], v[46:47], v[226:227]
    v_pk_fma_f32 v[228:229], v[88:89], v[48:49], v[228:229]
    v_pk_fma_f32 v[230:231], v[90:91], v[50:51], v[230:231]
    v_pk_add_f32 v[24:25], v[24:25], v[224:225]
    v_pk_fma_f32 v[26:27], v[224:225], v[224:225], v[26:27]
    v_pk_add_f32 v[24:25], v[24:25], v[226:227]
    v_pk_fma_f32 v[26:27], v[226:227], v[226:227], v[26:27]
    v_pk_add_f32 v[24:25], v[24:25], v[228:229]
    v_pk_fma_f32 v[26:27], v[228:229], v[228:229], v[26:27]
    v_pk_add_f32 v[24:25], v[24:25], v[230:231]
    v_pk_fma_f32 v[26:27], v[230:231], v[230:231], v[26:27]
    s_waitcnt lgkmcnt(4)
    v_lshlrev_b32 v52, 16, v124
    v_and_b32 v53, s59, v124
    v_lshlrev_b32 v54, 16, v125
    v_and_b32 v55, s59, v125
    v_lshlrev_b32 v56, 16, v126
    v_and_b32 v57, s59, v126
    v_lshlrev_b32 v58, 16, v127
    v_and_b32 v59, s59, v127
    v_pk_fma_f32 v[232:233], v[92:93], v[52:53], v[232:233]
    v_pk_fma_f32 v[234:235], v[94:95], v[54:55], v[234:235]
    v_pk_fma_f32 v[236:237], v[96:97], v[56:57], v[236:237]
    v_pk_fma_f32 v[238:239], v[98:99], v[58:59], v[238:239]
    v_pk_add_f32 v[24:25], v[24:25], v[232:233]
    v_pk_fma_f32 v[26:27], v[232:233], v[232:233], v[26:27]
    v_pk_add_f32 v[24:25], v[24:25], v[234:235]
    v_pk_fma_f32 v[26:27], v[234:235], v[234:235], v[26:27]
    v_pk_add_f32 v[24:25], v[24:25], v[236:237]
    v_pk_fma_f32 v[26:27], v[236:237], v[236:237], v[26:27]
    v_pk_add_f32 v[24:25], v[24:25], v[238:239]
    v_pk_fma_f32 v[26:27], v[238:239], v[238:239], v[26:27]
    s_waitcnt lgkmcnt(2)
    v_lshlrev_b32 v60, 16, v128
    v_and_b32 v61, s59, v128
    v_lshlrev_b32 v62, 16, v129
    v_and_b32 v63, s59, v129
    v_lshlrev_b32 v64, 16, v130
    v_and_b32 v65, s59, v130
    v_lshlrev_b32 v66, 16, v131
    v_and_b32 v67, s59, v131
    v_pk_fma_f32 v[240:241], v[100:101], v[60:61], v[240:241]
    v_pk_fma_f32 v[242:243], v[102:103], v[62:63], v[242:243]
    v_pk_fma_f32 v[244:245], v[104:105], v[64:65], v[244:245]
    v_pk_fma_f32 v[246:247], v[106:107], v[66:67], v[246:247]
    v_pk_add_f32 v[24:25], v[24:25], v[240:241]
    v_pk_fma_f32 v[26:27], v[240:241], v[240:241], v[26:27]
    v_pk_add_f32 v[24:25], v[24:25], v[242:243]
    v_pk_fma_f32 v[26:27], v[242:243], v[242:243], v[26:27]
    v_pk_add_f32 v[24:25], v[24:25], v[244:245]
    v_pk_fma_f32 v[26:27], v[244:245], v[244:245], v[26:27]
    v_pk_add_f32 v[24:25], v[24:25], v[246:247]
    v_pk_fma_f32 v[26:27], v[246:247], v[246:247], v[26:27]
    s_waitcnt lgkmcnt(0)
    v_lshlrev_b32 v68, 16, v132
    v_and_b32 v69, s59, v132
    v_lshlrev_b32 v70, 16, v133
    v_and_b32 v71, s59, v133
    v_lshlrev_b32 v72, 16, v134
    v_and_b32 v73, s59, v134
    v_lshlrev_b32 v74, 16, v135
    v_and_b32 v75, s59, v135
    v_pk_fma_f32 v[248:249], v[108:109], v[68:69], v[248:249]
    v_pk_fma_f32 v[250:251], v[110:111], v[70:71], v[250:251]
    v_pk_fma_f32 v[252:253], v[112:113], v[72:73], v[252:253]
    v_pk_fma_f32 v[254:255], v[114:115], v[74:75], v[254:255]
    v_pk_add_f32 v[24:25], v[24:25], v[248:249]
    v_pk_fma_f32 v[26:27], v[248:249], v[248:249], v[26:27]
    v_pk_add_f32 v[24:25], v[24:25], v[250:251]
    v_pk_fma_f32 v[26:27], v[250:251], v[250:251], v[26:27]
    v_pk_add_f32 v[24:25], v[24:25], v[252:253]
    v_pk_fma_f32 v[26:27], v[252:253], v[252:253], v[26:27]
    v_pk_add_f32 v[24:25], v[24:25], v[254:255]
    v_pk_fma_f32 v[26:27], v[254:255], v[254:255], v[26:27]
    v_add_f32 v24, v24, v25
    v_add_f32 v26, v26, v27
    s_nop 1
    v_permlane32_swap_b32 v24, v26
    v_add_f32 v24, v24, v26
    v_mov_b32 v26, v24
    s_nop 1
    v_permlane16_swap_b32 v24, v26
    v_add_f32 v24, v24, v26
    s_nop 1
    v_add_f32 v24, v24, v24 row_ror:8 row_mask:0xf bank_mask:0xf
    s_nop 1
    v_add_f32 v24, v24, v24 row_ror:4 row_mask:0xf bank_mask:0xf
    v_mul_f32 v24, s60, v24
    v_mov_b32 v26, v24
    s_nop 1
    v_permlane32_swap_b32 v24, v26
    v_fma_f32 v26, -v24, v24, v26
    v_max_f32 v26, 0, v26
    v_add_f32 v14, s61, v26
    v_rsq_f32 v14, v14
    s_nop 0
    v_mul_f32 v26, v26, v14
    v_fma_f32 v26, v26, v14, s61
    v_mul_f32 v14, s62, v14
    v_rsq_f32 v26, v26
    s_nop 0
    v_mul_f32 v14, v14, v26
    v_mul_f32_e64 v15, -v24, v14
    s_setprio 3
    s_mul_i32 s66, s76, 40960
    s_add_u32 s66, s66, 0x1000000
    s_lshl_b32 s68, s74, 5
    s_add_u32 s68, s68, s79
    v_mov_b32 v13, s53
    v_pk_fma_f32 v[76:77], v[216:217], v[14:15], v[14:15] op_sel:[0,0,1] op_sel_hi:[1,0,1]
    v_pk_fma_f32 v[78:79], v[218:219], v[14:15], v[14:15] op_sel:[0,0,1] op_sel_hi:[1,0,1]
    v_pk_fma_f32 v[80:81], v[220:221], v[14:15], v[14:15] op_sel:[0,0,1] op_sel_hi:[1,0,1]
    v_pk_fma_f32 v[82:83], v[222:223], v[14:15], v[14:15] op_sel:[0,0,1] op_sel_hi:[1,0,1]
    v_cvt_pk_bf16_f32 v116, v76, v77
    v_cvt_pk_bf16_f32 v117, v78, v79
    v_cvt_pk_bf16_f32 v118, v80, v81
    v_cvt_pk_bf16_f32 v119, v82, v83
    v_bfi_b32 v116, s77, 1, v116
    s_cmp_lg_u32 s55, 0
    s_cbranch_scc1 BS_167
    buffer_store_dwordx4 v[116:119], v0, s[32:35], s66 offen
BR_168:
    s_add_u32 s66, s66, 8192
    v_pk_fma_f32 v[84:85], v[224:225], v[14:15], v[14:15] op_sel:[0,0,1] op_sel_hi:[1,0,1]
    v_pk_fma_f32 v[86:87], v[226:227], v[14:15], v[14:15] op_sel:[0,0,1] op_sel_hi:[1,0,1]
    v_pk_fma_f32 v[88:89], v[228:229], v[14:15], v[14:15] op_sel:[0,0,1] op_sel_hi:[1,0,1]
    v_pk_fma_f32 v[90:91], v[230:231], v[14:15], v[14:15] op_sel:[0,0,1] op_sel_hi:[1,0,1]
    v_cvt_pk_bf16_f32 v120, v84, v85
    v_cvt_pk_bf16_f32 v121, v86, v87
    v_cvt_pk_bf16_f32 v122, v88, v89
    v_cvt_pk_bf16_f32 v123, v90, v91
    v_bfi_b32 v120, s77, 1, v120
    s_cmp_lg_u32 s55, 0
    s_cbranch_scc1 BS_169
    buffer_store_dwordx4 v[120:123], v0, s[32:35], s66 offen
BR_170:
    s_add_u32 s66, s66, 8192
    v_pk_fma_f32 v[92:93], v[232:233], v[14:15], v[14:15] op_sel:[0,0,1] op_sel_hi:[1,0,1]
    v_pk_fma_f32 v[94:95], v[234:235], v[14:15], v[14:15] op_sel:[0,0,1] op_sel_hi:[1,0,1]
    v_pk_fma_f32 v[96:97], v[236:237], v[14:15], v[14:15] op_sel:[0,0,1] op_sel_hi:[1,0,1]
    v_pk_fma_f32 v[98:99], v[238:239], v[14:15], v[14:15] op_sel:[0,0,1] op_sel_hi:[1,0,1]
    v_cvt_pk_bf16_f32 v124, v92, v93
    v_cvt_pk_bf16_f32 v125, v94, v95
    v_cvt_pk_bf16_f32 v126, v96, v97
    v_cvt_pk_bf16_f32 v127, v98, v99
    v_bfi_b32 v124, s77, 1, v124
    s_cmp_lg_u32 s55, 0
    s_cbranch_scc1 BS_171
    buffer_store_dwordx4 v[124:127], v0, s[32:35], s66 offen
BR_172:
    s_add_u32 s66, s66, 8192
    v_pk_fma_f32 v[100:101], v[240:241], v[14:15], v[14:15] op_sel:[0,0,1] op_sel_hi:[1,0,1]
    v_pk_fma_f32 v[102:103], v[242:243], v[14:15], v[14:15] op_sel:[0,0,1] op_sel_hi:[1,0,1]
    v_pk_fma_f32 v[104:105], v[244:245], v[14:15], v[14:15] op_sel:[0,0,1] op_sel_hi:[1,0,1]
    v_pk_fma_f32 v[106:107], v[246:247], v[14:15], v[14:15] op_sel:[0,0,1] op_sel_hi:[1,0,1]
    v_cvt_pk_bf16_f32 v128, v100, v101
    v_cvt_pk_bf16_f32 v129, v102, v103
    v_cvt_pk_bf16_f32 v130, v104, v105
    v_cvt_pk_bf16_f32 v131, v106, v107
    v_bfi_b32 v128, s77, 1, v128
    s_cmp_lg_u32 s55, 0
    s_cbranch_scc1 BS_173
    buffer_store_dwordx4 v[128:131], v0, s[32:35], s66 offen
BR_174:
    s_add_u32 s66, s66, 8192
    v_pk_fma_f32 v[108:109], v[248:249], v[14:15], v[14:15] op_sel:[0,0,1] op_sel_hi:[1,0,1]
    v_pk_fma_f32 v[110:111], v[250:251], v[14:15], v[14:15] op_sel:[0,0,1] op_sel_hi:[1,0,1]
    v_pk_fma_f32 v[112:113], v[252:253], v[14:15], v[14:15] op_sel:[0,0,1] op_sel_hi:[1,0,1]
    v_pk_fma_f32 v[114:115], v[254:255], v[14:15], v[14:15] op_sel:[0,0,1] op_sel_hi:[1,0,1]
    v_cvt_pk_bf16_f32 v132, v108, v109
    v_cvt_pk_bf16_f32 v133, v110, v111
    v_cvt_pk_bf16_f32 v134, v112, v113
    v_cvt_pk_bf16_f32 v135, v114, v115
    v_bfi_b32 v132, s77, 1, v132
    s_cmp_lg_u32 s55, 0
    s_cbranch_scc1 BS_175
    buffer_store_dwordx4 v[132:135], v0, s[32:35], s66 offen
    buffer_store_dword v13, v11, s[32:35], s68 offen offset:0
BR_176:
    s_setprio 0
SA_END:
    s_add_u32 s74, s70, 0
    s_add_u32 s75, s72, 0
    v_add_u32 v4, s75, v6
    v_xor_b32 v5, 0x80, v4
    s_lshl_b32 s76, s28, 3
    s_add_u32 s76, s76, s74
    ds_read_b64_tr_b16 v[116:117], v4 offset:0
    ds_read_b64_tr_b16 v[118:119], v5 offset:0
    ds_read_b64_tr_b16 v[120:121], v4 offset:4096
    ds_read_b64_tr_b16 v[122:123], v5 offset:4096
    ds_read_b64_tr_b16 v[124:125], v4 offset:8192
    ds_read_b64_tr_b16 v[126:127], v5 offset:8192
    ds_read_b64_tr_b16 v[128:129], v4 offset:12288
    ds_read_b64_tr_b16 v[130:131], v5 offset:12288
    ds_read_b64_tr_b16 v[132:133], v4 offset:16384
    ds_read_b64_tr_b16 v[134:135], v5 offset:16384
    s_waitcnt lgkmcnt(8)
    v_lshlrev_b32 v36, 16, v116
    v_and_b32 v37, s59, v116
    v_lshlrev_b32 v38, 16, v117
    v_and_b32 v39, s59, v117
    v_lshlrev_b32 v40, 16, v118
    v_and_b32 v41, s59, v118
    v_lshlrev_b32 v42, 16, v119
    v_and_b32 v43, s59, v119
    s_waitcnt lgkmcnt(6)
    v_lshlrev_b32 v44, 16, v120
    v_and_b32 v45, s59, v120
    v_lshlrev_b32 v46, 16, v121
    v_and_b32 v47, s59, v121
    v_lshlrev_b32 v48, 16, v122
    v_and_b32 v49, s59, v122
    v_lshlrev_b32 v50, 16, v123
    v_and_b32 v51, s59, v123
    s_waitcnt lgkmcnt(4)
    v_lshlrev_b32 v52, 16, v124
    v_and_b32 v53, s59, v124
    v_lshlrev_b32 v54, 16, v125
    v_and_b32 v55, s59, v125
    v_lshlrev_b32 v56, 16, v126
    v_and_b32 v57, s59, v126
    v_lshlrev_b32 v58, 16, v127
    v_and_b32 v59, s59, v127
    s_waitcnt lgkmcnt(2)
    v_lshlrev_b32 v60, 16, v128
    v_and_b32 v61, s59, v128
    v_lshlrev_b32 v62, 16, v129
    v_and_b32 v63, s59, v129
    v_lshlrev_b32 v64, 16, v130
    v_and_b32 v65, s59, v130
    v_lshlrev_b32 v66, 16, v131
    v_and_b32 v67, s59, v131
    s_waitcnt lgkmcnt(0)
    v_lshlrev_b32 v68, 16, v132
    v_and_b32 v69, s59, v132
    v_lshlrev_b32 v70, 16, v133
    v_and_b32 v71, s59, v133
    v_lshlrev_b32 v72, 16, v134
    v_and_b32 v73, s59, v134
    v_lshlrev_b32 v74, 16, v135
    v_and_b32 v75, s59, v135
    s_lshl_b32 s66, s28, 13
    s_lshl_b32 s67, s74, 8
    s_add_u32 s66, s66, s67
    s_add_u32 s66, s66, 131072
    s_lshl_b32 s63, s74, 1
    s_lshr_b32 s63, 0xe4e4, s63
    s_and_b32 s63, s63, 3
    s_mul_i32 s63, s63, 122880
    s_mul_i32 s67, s28, 835584
    s_add_u32 s67, s67, s63
    s_add_u32 s67, s67, 0x1454000
    s_bitcmp1_b32 0xf0f0, s74
    s_cselect_b32 s80, 1, 0x10000
    s_and_b32 s63, s79, 31
    s_add_u32 s81, s66, s63
    s_add_u32 s81, s81, 5120
    s_add_u32 s68, s67, 40960
    s_add_u32 s69, s67, 81920
    s_mov_b32 s58, 0
PL_177:
    buffer_load_dword v13, v12, s[32:35], s66 offen sc1
    s_add_u32 s58, s58, 1
    s_waitcnt vmcnt(0)
    v_cmp_ne_u32 vcc, s53, v13
    s_nop 1
    s_cbranch_vccz PD_178
    s_cmp_lt_u32 s58, s57
    s_cbranch_scc1 PL_177
    s_mov_b32 s57, 0
PD_178:
    s_setprio 1
ML_179:
    buffer_load_dwordx4 v[76:79], v0, s[32:35], s67 offen sc1
    s_add_u32 s67, s67, 8192
    buffer_load_dwordx4 v[80:83], v0, s[32:35], s68 offen sc1
    s_add_u32 s68, s68, 8192
    buffer_load_dwordx4 v[84:87], v0, s[32:35], s69 offen sc1
    s_add_u32 s69, s69, 8192
    buffer_load_dwordx4 v[88:91], v0, s[32:35], s67 offen sc1
    s_add_u32 s67, s67, 8192
    buffer_load_dwordx4 v[92:95], v0, s[32:35], s68 offen sc1
    s_add_u32 s68, s68, 8192
    buffer_load_dwordx4 v[96:99], v0, s[32:35], s69 offen sc1
    s_add_u32 s69, s69, 8192
    buffer_load_dwordx4 v[100:103], v0, s[32:35], s67 offen sc1
    s_add_u32 s67, s67, 8192
    buffer_load_dwordx4 v[104:107], v0, s[32:35], s68 offen sc1
    s_add_u32 s68, s68, 8192
    buffer_load_dwordx4 v[108:111], v0, s[32:35], s69 offen sc1
    s_add_u32 s69, s69, 8192
    buffer_load_dwordx4 v[112:115], v0, s[32:35], s67 offen sc1
    s_add_u32 s67, s67, 8192
    buffer_load_dwordx4 v[116:119], v0, s[32:35], s68 offen sc1
    s_add_u32 s68, s68, 8192
    buffer_load_dwordx4 v[120:123], v0, s[32:35], s69 offen sc1
    s_add_u32 s69, s69, 8192
    buffer_load_dwordx4 v[124:127], v0, s[32:35], s67 offen sc1
    buffer_load_dwordx4 v[128:131], v0, s[32:35], s68 offen sc1
    buffer_load_dwordx4 v[132:135], v0, s[32:35], s69 offen sc1
    s_waitcnt vmcnt(14)
    v_dot2c_f32_bf16 v136, s89, v76
    v_dot2c_f32_bf16 v137, s90, v76
    v_dot2c_f32_bf16 v138, s89, v77
    v_dot2c_f32_bf16 v139, s90, v77
    v_dot2c_f32_bf16 v140, s89, v78
    v_dot2c_f32_bf16 v141, s90, v78
    v_dot2c_f32_bf16 v142, s89, v79
    v_dot2c_f32_bf16 v143, s90, v79
    s_waitcnt vmcnt(13)
    v_dot2c_f32_bf16 v136, s89, v80
    v_dot2c_f32_bf16 v137, s90, v80
    v_dot2c_f32_bf16 v138, s89, v81
    v_dot2c_f32_bf16 v139, s90, v81
    v_dot2c_f32_bf16 v140, s89, v82
    v_dot2c_f32_bf16 v141, s90, v82
    v_dot2c_f32_bf16 v142, s89, v83
    v_dot2c_f32_bf16 v143, s90, v83
    s_waitcnt vmcnt(12)
    v_or3_b32 v13, v76, v80, v84
    v_dot2c_f32_bf16 v136, s89, v84
    v_dot2c_f32_bf16 v137, s90, v84
    v_dot2c_f32_bf16 v138, s89, v85
    v_dot2c_f32_bf16 v139, s90, v85
    v_dot2c_f32_bf16 v140, s89, v86
    v_dot2c_f32_bf16 v141, s90, v86
    v_dot2c_f32_bf16 v142, s89, v87
    v_dot2c_f32_bf16 v143, s90, v87
    v_pk_mul_f32 v[26:27], v[136:137], v[136:137]
    v_pk_add_f32 v[24:25], v[136:137], v[138:139]
    v_pk_fma_f32 v[26:27], v[138:139], v[138:139], v[26:27]
    v_pk_add_f32 v[24:25], v[24:25], v[140:141]
    v_pk_fma_f32 v[26:27], v[140:141], v[140:141], v[26:27]
    v_pk_add_f32 v[24:25], v[24:25], v[142:143]
    v_pk_fma_f32 v[26:27], v[142:143], v[142:143], v[26:27]
    s_waitcnt vmcnt(11)
    v_dot2c_f32_bf16 v144, s89, v88
    v_dot2c_f32_bf16 v145, s90, v88
    v_dot2c_f32_bf16 v146, s89, v89
    v_dot2c_f32_bf16 v147, s90, v89
    v_dot2c_f32_bf16 v148, s89, v90
    v_dot2c_f32_bf16 v149, s90, v90
    v_dot2c_f32_bf16 v150, s89, v91
    v_dot2c_f32_bf16 v151, s90, v91
    s_waitcnt vmcnt(10)
    v_or3_b32 v13, v13, v88, v92
    v_dot2c_f32_bf16 v144, s89, v92
    v_dot2c_f32_bf16 v145, s90, v92
    v_dot2c_f32_bf16 v146, s89, v93
    v_dot2c_f32_bf16 v147, s90, v93
    v_dot2c_f32_bf16 v148, s89, v94
    v_dot2c_f32_bf16 v149, s90, v94
    v_dot2c_f32_bf16 v150, s89, v95
    v_dot2c_f32_bf16 v151, s90, v95
    s_waitcnt vmcnt(9)
    v_dot2c_f32_bf16 v144, s89, v96
    v_dot2c_f32_bf16 v145, s90, v96
    v_dot2c_f32_bf16 v146, s89, v97
    v_dot2c_f32_bf16 v147, s90, v97
    v_dot2c_f32_bf16 v148, s89, v98
    v_dot2c_f32_bf16 v149, s90, v98
    v_dot2c_f32_bf16 v150, s89, v99
    v_dot2c_f32_bf16 v151, s90, v99
    v_pk_add_f32 v[24:25], v[24:25], v[144:145]
    v_pk_fma_f32 v[26:27], v[144:145], v[144:145], v[26:27]
    v_pk_add_f32 v[24:25], v[24:25], v[146:147]
    v_pk_fma_f32 v[26:27], v[146:147], v[146:147], v[26:27]
    v_pk_add_f32 v[24:25], v[24:25], v[148:149]
    v_pk_fma_f32 v[26:27], v[148:149], v[148:149], v[26:27]
    v_pk_add_f32 v[24:25], v[24:25], v[150:151]
    v_pk_fma_f32 v[26:27], v[150:151], v[150:151], v[26:27]
    s_waitcnt vmcnt(8)
    v_or3_b32 v13, v13, v96, v100
    v_dot2c_f32_bf16 v152, s89, v100
    v_dot2c_f32_bf16 v153, s90, v100
    v_dot2c_f32_bf16 v154, s89, v101
    v_dot2c_f32_bf16 v155, s90, v101
    v_dot2c_f32_bf16 v156, s89, v102
    v_dot2c_f32_bf16 v157, s90, v102
    v_dot2c_f32_bf16 v158, s89, v103
    v_dot2c_f32_bf16 v159, s90, v103
    s_waitcnt vmcnt(7)
    v_dot2c_f32_bf16 v152, s89, v104
    v_dot2c_f32_bf16 v153, s90, v104
    v_dot2c_f32_bf16 v154, s89, v105
    v_dot2c_f32_bf16 v155, s90, v105
    v_dot2c_f32_bf16 v156, s89, v106
    v_dot2c_f32_bf16 v157, s90, v106
    v_dot2c_f32_bf16 v158, s89, v107
    v_dot2c_f32_bf16 v159, s90, v107
    s_waitcnt vmcnt(6)
    v_or3_b32 v13, v13, v104, v108
    v_dot2c_f32_bf16 v152, s89, v108
    v_dot2c_f32_bf16 v153, s90, v108
    v_dot2c_f32_bf16 v154, s89, v109
    v_dot2c_f32_bf16 v155, s90, v109
    v_dot2c_f32_bf16 v156, s89, v110
    v_dot2c_f32_bf16 v157, s90, v110
    v_dot2c_f32_bf16 v158, s89, v111
    v_dot2c_f32_bf16 v159, s90, v111
    v_pk_add_f32 v[24:25], v[24:25], v[152:153]
    v_pk_fma_f32 v[26:27], v[152:153], v[152:153], v[26:27]
    v_pk_add_f32 v[24:25], v[24:25], v[154:155]
    v_pk_fma_f32 v[26:27], v[154:155], v[154:155], v[26:27]
    v_pk_add_f32 v[24:25], v[24:25], v[156:157]
    v_pk_fma_f32 v[26:27], v[156:157], v[156:157], v[26:27]
    v_pk_add_f32 v[24:25], v[24:25], v[158:159]
    v_pk_fma_f32 v[26:27], v[158:159], v[158:159], v[26:27]
    s_waitcnt vmcnt(5)
    v_dot2c_f32_bf16 v160, s89, v112
    v_dot2c_f32_bf16 v161, s90, v112
    v_dot2c_f32_bf16 v162, s89, v113
    v_dot2c_f32_bf16 v163, s90, v113
    v_dot2c_f32_bf16 v164, s89, v114
    v_dot2c_f32_bf16 v165, s90, v114
    v_dot2c_f32_bf16 v166, s89, v115
    v_dot2c_f32_bf16 v167, s90, v115
    s_waitcnt vmcnt(4)
    v_or3_b32 v13, v13, v112, v116
    v_dot2c_f32_bf16 v160, s89, v116
    v_dot2c_f32_bf16 v161, s90, v116
    v_dot2c_f32_bf16 v162, s89, v117
    v_dot2c_f32_bf16 v163, s90, v117
    v_dot2c_f32_bf16 v164, s89, v118
    v_dot2c_f32_bf16 v165, s90, v118
    v_dot2c_f32_bf16 v166, s89, v119
    v_dot2c_f32_bf16 v167, s90, v119
    s_waitcnt vmcnt(3)
    v_dot2c_f32_bf16 v160, s89, v120
    v_dot2c_f32_bf16 v161, s90, v120
    v_dot2c_f32_bf16 v162, s89, v121
    v_dot2c_f32_bf16 v163, s90, v121
    v_dot2c_f32_bf16 v164, s89, v122
    v_dot2c_f32_bf16 v165, s90, v122
    v_dot2c_f32_bf16 v166, s89, v123
    v_dot2c_f32_bf16 v167, s90, v123
    v_pk_add_f32 v[24:25], v[24:25], v[160:161]
    v_pk_fma_f32 v[26:27], v[160:161], v[160:161], v[26:27]
    v_pk_add_f32 v[24:25], v[24:25], v[162:163]
    v_pk_fma_f32 v[26:27], v[162:163], v[162:163], v[26:27]
    v_pk_add_f32 v[24:25], v[24:25], v[164:165]
    v_pk_fma_f32 v[26:27], v[164:165], v[164:165], v[26:27]
    v_pk_add_f32 v[24:25], v[24:25], v[166:167]
    v_pk_fma_f32 v[26:27], v[166:167], v[166:167], v[26:27]
    s_waitcnt vmcnt(2)
    v_or3_b32 v13, v13, v120, v124
    v_dot2c_f32_bf16 v168, s89, v124
    v_dot2c_f32_bf16 v169, s90, v124
    v_dot2c_f32_bf16 v170, s89, v125
    v_dot2c_f32_bf16 v171, s90, v125
    v_dot2c_f32_bf16 v172, s89, v126
    v_dot2c_f32_bf16 v173, s90, v126
    v_dot2c_f32_bf16 v174, s89, v127
    v_dot2c_f32_bf16 v175, s90, v127
    s_waitcnt vmcnt(1)
    v_dot2c_f32_bf16 v168, s89, v128
    v_dot2c_f32_bf16 v169, s90, v128
    v_dot2c_f32_bf16 v170, s89, v129
    v_dot2c_f32_bf16 v171, s90, v129
    v_dot2c_f32_bf16 v172, s89, v130
    v_dot2c_f32_bf16 v173, s90, v130
    v_dot2c_f32_bf16 v174, s89, v131
    v_dot2c_f32_bf16 v175, s90, v131
    s_waitcnt vmcnt(0)
    v_or3_b32 v13, v13, v128, v132
    v_and_b32 v13, s80, v13
    v_cmp_ne_u32 vcc, 0, v13
    v_dot2c_f32_bf16 v168, s89, v132
    v_dot2c_f32_bf16 v169, s90, v132
    v_dot2c_f32_bf16 v170, s89, v133
    v_dot2c_f32_bf16 v171, s90, v133
    v_dot2c_f32_bf16 v172, s89, v134
    v_dot2c_f32_bf16 v173, s90, v134
    v_dot2c_f32_bf16 v174, s89, v135
    v_dot2c_f32_bf16 v175, s90, v135
    s_cbranch_vccnz MF_180
MO_181:
    v_pk_add_f32 v[24:25], v[24:25], v[168:169]
    v_pk_fma_f32 v[26:27], v[168:169], v[168:169], v[26:27]
    v_pk_add_f32 v[24:25], v[24:25], v[170:171]
    v_pk_fma_f32 v[26:27], v[170:171], v[170:171], v[26:27]
    v_pk_add_f32 v[24:25], v[24:25], v[172:173]
    v_pk_fma_f32 v[26:27], v[172:173], v[172:173], v[26:27]
    v_pk_add_f32 v[24:25], v[24:25], v[174:175]
    v_pk_fma_f32 v[26:27], v[174:175], v[174:175], v[26:27]
    v_mov_b32 v13, s53
    s_cmp_lg_u32 s55, 0
    s_cbranch_scc1 BS_183
    buffer_store_dword v13, v11, s[32:35], s81 offen
BR_184:
MQ_182:
    s_setprio 2
    v_add_f32 v24, v24, v25
    v_add_f32 v26, v26, v27
    s_nop 1
    v_permlane32_swap_b32 v24, v26
    v_add_f32 v24, v24, v26
    v_mov_b32 v26, v24
    s_nop 1
    v_permlane16_swap_b32 v24, v26
    v_add_f32 v24, v24, v26
    s_nop 1
    v_add_f32 v24, v24, v24 row_ror:8 row_mask:0xf bank_mask:0xf
    s_nop 1
    v_add_f32 v24, v24, v24 row_ror:4 row_mask:0xf bank_mask:0xf
    v_mul_f32 v24, s60, v24
    v_mov_b32 v26, v24
    s_nop 1
    v_permlane32_swap_b32 v24, v26
    v_fma_f32 v26, -v24, v24, v26
    v_max_f32 v26, 0, v26
    v_add_f32 v14, s61, v26
    v_rsq_f32 v14, v14
    s_nop 0
    v_mul_f32_e64 v15, -v24, v14
    v_pk_fma_f32 v[76:77], v[136:137], v[14:15], v[14:15] op_sel:[0,0,1] op_sel_hi:[1,0,1]
    v_pk_fma_f32 v[78:79], v[138:139], v[14:15], v[14:15] op_sel:[0,0,1] op_sel_hi:[1,0,1]
    v_pk_fma_f32 v[80:81], v[140:141], v[14:15], v[14:15] op_sel:[0,0,1] op_sel_hi:[1,0,1]
    v_pk_fma_f32 v[82:83], v[142:143], v[14:15], v[14:15] op_sel:[0,0,1] op_sel_hi:[1,0,1]
    v_pk_fma_f32 v[136:137], v[76:77], v[36:37], v[136:137]
    v_pk_fma_f32 v[138:139], v[78:79], v[38:39], v[138:139]
    v_pk_fma_f32 v[140:141], v[80:81], v[40:41], v[140:141]
    v_pk_fma_f32 v[142:143], v[82:83], v[42:43], v[142:143]
    v_pk_mul_f32 v[26:27], v[136:137], v[136:137]
    v_pk_add_f32 v[24:25], v[136:137], v[138:139]
    v_pk_fma_f32 v[26:27], v[138:139], v[138:139], v[26:27]
    v_pk_add_f32 v[24:25], v[24:25], v[140:141]
    v_pk_fma_f32 v[26:27], v[140:141], v[140:141], v[26:27]
    v_pk_add_f32 v[24:25], v[24:25], v[142:143]
    v_pk_fma_f32 v[26:27], v[142:143], v[142:143], v[26:27]
    v_pk_fma_f32 v[84:85], v[144:145], v[14:15], v[14:15] op_sel:[0,0,1] op_sel_hi:[1,0,1]
    v_pk_fma_f32 v[86:87], v[146:147], v[14:15], v[14:15] op_sel:[0,0,1] op_sel_hi:[1,0,1]
    v_pk_fma_f32 v[88:89], v[148:149], v[14:15], v[14:15] op_sel:[0,0,1] op_sel_hi:[1,0,1]
    v_pk_fma_f32 v[90:91], v[150:151], v[14:15], v[14:15] op_sel:[0,0,1] op_sel_hi:[1,0,1]
    v_pk_fma_f32 v[144:145], v[84:85], v[44:45], v[144:145]
    v_pk_fma_f32 v[146:147], v[86:87], v[46:47], v[146:147]
    v_pk_fma_f32 v[148:149], v[88:89], v[48:49], v[148:149]
    v_pk_fma_f32 v[150:151], v[90:91], v[50:51], v[150:151]
    v_pk_add_f32 v[24:25], v[24:25], v[144:145]
    v_pk_fma_f32 v[26:27], v[144:145], v[144:145], v[26:27]
    v_pk_add_f32 v[24:25], v[24:25], v[146:147]
    v_pk_fma_f32 v[26:27], v[146:147], v[146:147], v[26:27]
    v_pk_add_f32 v[24:25], v[24:25], v[148:149]
    v_pk_fma_f32 v[26:27], v[148:149], v[148:149], v[26:27]
    v_pk_add_f32 v[24:25], v[24:25], v[150:151]
    v_pk_fma_f32 v[26:27], v[150:151], v[150:151], v[26:27]
    v_pk_fma_f32 v[92:93], v[152:153], v[14:15], v[14:15] op_sel:[0,0,1] op_sel_hi:[1,0,1]
    v_pk_fma_f32 v[94:95], v[154:155], v[14:15], v[14:15] op_sel:[0,0,1] op_sel_hi:[1,0,1]
    v_pk_fma_f32 v[96:97], v[156:157], v[14:15], v[14:15] op_sel:[0,0,1] op_sel_hi:[1,0,1]
    v_pk_fma_f32 v[98:99], v[158:159], v[14:15], v[14:15] op_sel:[0,0,1] op_sel_hi:[1,0,1]
    v_pk_fma_f32 v[152:153], v[92:93], v[52:53], v[152:153]
    v_pk_fma_f32 v[154:155], v[94:95], v[54:55], v[154:155]
    v_pk_fma_f32 v[156:157], v[96:97], v[56:57], v[156:157]
    v_pk_fma_f32 v[158:159], v[98:99], v[58:59], v[158:159]
    v_pk_add_f32 v[24:25], v[24:25], v[152:153]
    v_pk_fma_f32 v[26:27], v[152:153], v[152:153], v[26:27]
    v_pk_add_f32 v[24:25], v[24:25], v[154:155]
    v_pk_fma_f32 v[26:27], v[154:155], v[154:155], v[26:27]
    v_pk_add_f32 v[24:25], v[24:25], v[156:157]
    v_pk_fma_f32 v[26:27], v[156:157], v[156:157], v[26:27]
    v_pk_add_f32 v[24:25], v[24:25], v[158:159]
    v_pk_fma_f32 v[26:27], v[158:159], v[158:159], v[26:27]
    v_pk_fma_f32 v[100:101], v[160:161], v[14:15], v[14:15] op_sel:[0,0,1] op_sel_hi:[1,0,1]
    v_pk_fma_f32 v[102:103], v[162:163], v[14:15], v[14:15] op_sel:[0,0,1] op_sel_hi:[1,0,1]
    v_pk_fma_f32 v[104:105], v[164:165], v[14:15], v[14:15] op_sel:[0,0,1] op_sel_hi:[1,0,1]
    v_pk_fma_f32 v[106:107], v[166:167], v[14:15], v[14:15] op_sel:[0,0,1] op_sel_hi:[1,0,1]
    v_pk_fma_f32 v[160:161], v[100:101], v[60:61], v[160:161]
    v_pk_fma_f32 v[162:163], v[102:103], v[62:63], v[162:163]
    v_pk_fma_f32 v[164:165], v[104:105], v[64:65], v[164:165]
    v_pk_fma_f32 v[166:167], v[106:107], v[66:67], v[166:167]
    v_pk_add_f32 v[24:25], v[24:25], v[160:161]
    v_pk_fma_f32 v[26:27], v[160:161], v[160:161], v[26:27]
    v_pk_add_f32 v[24:25], v[24:25], v[162:163]
    v_pk_fma_f32 v[26:27], v[162:163], v[162:163], v[26:27]
    v_pk_add_f32 v[24:25], v[24:25], v[164:165]
    v_pk_fma_f32 v[26:27], v[164:165], v[164:165], v[26:27]
    v_pk_add_f32 v[24:25], v[24:25], v[166:167]
    v_pk_fma_f32 v[26:27], v[166:167], v[166:167], v[26:27]
    v_pk_fma_f32 v[108:109], v[168:169], v[14:15], v[14:15] op_sel:[0,0,1] op_sel_hi:[1,0,1]
    v_pk_fma_f32 v[110:111], v[170:171], v[14:15], v[14:15] op_sel:[0,0,1] op_sel_hi:[1,0,1]
    v_pk_fma_f32 v[112:113], v[172:173], v[14:15], v[14:15] op_sel:[0,0,1] op_sel_hi:[1,0,1]
    v_pk_fma_f32 v[114:115], v[174:175], v[14:15], v[14:15] op_sel:[0,0,1] op_sel_hi:[1,0,1]
    v_pk_fma_f32 v[168:169], v[108:109], v[68:69], v[168:169]
    v_pk_fma_f32 v[170:171], v[110:111], v[70:71], v[170:171]
    v_pk_fma_f32 v[172:173], v[112:113], v[72:73], v[172:173]
    v_pk_fma_f32 v[174:175], v[114:115], v[74:75], v[174:175]
    v_pk_add_f32 v[24:25], v[24:25], v[168:169]
    v_pk_fma_f32 v[26:27], v[168:169], v[168:169], v[26:27]
    v_pk_add_f32 v[24:25], v[24:25], v[170:171]
    v_pk_fma_f32 v[26:27], v[170:171], v[170:171], v[26:27]
    v_pk_add_f32 v[24:25], v[24:25], v[172:173]
    v_pk_fma_f32 v[26:27], v[172:173], v[172:173], v[26:27]
    v_pk_add_f32 v[24:25], v[24:25], v[174:175]
    v_pk_fma_f32 v[26:27], v[174:175], v[174:175], v[26:27]
    v_add_f32 v24, v24, v25
    v_add_f32 v26, v26, v27
    s_nop 1
    v_permlane32_swap_b32 v24, v26
    v_add_f32 v24, v24, v26
    v_mov_b32 v26, v24
    s_nop 1
    v_permlane16_swap_b32 v24, v26
    v_add_f32 v24, v24, v26
    s_nop 1
    v_add_f32 v24, v24, v24 row_ror:8 row_mask:0xf bank_mask:0xf
    s_nop 1
    v_add_f32 v24, v24, v24 row_ror:4 row_mask:0xf bank_mask:0xf
    v_mul_f32 v24, s60, v24
    v_mov_b32 v26, v24
    s_nop 1
    v_permlane32_swap_b32 v24, v26
    v_fma_f32 v26, -v24, v24, v26
    v_max_f32 v26, 0, v26
    v_add_f32 v14, s61, v26
    v_rsq_f32 v14, v14
    s_nop 0
    v_mul_f32 v26, v26, v14
    v_fma_f32 v26, v26, v14, s61
    v_mul_f32 v14, s62, v14
    v_rsq_f32 v26, v26
    s_nop 0
    v_mul_f32 v14, v14, v26
    v_mul_f32_e64 v15, -v24, v14
    s_setprio 3
    s_mul_i32 s66, s76, 40960
    s_add_u32 s66, s66, 0x1000000
    s_lshl_b32 s68, s74, 5
    s_add_u32 s68, s68, s79
    v_mov_b32 v13, s53
    v_pk_fma_f32 v[76:77], v[136:137], v[14:15], v[14:15] op_sel:[0,0,1] op_sel_hi:[1,0,1]
    v_pk_fma_f32 v[78:79], v[138:139], v[14:15], v[14:15] op_sel:[0,0,1] op_sel_hi:[1,0,1]
    v_pk_fma_f32 v[80:81], v[140:141], v[14:15], v[14:15] op_sel:[0,0,1] op_sel_hi:[1,0,1]
    v_pk_fma_f32 v[82:83], v[142:143], v[14:15], v[14:15] op_sel:[0,0,1] op_sel_hi:[1,0,1]
    v_cvt_pk_bf16_f32 v116, v76, v77
    v_cvt_pk_bf16_f32 v117, v78, v79
    v_cvt_pk_bf16_f32 v118, v80, v81
    v_cvt_pk_bf16_f32 v119, v82, v83
    v_and_b32 v116, -2, v116
    s_cmp_lg_u32 s55, 0
    s_cbranch_scc1 BS_185
    buffer_store_dwordx4 v[116:119], v0, s[32:35], s66 offen
BR_186:
    s_add_u32 s66, s66, 8192
    v_pk_fma_f32 v[84:85], v[144:145], v[14:15], v[14:15] op_sel:[0,0,1] op_sel_hi:[1,0,1]
    v_pk_fma_f32 v[86:87], v[146:147], v[14:15], v[14:15] op_sel:[0,0,1] op_sel_hi:[1,0,1]
    v_pk_fma_f32 v[88:89], v[148:149], v[14:15], v[14:15] op_sel:[0,0,1] op_sel_hi:[1,0,1]
    v_pk_fma_f32 v[90:91], v[150:151], v[14:15], v[14:15] op_sel:[0,0,1] op_sel_hi:[1,0,1]
    v_cvt_pk_bf16_f32 v120, v84, v85
    v_cvt_pk_bf16_f32 v121, v86, v87
    v_cvt_pk_bf16_f32 v122, v88, v89
    v_cvt_pk_bf16_f32 v123, v90, v91
    v_and_b32 v120, -2, v120
    s_cmp_lg_u32 s55, 0
    s_cbranch_scc1 BS_187
    buffer_store_dwordx4 v[120:123], v0, s[32:35], s66 offen
BR_188:
    s_add_u32 s66, s66, 8192
    v_pk_fma_f32 v[92:93], v[152:153], v[14:15], v[14:15] op_sel:[0,0,1] op_sel_hi:[1,0,1]
    v_pk_fma_f32 v[94:95], v[154:155], v[14:15], v[14:15] op_sel:[0,0,1] op_sel_hi:[1,0,1]
    v_pk_fma_f32 v[96:97], v[156:157], v[14:15], v[14:15] op_sel:[0,0,1] op_sel_hi:[1,0,1]
    v_pk_fma_f32 v[98:99], v[158:159], v[14:15], v[14:15] op_sel:[0,0,1] op_sel_hi:[1,0,1]
    v_cvt_pk_bf16_f32 v124, v92, v93
    v_cvt_pk_bf16_f32 v125, v94, v95
    v_cvt_pk_bf16_f32 v126, v96, v97
    v_cvt_pk_bf16_f32 v127, v98, v99
    v_and_b32 v124, -2, v124
    s_cmp_lg_u32 s55, 0
    s_cbranch_scc1 BS_189
    buffer_store_dwordx4 v[124:127], v0, s[32:35], s66 offen
BR_190:
    s_add_u32 s66, s66, 8192
    v_pk_fma_f32 v[100:101], v[160:161], v[14:15], v[14:15] op_sel:[0,0,1] op_sel_hi:[1,0,1]
    v_pk_fma_f32 v[102:103], v[162:163], v[14:15], v[14:15] op_sel:[0,0,1] op_sel_hi:[1,0,1]
    v_pk_fma_f32 v[104:105], v[164:165], v[14:15], v[14:15] op_sel:[0,0,1] op_sel_hi:[1,0,1]
    v_pk_fma_f32 v[106:107], v[166:167], v[14:15], v[14:15] op_sel:[0,0,1] op_sel_hi:[1,0,1]
    v_cvt_pk_bf16_f32 v128, v100, v101
    v_cvt_pk_bf16_f32 v129, v102, v103
    v_cvt_pk_bf16_f32 v130, v104, v105
    v_cvt_pk_bf16_f32 v131, v106, v107
    v_and_b32 v128, -2, v128
    s_cmp_lg_u32 s55, 0
    s_cbranch_scc1 BS_191
    buffer_store_dwordx4 v[128:131], v0, s[32:35], s66 offen
BR_192:
    s_add_u32 s66, s66, 8192
    v_pk_fma_f32 v[108:109], v[168:169], v[14:15], v[14:15] op_sel:[0,0,1] op_sel_hi:[1,0,1]
    v_pk_fma_f32 v[110:111], v[170:171], v[14:15], v[14:15] op_sel:[0,0,1] op_sel_hi:[1,0,1]
    v_pk_fma_f32 v[112:113], v[172:173], v[14:15], v[14:15] op_sel:[0,0,1] op_sel_hi:[1,0,1]
    v_pk_fma_f32 v[114:115], v[174:175], v[14:15], v[14:15] op_sel:[0,0,1] op_sel_hi:[1,0,1]
    v_cvt_pk_bf16_f32 v132, v108, v109
    v_cvt_pk_bf16_f32 v133, v110, v111
    v_cvt_pk_bf16_f32 v134, v112, v113
    v_cvt_pk_bf16_f32 v135, v114, v115
    v_and_b32 v132, -2, v132
    s_cmp_lg_u32 s55, 0
    s_cbranch_scc1 BS_193
    buffer_store_dwordx4 v[132:135], v0, s[32:35], s66 offen
    buffer_store_dword v13, v11, s[32:35], s68 offen offset:256
BR_194:
    s_setprio 0
    s_add_u32 s74, s70, 3
    s_add_u32 s75, s72, 40960
    v_add_u32 v4, s75, v6
    v_xor_b32 v5, 0x80, v4
    s_lshl_b32 s76, s28, 3
    s_add_u32 s76, s76, s74
    ds_read_b64_tr_b16 v[116:117], v4 offset:0
    ds_read_b64_tr_b16 v[118:119], v5 offset:0
    ds_read_b64_tr_b16 v[120:121], v4 offset:4096
    ds_read_b64_tr_b16 v[122:123], v5 offset:4096
    ds_read_b64_tr_b16 v[124:125], v4 offset:8192
    ds_read_b64_tr_b16 v[126:127], v5 offset:8192
    ds_read_b64_tr_b16 v[128:129], v4 offset:12288
    ds_read_b64_tr_b16 v[130:131], v5 offset:12288
    ds_read_b64_tr_b16 v[132:133], v4 offset:16384
    ds_read_b64_tr_b16 v[134:135], v5 offset:16384
    s_waitcnt lgkmcnt(8)
    v_lshlrev_b32 v36, 16, v116
    v_and_b32 v37, s59, v116
    v_lshlrev_b32 v38, 16, v117
    v_and_b32 v39, s59, v117
    v_lshlrev_b32 v40, 16, v118
    v_and_b32 v41, s59, v118
    v_lshlrev_b32 v42, 16, v119
    v_and_b32 v43, s59, v119
    s_waitcnt lgkmcnt(6)
    v_lshlrev_b32 v44, 16, v120
    v_and_b32 v45, s59, v120
    v_lshlrev_b32 v46, 16, v121
    v_and_b32 v47, s59, v121
    v_lshlrev_b32 v48, 16, v122
    v_and_b32 v49, s59, v122
    v_lshlrev_b32 v50, 16, v123
    v_and_b32 v51, s59, v123
    s_waitcnt lgkmcnt(4)
    v_lshlrev_b32 v52, 16, v124
    v_and_b32 v53, s59, v124
    v_lshlrev_b32 v54, 16, v125
    v_and_b32 v55, s59, v125
    v_lshlrev_b32 v56, 16, v126
    v_and_b32 v57, s59, v126
    v_lshlrev_b32 v58, 16, v127
    v_and_b32 v59, s59, v127
    s_waitcnt lgkmcnt(2)
    v_lshlrev_b32 v60, 16, v128
    v_and_b32 v61, s59, v128
    v_lshlrev_b32 v62, 16, v129
    v_and_b32 v63, s59, v129
    v_lshlrev_b32 v64, 16, v130
    v_and_b32 v65, s59, v130
    v_lshlrev_b32 v66, 16, v131
    v_and_b32 v67, s59, v131
    s_waitcnt lgkmcnt(0)
    v_lshlrev_b32 v68, 16, v132
    v_and_b32 v69, s59, v132
    v_lshlrev_b32 v70, 16, v133
    v_and_b32 v71, s59, v133
    v_lshlrev_b32 v72, 16, v134
    v_and_b32 v73, s59, v134
    v_lshlrev_b32 v74, 16, v135
    v_and_b32 v75, s59, v135
    s_lshl_b32 s66, s28, 13
    s_lshl_b32 s67, s74, 8
    s_add_u32 s66, s66, s67
    s_add_u32 s66, s66, 131072
    s_lshl_b32 s63, s74, 1
    s_lshr_b32 s63, 0xe4e4, s63
    s_and_b32 s63, s63, 3
    s_mul_i32 s63, s63, 122880
    s_mul_i32 s67, s28, 835584
    s_add_u32 s67, s67, s63
    s_add_u32 s67, s67, 0x1454000
    s_bitcmp1_b32 0xf0f0, s74
    s_cselect_b32 s80, 1, 0x10000
    s_and_b32 s63, s79, 31
    s_add_u32 s81, s66, s63
    s_add_u32 s81, s81, 5120
    s_add_u32 s68, s67, 40960
    s_add_u32 s69, s67, 81920
    s_mov_b32 s58, 0
PL_195:
    buffer_load_dword v13, v12, s[32:35], s66 offen sc1
    s_add_u32 s58, s58, 1
    s_waitcnt vmcnt(0)
    v_cmp_ne_u32 vcc, s53, v13
    s_nop 1
    s_cbranch_vccz PD_196
    s_cmp_lt_u32 s58, s57
    s_cbranch_scc1 PL_195
    s_mov_b32 s57, 0
PD_196:
    s_setprio 1
ML_197:
    buffer_load_dwordx4 v[76:79], v0, s[32:35], s67 offen sc1
    s_add_u32 s67, s67, 8192
    buffer_load_dwordx4 v[80:83], v0, s[32:35], s68 offen sc1
    s_add_u32 s68, s68, 8192
    buffer_load_dwordx4 v[84:87], v0, s[32:35], s69 offen sc1
    s_add_u32 s69, s69, 8192
    buffer_load_dwordx4 v[88:91], v0, s[32:35], s67 offen sc1
    s_add_u32 s67, s67, 8192
    buffer_load_dwordx4 v[92:95], v0, s[32:35], s68 offen sc1
    s_add_u32 s68, s68, 8192
    buffer_load_dwordx4 v[96:99], v0, s[32:35], s69 offen sc1
    s_add_u32 s69, s69, 8192
    buffer_load_dwordx4 v[100:103], v0, s[32:35], s67 offen sc1
    s_add_u32 s67, s67, 8192
    buffer_load_dwordx4 v[104:107], v0, s[32:35], s68 offen sc1
    s_add_u32 s68, s68, 8192
    buffer_load_dwordx4 v[108:111], v0, s[32:35], s69 offen sc1
    s_add_u32 s69, s69, 8192
    buffer_load_dwordx4 v[112:115], v0, s[32:35], s67 offen sc1
    s_add_u32 s67, s67, 8192
    buffer_load_dwordx4 v[116:119], v0, s[32:35], s68 offen sc1
    s_add_u32 s68, s68, 8192
    buffer_load_dwordx4 v[120:123], v0, s[32:35], s69 offen sc1
    s_add_u32 s69, s69, 8192
    buffer_load_dwordx4 v[124:127], v0, s[32:35], s67 offen sc1
    buffer_load_dwordx4 v[128:131], v0, s[32:35], s68 offen sc1
    buffer_load_dwordx4 v[132:135], v0, s[32:35], s69 offen sc1
    s_waitcnt vmcnt(14)
    v_dot2c_f32_bf16 v176, s89, v76
    v_dot2c_f32_bf16 v177, s90, v76
    v_dot2c_f32_bf16 v178, s89, v77
    v_dot2c_f32_bf16 v179, s90, v77
    v_dot2c_f32_bf16 v180, s89, v78
    v_dot2c_f32_bf16 v181, s90, v78
    v_dot2c_f32_bf16 v182, s89, v79
    v_dot2c_f32_bf16 v183, s90, v79
    s_waitcnt vmcnt(13)
    v_dot2c_f32_bf16 v176, s89, v80
    v_dot2c_f32_bf16 v177, s90, v80
    v_dot2c_f32_bf16 v178, s89, v81
    v_dot2c_f32_bf16 v179, s90, v81
    v_dot2c_f32_bf16 v180, s89, v82
    v_dot2c_f32_bf16 v181, s90, v82
    v_dot2c_f32_bf16 v182, s89, v83
    v_dot2c_f32_bf16 v183, s90, v83
    s_waitcnt vmcnt(12)
    v_or3_b32 v13, v76, v80, v84
    v_dot2c_f32_bf16 v176, s89, v84
    v_dot2c_f32_bf16 v177, s90, v84
    v_dot2c_f32_bf16 v178, s89, v85
    v_dot2c_f32_bf16 v179, s90, v85
    v_dot2c_f32_bf16 v180, s89, v86
    v_dot2c_f32_bf16 v181, s90, v86
    v_dot2c_f32_bf16 v182, s89, v87
    v_dot2c_f32_bf16 v183, s90, v87
    v_pk_mul_f32 v[26:27], v[176:177], v[176:177]
    v_pk_add_f32 v[24:25], v[176:177], v[178:179]
    v_pk_fma_f32 v[26:27], v[178:179], v[178:179], v[26:27]
    v_pk_add_f32 v[24:25], v[24:25], v[180:181]
    v_pk_fma_f32 v[26:27], v[180:181], v[180:181], v[26:27]
    v_pk_add_f32 v[24:25], v[24:25], v[182:183]
    v_pk_fma_f32 v[26:27], v[182:183], v[182:183], v[26:27]
    s_waitcnt vmcnt(11)
    v_dot2c_f32_bf16 v184, s89, v88
    v_dot2c_f32_bf16 v185, s90, v88
    v_dot2c_f32_bf16 v186, s89, v89
    v_dot2c_f32_bf16 v187, s90, v89
    v_dot2c_f32_bf16 v188, s89, v90
    v_dot2c_f32_bf16 v189, s90, v90
    v_dot2c_f32_bf16 v190, s89, v91
    v_dot2c_f32_bf16 v191, s90, v91
    s_waitcnt vmcnt(10)
    v_or3_b32 v13, v13, v88, v92
    v_dot2c_f32_bf16 v184, s89, v92
    v_dot2c_f32_bf16 v185, s90, v92
    v_dot2c_f32_bf16 v186, s89, v93
    v_dot2c_f32_bf16 v187, s90, v93
    v_dot2c_f32_bf16 v188, s89, v94
    v_dot2c_f32_bf16 v189, s90, v94
    v_dot2c_f32_bf16 v190, s89, v95
    v_dot2c_f32_bf16 v191, s90, v95
    s_waitcnt vmcnt(9)
    v_dot2c_f32_bf16 v184, s89, v96
    v_dot2c_f32_bf16 v185, s90, v96
    v_dot2c_f32_bf16 v186, s89, v97
    v_dot2c_f32_bf16 v187, s90, v97
    v_dot2c_f32_bf16 v188, s89, v98
    v_dot2c_f32_bf16 v189, s90, v98
    v_dot2c_f32_bf16 v190, s89, v99
    v_dot2c_f32_bf16 v191, s90, v99
    v_pk_add_f32 v[24:25], v[24:25], v[184:185]
    v_pk_fma_f32 v[26:27], v[184:185], v[184:185], v[26:27]
    v_pk_add_f32 v[24:25], v[24:25], v[186:187]
    v_pk_fma_f32 v[26:27], v[186:187], v[186:187], v[26:27]
    v_pk_add_f32 v[24:25], v[24:25], v[188:189]
    v_pk_fma_f32 v[26:27], v[188:189], v[188:189], v[26:27]
    v_pk_add_f32 v[24:25], v[24:25], v[190:191]
    v_pk_fma_f32 v[26:27], v[190:191], v[190:191], v[26:27]
    s_waitcnt vmcnt(8)
    v_or3_b32 v13, v13, v96, v100
    v_dot2c_f32_bf16 v192, s89, v100
    v_dot2c_f32_bf16 v193, s90, v100
    v_dot2c_f32_bf16 v194, s89, v101
    v_dot2c_f32_bf16 v195, s90, v101
    v_dot2c_f32_bf16 v196, s89, v102
    v_dot2c_f32_bf16 v197, s90, v102
    v_dot2c_f32_bf16 v198, s89, v103
    v_dot2c_f32_bf16 v199, s90, v103
    s_waitcnt vmcnt(7)
    v_dot2c_f32_bf16 v192, s89, v104
    v_dot2c_f32_bf16 v193, s90, v104
    v_dot2c_f32_bf16 v194, s89, v105
    v_dot2c_f32_bf16 v195, s90, v105
    v_dot2c_f32_bf16 v196, s89, v106
    v_dot2c_f32_bf16 v197, s90, v106
    v_dot2c_f32_bf16 v198, s89, v107
    v_dot2c_f32_bf16 v199, s90, v107
    s_waitcnt vmcnt(6)
    v_or3_b32 v13, v13, v104, v108
    v_dot2c_f32_bf16 v192, s89, v108
    v_dot2c_f32_bf16 v193, s90, v108
    v_dot2c_f32_bf16 v194, s89, v109
    v_dot2c_f32_bf16 v195, s90, v109
    v_dot2c_f32_bf16 v196, s89, v110
    v_dot2c_f32_bf16 v197, s90, v110
    v_dot2c_f32_bf16 v198, s89, v111
    v_dot2c_f32_bf16 v199, s90, v111
    v_pk_add_f32 v[24:25], v[24:25], v[192:193]
    v_pk_fma_f32 v[26:27], v[192:193], v[192:193], v[26:27]
    v_pk_add_f32 v[24:25], v[24:25], v[194:195]
    v_pk_fma_f32 v[26:27], v[194:195], v[194:195], v[26:27]
    v_pk_add_f32 v[24:25], v[24:25], v[196:197]
    v_pk_fma_f32 v[26:27], v[196:197], v[196:197], v[26:27]
    v_pk_add_f32 v[24:25], v[24:25], v[198:199]
    v_pk_fma_f32 v[26:27], v[198:199], v[198:199], v[26:27]
    s_waitcnt vmcnt(5)
    v_dot2c_f32_bf16 v200, s89, v112
    v_dot2c_f32_bf16 v201, s90, v112
    v_dot2c_f32_bf16 v202, s89, v113
    v_dot2c_f32_bf16 v203, s90, v113
    v_dot2c_f32_bf16 v204, s89, v114
    v_dot2c_f32_bf16 v205, s90, v114
    v_dot2c_f32_bf16 v206, s89, v115
    v_dot2c_f32_bf16 v207, s90, v115
    s_waitcnt vmcnt(4)
    v_or3_b32 v13, v13, v112, v116
    v_dot2c_f32_bf16 v200, s89, v116
    v_dot2c_f32_bf16 v201, s90, v116
    v_dot2c_f32_bf16 v202, s89, v117
    v_dot2c_f32_bf16 v203, s90, v117
    v_dot2c_f32_bf16 v204, s89, v118
    v_dot2c_f32_bf16 v205, s90, v118
    v_dot2c_f32_bf16 v206, s89, v119
    v_dot2c_f32_bf16 v207, s90, v119
    s_waitcnt vmcnt(3)
    v_dot2c_f32_bf16 v200, s89, v120
    v_dot2c_f32_bf16 v201, s90, v120
    v_dot2c_f32_bf16 v202, s89, v121
    v_dot2c_f32_bf16 v203, s90, v121
    v_dot2c_f32_bf16 v204, s89, v122
    v_dot2c_f32_bf16 v205, s90, v122
    v_dot2c_f32_bf16 v206, s89, v123
    v_dot2c_f32_bf16 v207, s90, v123
    v_pk_add_f32 v[24:25], v[24:25], v[200:201]
    v_pk_fma_f32 v[26:27], v[200:201], v[200:201], v[26:27]
    v_pk_add_f32 v[24:25], v[24:25], v[202:203]
    v_pk_fma_f32 v[26:27], v[202:203], v[202:203], v[26:27]
    v_pk_add_f32 v[24:25], v[24:25], v[204:205]
    v_pk_fma_f32 v[26:27], v[204:205], v[204:205], v[26:27]
    v_pk_add_f32 v[24:25], v[24:25], v[206:207]
    v_pk_fma_f32 v[26:27], v[206:207], v[206:207], v[26:27]
    s_waitcnt vmcnt(2)
    v_or3_b32 v13, v13, v120, v124
    v_dot2c_f32_bf16 v208, s89, v124
    v_dot2c_f32_bf16 v209, s90, v124
    v_dot2c_f32_bf16 v210, s89, v125
    v_dot2c_f32_bf16 v211, s90, v125
    v_dot2c_f32_bf16 v212, s89, v126
    v_dot2c_f32_bf16 v213, s90, v126
    v_dot2c_f32_bf16 v214, s89, v127
    v_dot2c_f32_bf16 v215, s90, v127
    s_waitcnt vmcnt(1)
    v_dot2c_f32_bf16 v208, s89, v128
    v_dot2c_f32_bf16 v209, s90, v128
    v_dot2c_f32_bf16 v210, s89, v129
    v_dot2c_f32_bf16 v211, s90, v129
    v_dot2c_f32_bf16 v212, s89, v130
    v_dot2c_f32_bf16 v213, s90, v130
    v_dot2c_f32_bf16 v214, s89, v131
    v_dot2c_f32_bf16 v215, s90, v131
    s_waitcnt vmcnt(0)
    v_or3_b32 v13, v13, v128, v132
    v_and_b32 v13, s80, v13
    v_cmp_ne_u32 vcc, 0, v13
    v_dot2c_f32_bf16 v208, s89, v132
    v_dot2c_f32_bf16 v209, s90, v132
    v_dot2c_f32_bf16 v210, s89, v133
    v_dot2c_f32_bf16 v211, s90, v133
    v_dot2c_f32_bf16 v212, s89, v134
    v_dot2c_f32_bf16 v213, s90, v134
    v_dot2c_f32_bf16 v214, s89, v135
    v_dot2c_f32_bf16 v215, s90, v135
    s_cbranch_vccnz MF_198
MO_199:
    v_pk_add_f32 v[24:25], v[24:25], v[208:209]
    v_pk_fma_f32 v[26:27], v[208:209], v[208:209], v[26:27]
    v_pk_add_f32 v[24:25], v[24:25], v[210:211]
    v_pk_fma_f32 v[26:27], v[210:211], v[210:211], v[26:27]
    v_pk_add_f32 v[24:25], v[24:25], v[212:213]
    v_pk_fma_f32 v[26:27], v[212:213], v[212:213], v[26:27]
    v_pk_add_f32 v[24:25], v[24:25], v[214:215]
    v_pk_fma_f32 v[26:27], v[214:215], v[214:215], v[26:27]
    v_mov_b32 v13, s53
    s_cmp_lg_u32 s55, 0
    s_cbranch_scc1 BS_201
    buffer_store_dword v13, v11, s[32:35], s81 offen
BR_202:
MQ_200:
    s_setprio 2
    v_add_f32 v24, v24, v25
    v_add_f32 v26, v26, v27
    s_nop 1
    v_permlane32_swap_b32 v24, v26
    v_add_f32 v24, v24, v26
    v_mov_b32 v26, v24
    s_nop 1
    v_permlane16_swap_b32 v24, v26
    v_add_f32 v24, v24, v26
    s_nop 1
    v_add_f32 v24, v24, v24 row_ror:8 row_mask:0xf bank_mask:0xf
    s_nop 1
    v_add_f32 v24, v24, v24 row_ror:4 row_mask:0xf bank_mask:0xf
    v_mul_f32 v24, s60, v24
    v_mov_b32 v26, v24
    s_nop 1
    v_permlane32_swap_b32 v24, v26
    v_fma_f32 v26, -v24, v24, v26
    v_max_f32 v26, 0, v26
    v_add_f32 v14, s61, v26
    v_rsq_f32 v14, v14
    s_nop 0
    v_mul_f32_e64 v15, -v24, v14
    v_pk_fma_f32 v[76:77], v[176:177], v[14:15], v[14:15] op_sel:[0,0,1] op_sel_hi:[1,0,1]
    v_pk_fma_f32 v[78:79], v[178:179], v[14:15], v[14:15] op_sel:[0,0,1] op_sel_hi:[1,0,1]
    v_pk_fma_f32 v[80:81], v[180:181], v[14:15], v[14:15] op_sel:[0,0,1] op_sel_hi:[1,0,1]
    v_pk_fma_f32 v[82:83], v[182:183], v[14:15], v[14:15] op_sel:[0,0,1] op_sel_hi:[1,0,1]
    v_pk_fma_f32 v[176:177], v[76:77], v[36:37], v[176:177]
    v_pk_fma_f32 v[178:179], v[78:79], v[38:39], v[178:179]
    v_pk_fma_f32 v[180:181], v[80:81], v[40:41], v[180:181]
    v_pk_fma_f32 v[182:183], v[82:83], v[42:43], v[182:183]
    v_pk_mul_f32 v[26:27], v[176:177], v[176:177]
    v_pk_add_f32 v[24:25], v[176:177], v[178:179]
    v_pk_fma_f32 v[26:27], v[178:179], v[178:179], v[26:27]
    v_pk_add_f32 v[24:25], v[24:25], v[180:181]
    v_pk_fma_f32 v[26:27], v[180:181], v[180:181], v[26:27]
    v_pk_add_f32 v[24:25], v[24:25], v[182:183]
    v_pk_fma_f32 v[26:27], v[182:183], v[182:183], v[26:27]
    v_pk_fma_f32 v[84:85], v[184:185], v[14:15], v[14:15] op_sel:[0,0,1] op_sel_hi:[1,0,1]
    v_pk_fma_f32 v[86:87], v[186:187], v[14:15], v[14:15] op_sel:[0,0,1] op_sel_hi:[1,0,1]
    v_pk_fma_f32 v[88:89], v[188:189], v[14:15], v[14:15] op_sel:[0,0,1] op_sel_hi:[1,0,1]
    v_pk_fma_f32 v[90:91], v[190:191], v[14:15], v[14:15] op_sel:[0,0,1] op_sel_hi:[1,0,1]
    v_pk_fma_f32 v[184:185], v[84:85], v[44:45], v[184:185]
    v_pk_fma_f32 v[186:187], v[86:87], v[46:47], v[186:187]
    v_pk_fma_f32 v[188:189], v[88:89], v[48:49], v[188:189]
    v_pk_fma_f32 v[190:191], v[90:91], v[50:51], v[190:191]
    v_pk_add_f32 v[24:25], v[24:25], v[184:185]
    v_pk_fma_f32 v[26:27], v[184:185], v[184:185], v[26:27]
    v_pk_add_f32 v[24:25], v[24:25], v[186:187]
    v_pk_fma_f32 v[26:27], v[186:187], v[186:187], v[26:27]
    v_pk_add_f32 v[24:25], v[24:25], v[188:189]
    v_pk_fma_f32 v[26:27], v[188:189], v[188:189], v[26:27]
    v_pk_add_f32 v[24:25], v[24:25], v[190:191]
    v_pk_fma_f32 v[26:27], v[190:191], v[190:191], v[26:27]
    v_pk_fma_f32 v[92:93], v[192:193], v[14:15], v[14:15] op_sel:[0,0,1] op_sel_hi:[1,0,1]
    v_pk_fma_f32 v[94:95], v[194:195], v[14:15], v[14:15] op_sel:[0,0,1] op_sel_hi:[1,0,1]
    v_pk_fma_f32 v[96:97], v[196:197], v[14:15], v[14:15] op_sel:[0,0,1] op_sel_hi:[1,0,1]
    v_pk_fma_f32 v[98:99], v[198:199], v[14:15], v[14:15] op_sel:[0,0,1] op_sel_hi:[1,0,1]
    v_pk_fma_f32 v[192:193], v[92:93], v[52:53], v[192:193]
    v_pk_fma_f32 v[194:195], v[94:95], v[54:55], v[194:195]
    v_pk_fma_f32 v[196:197], v[96:97], v[56:57], v[196:197]
    v_pk_fma_f32 v[198:199], v[98:99], v[58:59], v[198:199]
    v_pk_add_f32 v[24:25], v[24:25], v[192:193]
    v_pk_fma_f32 v[26:27], v[192:193], v[192:193], v[26:27]
    v_pk_add_f32 v[24:25], v[24:25], v[194:195]
    v_pk_fma_f32 v[26:27], v[194:195], v[194:195], v[26:27]
    v_pk_add_f32 v[24:25], v[24:25], v[196:197]
    v_pk_fma_f32 v[26:27], v[196:197], v[196:197], v[26:27]
    v_pk_add_f32 v[24:25], v[24:25], v[198:199]
    v_pk_fma_f32 v[26:27], v[198:199], v[198:199], v[26:27]
    v_pk_fma_f32 v[100:101], v[200:201], v[14:15], v[14:15] op_sel:[0,0,1] op_sel_hi:[1,0,1]
    v_pk_fma_f32 v[102:103], v[202:203], v[14:15], v[14:15] op_sel:[0,0,1] op_sel_hi:[1,0,1]
    v_pk_fma_f32 v[104:105], v[204:205], v[14:15], v[14:15] op_sel:[0,0,1] op_sel_hi:[1,0,1]
    v_pk_fma_f32 v[106:107], v[206:207], v[14:15], v[14:15] op_sel:[0,0,1] op_sel_hi:[1,0,1]
    v_pk_fma_f32 v[200:201], v[100:101], v[60:61], v[200:201]
    v_pk_fma_f32 v[202:203], v[102:103], v[62:63], v[202:203]
    v_pk_fma_f32 v[204:205], v[104:105], v[64:65], v[204:205]
    v_pk_fma_f32 v[206:207], v[106:107], v[66:67], v[206:207]
    v_pk_add_f32 v[24:25], v[24:25], v[200:201]
    v_pk_fma_f32 v[26:27], v[200:201], v[200:201], v[26:27]
    v_pk_add_f32 v[24:25], v[24:25], v[202:203]
    v_pk_fma_f32 v[26:27], v[202:203], v[202:203], v[26:27]
    v_pk_add_f32 v[24:25], v[24:25], v[204:205]
    v_pk_fma_f32 v[26:27], v[204:205], v[204:205], v[26:27]
    v_pk_add_f32 v[24:25], v[24:25], v[206:207]
    v_pk_fma_f32 v[26:27], v[206:207], v[206:207], v[26:27]
    v_pk_fma_f32 v[108:109], v[208:209], v[14:15], v[14:15] op_sel:[0,0,1] op_sel_hi:[1,0,1]
    v_pk_fma_f32 v[110:111], v[210:211], v[14:15], v[14:15] op_sel:[0,0,1] op_sel_hi:[1,0,1]
    v_pk_fma_f32 v[112:113], v[212:213], v[14:15], v[14:15] op_sel:[0,0,1] op_sel_hi:[1,0,1]
    v_pk_fma_f32 v[114:115], v[214:215], v[14:15], v[14:15] op_sel:[0,0,1] op_sel_hi:[1,0,1]
    v_pk_fma_f32 v[208:209], v[108:109], v[68:69], v[208:209]
    v_pk_fma_f32 v[210:211], v[110:111], v[70:71], v[210:211]
    v_pk_fma_f32 v[212:213], v[112:113], v[72:73], v[212:213]
    v_pk_fma_f32 v[214:215], v[114:115], v[74:75], v[214:215]
    v_pk_add_f32 v[24:25], v[24:25], v[208:209]
    v_pk_fma_f32 v[26:27], v[208:209], v[208:209], v[26:27]
    v_pk_add_f32 v[24:25], v[24:25], v[210:211]
    v_pk_fma_f32 v[26:27], v[210:211], v[210:211], v[26:27]
    v_pk_add_f32 v[24:25], v[24:25], v[212:213]
    v_pk_fma_f32 v[26:27], v[212:213], v[212:213], v[26:27]
    v_pk_add_f32 v[24:25], v[24:25], v[214:215]
    v_pk_fma_f32 v[26:27], v[214:215], v[214:215], v[26:27]
    v_add_f32 v24, v24, v25
    v_add_f32 v26, v26, v27
    s_nop 1
    v_permlane32_swap_b32 v24, v26
    v_add_f32 v24, v24, v26
    v_mov_b32 v26, v24
    s_nop 1
    v_permlane16_swap_b32 v24, v26
    v_add_f32 v24, v24, v26
    s_nop 1
    v_add_f32 v24, v24, v24 row_ror:8 row_mask:0xf bank_mask:0xf
    s_nop 1
    v_add_f32 v24, v24, v24 row_ror:4 row_mask:0xf bank_mask:0xf
    v_mul_f32 v24, s60, v24
    v_mov_b32 v26, v24
    s_nop 1
    v_permlane32_swap_b32 v24, v26
    v_fma_f32 v26, -v24, v24, v26
    v_max_f32 v26, 0, v26
    v_add_f32 v14, s61, v26
    v_rsq_f32 v14, v14
    s_nop 0
    v_mul_f32 v26, v26, v14
    v_fma_f32 v26, v26, v14, s61
    v_mul_f32 v14, s62, v14
    v_rsq_f32 v26, v26
    s_nop 0
    v_mul_f32 v14, v14, v26
    v_mul_f32_e64 v15, -v24, v14
    s_setprio 3
    s_mul_i32 s66, s76, 40960
    s_add_u32 s66, s66, 0x1000000
    s_lshl_b32 s68, s74, 5
    s_add_u32 s68, s68, s79
    v_mov_b32 v13, s53
    v_pk_fma_f32 v[76:77], v[176:177], v[14:15], v[14:15] op_sel:[0,0,1] op_sel_hi:[1,0,1]
    v_pk_fma_f32 v[78:79], v[178:179], v[14:15], v[14:15] op_sel:[0,0,1] op_sel_hi:[1,0,1]
    v_pk_fma_f32 v[80:81], v[180:181], v[14:15], v[14:15] op_sel:[0,0,1] op_sel_hi:[1,0,1]
    v_pk_fma_f32 v[82:83], v[182:183], v[14:15], v[14:15] op_sel:[0,0,1] op_sel_hi:[1,0,1]
    v_cvt_pk_bf16_f32 v116, v76, v77
    v_cvt_pk_bf16_f32 v117, v78, v79
    v_cvt_pk_bf16_f32 v118, v80, v81
    v_cvt_pk_bf16_f32 v119, v82, v83
    v_and_b32 v116, -2, v116
    s_cmp_lg_u32 s55, 0
    s_cbranch_scc1 BS_203
    buffer_store_dwordx4 v[116:119], v0, s[32:35], s66 offen
BR_204:
    s_add_u32 s66, s66, 8192
    v_pk_fma_f32 v[84:85], v[184:185], v[14:15], v[14:15] op_sel:[0,0,1] op_sel_hi:[1,0,1]
    v_pk_fma_f32 v[86:87], v[186:187], v[14:15], v[14:15] op_sel:[0,0,1] op_sel_hi:[1,0,1]
    v_pk_fma_f32 v[88:89], v[188:189], v[14:15], v[14:15] op_sel:[0,0,1] op_sel_hi:[1,0,1]
    v_pk_fma_f32 v[90:91], v[190:191], v[14:15], v[14:15] op_sel:[0,0,1] op_sel_hi:[1,0,1]
    v_cvt_pk_bf16_f32 v120, v84, v85
    v_cvt_pk_bf16_f32 v121, v86, v87
    v_cvt_pk_bf16_f32 v122, v88, v89
    v_cvt_pk_bf16_f32 v123, v90, v91
    v_and_b32 v120, -2, v120
    s_cmp_lg_u32 s55, 0
    s_cbranch_scc1 BS_205
    buffer_store_dwordx4 v[120:123], v0, s[32:35], s66 offen
BR_206:
    s_add_u32 s66, s66, 8192
    v_pk_fma_f32 v[92:93], v[192:193], v[14:15], v[14:15] op_sel:[0,0,1] op_sel_hi:[1,0,1]
    v_pk_fma_f32 v[94:95], v[194:195], v[14:15], v[14:15] op_sel:[0,0,1] op_sel_hi:[1,0,1]
    v_pk_fma_f32 v[96:97], v[196:197], v[14:15], v[14:15] op_sel:[0,0,1] op_sel_hi:[1,0,1]
    v_pk_fma_f32 v[98:99], v[198:199], v[14:15], v[14:15] op_sel:[0,0,1] op_sel_hi:[1,0,1]
    v_cvt_pk_bf16_f32 v124, v92, v93
    v_cvt_pk_bf16_f32 v125, v94, v95
    v_cvt_pk_bf16_f32 v126, v96, v97
    v_cvt_pk_bf16_f32 v127, v98, v99
    v_and_b32 v124, -2, v124
    s_cmp_lg_u32 s55, 0
    s_cbranch_scc1 BS_207
    buffer_store_dwordx4 v[124:127], v0, s[32:35], s66 offen
BR_208:
    s_add_u32 s66, s66, 8192
    v_pk_fma_f32 v[100:101], v[200:201], v[14:15], v[14:15] op_sel:[0,0,1] op_sel_hi:[1,0,1]
    v_pk_fma_f32 v[102:103], v[202:203], v[14:15], v[14:15] op_sel:[0,0,1] op_sel_hi:[1,0,1]
    v_pk_fma_f32 v[104:105], v[204:205], v[14:15], v[14:15] op_sel:[0,0,1] op_sel_hi:[1,0,1]
    v_pk_fma_f32 v[106:107], v[206:207], v[14:15], v[14:15] op_sel:[0,0,1] op_sel_hi:[1,0,1]
    v_cvt_pk_bf16_f32 v128, v100, v101
    v_cvt_pk_bf16_f32 v129, v102, v103
    v_cvt_pk_bf16_f32 v130, v104, v105
    v_cvt_pk_bf16_f32 v131, v106, v107
    v_and_b32 v128, -2, v128
    s_cmp_lg_u32 s55, 0
    s_cbranch_scc1 BS_209
    buffer_store_dwordx4 v[128:131], v0, s[32:35], s66 offen
BR_210:
    s_add_u32 s66, s66, 8192
    v_pk_fma_f32 v[108:109], v[208:209], v[14:15], v[14:15] op_sel:[0,0,1] op_sel_hi:[1,0,1]
    v_pk_fma_f32 v[110:111], v[210:211], v[14:15], v[14:15] op_sel:[0,0,1] op_sel_hi:[1,0,1]
    v_pk_fma_f32 v[112:113], v[212:213], v[14:15], v[14:15] op_sel:[0,0,1] op_sel_hi:[1,0,1]
    v_pk_fma_f32 v[114:115], v[214:215], v[14:15], v[14:15] op_sel:[0,0,1] op_sel_hi:[1,0,1]
    v_cvt_pk_bf16_f32 v132, v108, v109
    v_cvt_pk_bf16_f32 v133, v110, v111
    v_cvt_pk_bf16_f32 v134, v112, v113
    v_cvt_pk_bf16_f32 v135, v114, v115
    v_and_b32 v132, -2, v132
    s_cmp_lg_u32 s55, 0
    s_cbranch_scc1 BS_211
    buffer_store_dwordx4 v[132:135], v0, s[32:35], s66 offen
    buffer_store_dword v13, v11, s[32:35], s68 offen offset:256
BR_212:
    s_setprio 0
    s_add_u32 s74, s70, 6
    s_cmp_gt_u32 s74, 7
    s_cbranch_scc1 SB_END
    s_add_u32 s75, s72, 81920
    v_add_u32 v4, s75, v6
    v_xor_b32 v5, 0x80, v4
    s_lshl_b32 s76, s28, 3
    s_add_u32 s76, s76, s74
    ds_read_b64_tr_b16 v[116:117], v4 offset:0
    ds_read_b64_tr_b16 v[118:119], v5 offset:0
    ds_read_b64_tr_b16 v[120:121], v4 offset:4096
    ds_read_b64_tr_b16 v[122:123], v5 offset:4096
    ds_read_b64_tr_b16 v[124:125], v4 offset:8192
    ds_read_b64_tr_b16 v[126:127], v5 offset:8192
    ds_read_b64_tr_b16 v[128:129], v4 offset:12288
    ds_read_b64_tr_b16 v[130:131], v5 offset:12288
    ds_read_b64_tr_b16 v[132:133], v4 offset:16384
    ds_read_b64_tr_b16 v[134:135], v5 offset:16384
    s_waitcnt lgkmcnt(8)
    v_lshlrev_b32 v36, 16, v116
    v_and_b32 v37, s59, v116
    v_lshlrev_b32 v38, 16, v117
    v_and_b32 v39, s59, v117
    v_lshlrev_b32 v40, 16, v118
    v_and_b32 v41, s59, v118
    v_lshlrev_b32 v42, 16, v119
    v_and_b32 v43, s59, v119
    s_waitcnt lgkmcnt(6)
    v_lshlrev_b32 v44, 16, v120
    v_and_b32 v45, s59, v120
    v_lshlrev_b32 v46, 16, v121
    v_and_b32 v47, s59, v121
    v_lshlrev_b32 v48, 16, v122
    v_and_b32 v49, s59, v122
    v_lshlrev_b32 v50, 16, v123
    v_and_b32 v51, s59, v123
    s_waitcnt lgkmcnt(4)
    v_lshlrev_b32 v52, 16, v124
    v_and_b32 v53, s59, v124
    v_lshlrev_b32 v54, 16, v125
    v_and_b32 v55, s59, v125
    v_lshlrev_b32 v56, 16, v126
    v_and_b32 v57, s59, v126
    v_lshlrev_b32 v58, 16, v127
    v_and_b32 v59, s59, v127
    s_waitcnt lgkmcnt(2)
    v_lshlrev_b32 v60, 16, v128
    v_and_b32 v61, s59, v128
    v_lshlrev_b32 v62, 16, v129
    v_and_b32 v63, s59, v129
    v_lshlrev_b32 v64, 16, v130
    v_and_b32 v65, s59, v130
    v_lshlrev_b32 v66, 16, v131
    v_and_b32 v67, s59, v131
    s_waitcnt lgkmcnt(0)
    v_lshlrev_b32 v68, 16, v132
    v_and_b32 v69, s59, v132
    v_lshlrev_b32 v70, 16, v133
    v_and_b32 v71, s59, v133
    v_lshlrev_b32 v72, 16, v134
    v_and_b32 v73, s59, v134
    v_lshlrev_b32 v74, 16, v135
    v_and_b32 v75, s59, v135
    s_lshl_b32 s66, s28, 13
    s_lshl_b32 s67, s74, 8
    s_add_u32 s66, s66, s67
    s_add_u32 s66, s66, 131072
    s_lshl_b32 s63, s74, 1
    s_lshr_b32 s63, 0xe4e4, s63
    s_and_b32 s63, s63, 3
    s_mul_i32 s63, s63, 122880
    s_mul_i32 s67, s28, 835584
    s_add_u32 s67, s67, s63
    s_add_u32 s67, s67, 0x1454000
    s_bitcmp1_b32 0xf0f0, s74
    s_cselect_b32 s80, 1, 0x10000
    s_and_b32 s63, s79, 31
    s_add_u32 s81, s66, s63
    s_add_u32 s81, s81, 5120
    s_add_u32 s68, s67, 40960
    s_add_u32 s69, s67, 81920
    s_mov_b32 s58, 0
PL_213:
    buffer_load_dword v13, v12, s[32:35], s66 offen sc1
    s_add_u32 s58, s58, 1
    s_waitcnt vmcnt(0)
    v_cmp_ne_u32 vcc, s53, v13
    s_nop 1
    s_cbranch_vccz PD_214
    s_cmp_lt_u32 s58, s57
    s_cbranch_scc1 PL_213
    s_mov_b32 s57, 0
PD_214:
    s_setprio 1
ML_215:
    buffer_load_dwordx4 v[76:79], v0, s[32:35], s67 offen sc1
    s_add_u32 s67, s67, 8192
    buffer_load_dwordx4 v[80:83], v0, s[32:35], s68 offen sc1
    s_add_u32 s68, s68, 8192
    buffer_load_dwordx4 v[84:87], v0, s[32:35], s69 offen sc1
    s_add_u32 s69, s69, 8192
    buffer_load_dwordx4 v[88:91], v0, s[32:35], s67 offen sc1
    s_add_u32 s67, s67, 8192
    buffer_load_dwordx4 v[92:95], v0, s[32:35], s68 offen sc1
    s_add_u32 s68, s68, 8192
    buffer_load_dwordx4 v[96:99], v0, s[32:35], s69 offen sc1
    s_add_u32 s69, s69, 8192
    buffer_load_dwordx4 v[100:103], v0, s[32:35], s67 offen sc1
    s_add_u32 s67, s67, 8192
    buffer_load_dwordx4 v[104:107], v0, s[32:35], s68 offen sc1
    s_add_u32 s68, s68, 8192
    buffer_load_dwordx4 v[108:111], v0, s[32:35], s69 offen sc1
    s_add_u32 s69, s69, 8192
    buffer_load_dwordx4 v[112:115], v0, s[32:35], s67 offen sc1
    s_add_u32 s67, s67, 8192
    buffer_load_dwordx4 v[116:119], v0, s[32:35], s68 offen sc1
    s_add_u32 s68, s68, 8192
    buffer_load_dwordx4 v[120:123], v0, s[32:35], s69 offen sc1
    s_add_u32 s69, s69, 8192
    buffer_load_dwordx4 v[124:127], v0, s[32:35], s67 offen sc1
    buffer_load_dwordx4 v[128:131], v0, s[32:35], s68 offen sc1
    buffer_load_dwordx4 v[132:135], v0, s[32:35], s69 offen sc1
    s_waitcnt vmcnt(14)
    v_dot2c_f32_bf16 v216, s89, v76
    v_dot2c_f32_bf16 v217, s90, v76
    v_dot2c_f32_bf16 v218, s89, v77
    v_dot2c_f32_bf16 v219, s90, v77
    v_dot2c_f32_bf16 v220, s89, v78
    v_dot2c_f32_bf16 v221, s90, v78
    v_dot2c_f32_bf16 v222, s89, v79
    v_dot2c_f32_bf16 v223, s90, v79
    s_waitcnt vmcnt(13)
    v_dot2c_f32_bf16 v216, s89, v80
    v_dot2c_f32_bf16 v217, s90, v80
    v_dot2c_f32_bf16 v218, s89, v81
    v_dot2c_f32_bf16 v219, s90, v81
    v_dot2c_f32_bf16 v220, s89, v82
    v_dot2c_f32_bf16 v221, s90, v82
    v_dot2c_f32_bf16 v222, s89, v83
    v_dot2c_f32_bf16 v223, s90, v83
    s_waitcnt vmcnt(12)
    v_or3_b32 v13, v76, v80, v84
    v_dot2c_f32_bf16 v216, s89, v84
    v_dot2c_f32_bf16 v217, s90, v84
    v_dot2c_f32_bf16 v218, s89, v85
    v_dot2c_f32_bf16 v219, s90, v85
    v_dot2c_f32_bf16 v220, s89, v86
    v_dot2c_f32_bf16 v221, s90, v86
    v_dot2c_f32_bf16 v222, s89, v87
    v_dot2c_f32_bf16 v223, s90, v87
    v_pk_mul_f32 v[26:27], v[216:217], v[216:217]
    v_pk_add_f32 v[24:25], v[216:217], v[218:219]
    v_pk_fma_f32 v[26:27], v[218:219], v[218:219], v[26:27]
    v_pk_add_f32 v[24:25], v[24:25], v[220:221]
    v_pk_fma_f32 v[26:27], v[220:221], v[220:221], v[26:27]
    v_pk_add_f32 v[24:25], v[24:25], v[222:223]
    v_pk_fma_f32 v[26:27], v[222:223], v[222:223], v[26:27]
    s_waitcnt vmcnt(11)
    v_dot2c_f32_bf16 v224, s89, v88
    v_dot2c_f32_bf16 v225, s90, v88
    v_dot2c_f32_bf16 v226, s89, v89
    v_dot2c_f32_bf16 v227, s90, v89
    v_dot2c_f32_bf16 v228, s89, v90
    v_dot2c_f32_bf16 v229, s90, v90
    v_dot2c_f32_bf16 v230, s89, v91
    v_dot2c_f32_bf16 v231, s90, v91
    s_waitcnt vmcnt(10)
    v_or3_b32 v13, v13, v88, v92
    v_dot2c_f32_bf16 v224, s89, v92
    v_dot2c_f32_bf16 v225, s90, v92
    v_dot2c_f32_bf16 v226, s89, v93
    v_dot2c_f32_bf16 v227, s90, v93
    v_dot2c_f32_bf16 v228, s89, v94
    v_dot2c_f32_bf16 v229, s90, v94
    v_dot2c_f32_bf16 v230, s89, v95
    v_dot2c_f32_bf16 v231, s90, v95
    s_waitcnt vmcnt(9)
    v_dot2c_f32_bf16 v224, s89, v96
    v_dot2c_f32_bf16 v225, s90, v96
    v_dot2c_f32_bf16 v226, s89, v97
    v_dot2c_f32_bf16 v227, s90, v97
    v_dot2c_f32_bf16 v228, s89, v98
    v_dot2c_f32_bf16 v229, s90, v98
    v_dot2c_f32_bf16 v230, s89, v99
    v_dot2c_f32_bf16 v231, s90, v99
    v_pk_add_f32 v[24:25], v[24:25], v[224:225]
    v_pk_fma_f32 v[26:27], v[224:225], v[224:225], v[26:27]
    v_pk_add_f32 v[24:25], v[24:25], v[226:227]
    v_pk_fma_f32 v[26:27], v[226:227], v[226:227], v[26:27]
    v_pk_add_f32 v[24:25], v[24:25], v[228:229]
    v_pk_fma_f32 v[26:27], v[228:229], v[228:229], v[26:27]
    v_pk_add_f32 v[24:25], v[24:25], v[230:231]
    v_pk_fma_f32 v[26:27], v[230:231], v[230:231], v[26:27]
    s_waitcnt vmcnt(8)
    v_or3_b32 v13, v13, v96, v100
    v_dot2c_f32_bf16 v232, s89, v100
    v_dot2c_f32_bf16 v233, s90, v100
    v_dot2c_f32_bf16 v234, s89, v101
    v_dot2c_f32_bf16 v235, s90, v101
    v_dot2c_f32_bf16 v236, s89, v102
    v_dot2c_f32_bf16 v237, s90, v102
    v_dot2c_f32_bf16 v238, s89, v103
    v_dot2c_f32_bf16 v239, s90, v103
    s_waitcnt vmcnt(7)
    v_dot2c_f32_bf16 v232, s89, v104
    v_dot2c_f32_bf16 v233, s90, v104
    v_dot2c_f32_bf16 v234, s89, v105
    v_dot2c_f32_bf16 v235, s90, v105
    v_dot2c_f32_bf16 v236, s89, v106
    v_dot2c_f32_bf16 v237, s90, v106
    v_dot2c_f32_bf16 v238, s89, v107
    v_dot2c_f32_bf16 v239, s90, v107
    s_waitcnt vmcnt(6)
    v_or3_b32 v13, v13, v104, v108
    v_dot2c_f32_bf16 v232, s89, v108
    v_dot2c_f32_bf16 v233, s90, v108
    v_dot2c_f32_bf16 v234, s89, v109
    v_dot2c_f32_bf16 v235, s90, v109
    v_dot2c_f32_bf16 v236, s89, v110
    v_dot2c_f32_bf16 v237, s90, v110
    v_dot2c_f32_bf16 v238, s89, v111
    v_dot2c_f32_bf16 v239, s90, v111
    v_pk_add_f32 v[24:25], v[24:25], v[232:233]
    v_pk_fma_f32 v[26:27], v[232:233], v[232:233], v[26:27]
    v_pk_add_f32 v[24:25], v[24:25], v[234:235]
    v_pk_fma_f32 v[26:27], v[234:235], v[234:235], v[26:27]
    v_pk_add_f32 v[24:25], v[24:25], v[236:237]
    v_pk_fma_f32 v[26:27], v[236:237], v[236:237], v[26:27]
    v_pk_add_f32 v[24:25], v[24:25], v[238:239]
    v_pk_fma_f32 v[26:27], v[238:239], v[238:239], v[26:27]
    s_waitcnt vmcnt(5)
    v_dot2c_f32_bf16 v240, s89, v112
    v_dot2c_f32_bf16 v241, s90, v112
    v_dot2c_f32_bf16 v242, s89, v113
    v_dot2c_f32_bf16 v243, s90, v113
    v_dot2c_f32_bf16 v244, s89, v114
    v_dot2c_f32_bf16 v245, s90, v114
    v_dot2c_f32_bf16 v246, s89, v115
    v_dot2c_f32_bf16 v247, s90, v115
    s_waitcnt vmcnt(4)
    v_or3_b32 v13, v13, v112, v116
    v_dot2c_f32_bf16 v240, s89, v116
    v_dot2c_f32_bf16 v241, s90, v116
    v_dot2c_f32_bf16 v242, s89, v117
    v_dot2c_f32_bf16 v243, s90, v117
    v_dot2c_f32_bf16 v244, s89, v118
    v_dot2c_f32_bf16 v245, s90, v118
    v_dot2c_f32_bf16 v246, s89, v119
    v_dot2c_f32_bf16 v247, s90, v119
    s_waitcnt vmcnt(3)
    v_dot2c_f32_bf16 v240, s89, v120
    v_dot2c_f32_bf16 v241, s90, v120
    v_dot2c_f32_bf16 v242, s89, v121
    v_dot2c_f32_bf16 v243, s90, v121
    v_dot2c_f32_bf16 v244, s89, v122
    v_dot2c_f32_bf16 v245, s90, v122
    v_dot2c_f32_bf16 v246, s89, v123
    v_dot2c_f32_bf16 v247, s90, v123
    v_pk_add_f32 v[24:25], v[24:25], v[240:241]
    v_pk_fma_f32 v[26:27], v[240:241], v[240:241], v[26:27]
    v_pk_add_f32 v[24:25], v[24:25], v[242:243]
    v_pk_fma_f32 v[26:27], v[242:243], v[242:243], v[26:27]
    v_pk_add_f32 v[24:25], v[24:25], v[244:245]
    v_pk_fma_f32 v[26:27], v[244:245], v[244:245], v[26:27]
    v_pk_add_f32 v[24:25], v[24:25], v[246:247]
    v_pk_fma_f32 v[26:27], v[246:247], v[246:247], v[26:27]
    s_waitcnt vmcnt(2)
    v_or3_b32 v13, v13, v120, v124
    v_dot2c_f32_bf16 v248, s89, v124
    v_dot2c_f32_bf16 v249, s90, v124
    v_dot2c_f32_bf16 v250, s89, v125
    v_dot2c_f32_bf16 v251, s90, v125
    v_dot2c_f32_bf16 v252, s89, v126
    v_dot2c_f32_bf16 v253, s90, v126
    v_dot2c_f32_bf16 v254, s89, v127
    v_dot2c_f32_bf16 v255, s90, v127
    s_waitcnt vmcnt(1)
    v_dot2c_f32_bf16 v248, s89, v128
    v_dot2c_f32_bf16 v249, s90, v128
    v_dot2c_f32_bf16 v250, s89, v129
    v_dot2c_f32_bf16 v251, s90, v129
    v_dot2c_f32_bf16 v252, s89, v130
    v_dot2c_f32_bf16 v253, s90, v130
    v_dot2c_f32_bf16 v254, s89, v131
    v_dot2c_f32_bf16 v255, s90, v131
    s_waitcnt vmcnt(0)
    v_or3_b32 v13, v13, v128, v132
    v_and_b32 v13, s80, v13
    v_cmp_ne_u32 vcc, 0, v13
    v_dot2c_f32_bf16 v248, s89, v132
    v_dot2c_f32_bf16 v249, s90, v132
    v_dot2c_f32_bf16 v250, s89, v133
    v_dot2c_f32_bf16 v251, s90, v133
    v_dot2c_f32_bf16 v252, s89, v134
    v_dot2c_f32_bf16 v253, s90, v134
    v_dot2c_f32_bf16 v254, s89, v135
    v_dot2c_f32_bf16 v255, s90, v135
    s_cbranch_vccnz MF_216
MO_217:
    v_pk_add_f32 v[24:25], v[24:25], v[248:249]
    v_pk_fma_f32 v[26:27], v[248:249], v[248:249], v[26:27]
    v_pk_add_f32 v[24:25], v[24:25], v[250:251]
    v_pk_fma_f32 v[26:27], v[250:251], v[250:251], v[26:27]
    v_pk_add_f32 v[24:25], v[24:25], v[252:253]
    v_pk_fma_f32 v[26:27], v[252:253], v[252:253], v[26:27]
    v_pk_add_f32 v[24:25], v[24:25], v[254:255]
    v_pk_fma_f32 v[26:27], v[254:255], v[254:255], v[26:27]
    v_mov_b32 v13, s53
    s_cmp_lg_u32 s55, 0
    s_cbranch_scc1 BS_219
    buffer_store_dword v13, v11, s[32:35], s81 offen
BR_220:
MQ_218:
    s_setprio 2
    v_add_f32 v24, v24, v25
    v_add_f32 v26, v26, v27
    s_nop 1
    v_permlane32_swap_b32 v24, v26
    v_add_f32 v24, v24, v26
    v_mov_b32 v26, v24
    s_nop 1
    v_permlane16_swap_b32 v24, v26
    v_add_f32 v24, v24, v26
    s_nop 1
    v_add_f32 v24, v24, v24 row_ror:8 row_mask:0xf bank_mask:0xf
    s_nop 1
    v_add_f32 v24, v24, v24 row_ror:4 row_mask:0xf bank_mask:0xf
    v_mul_f32 v24, s60, v24
    v_mov_b32 v26, v24
    s_nop 1
    v_permlane32_swap_b32 v24, v26
    v_fma_f32 v26, -v24, v24, v26
    v_max_f32 v26, 0, v26
    v_add_f32 v14, s61, v26
    v_rsq_f32 v14, v14
    s_nop 0
    v_mul_f32_e64 v15, -v24, v14
    v_pk_fma_f32 v[76:77], v[216:217], v[14:15], v[14:15] op_sel:[0,0,1] op_sel_hi:[1,0,1]
    v_pk_fma_f32 v[78:79], v[218:219], v[14:15], v[14:15] op_sel:[0,0,1] op_sel_hi:[1,0,1]
    v_pk_fma_f32 v[80:81], v[220:221], v[14:15], v[14:15] op_sel:[0,0,1] op_sel_hi:[1,0,1]
    v_pk_fma_f32 v[82:83], v[222:223], v[14:15], v[14:15] op_sel:[0,0,1] op_sel_hi:[1,0,1]
    v_pk_fma_f32 v[216:217], v[76:77], v[36:37], v[216:217]
    v_pk_fma_f32 v[218:219], v[78:79], v[38:39], v[218:219]
    v_pk_fma_f32 v[220:221], v[80:81], v[40:41], v[220:221]
    v_pk_fma_f32 v[222:223], v[82:83], v[42:43], v[222:223]
    v_pk_mul_f32 v[26:27], v[216:217], v[216:217]
    v_pk_add_f32 v[24:25], v[216:217], v[218:219]
    v_pk_fma_f32 v[26:27], v[218:219], v[218:219], v[26:27]
    v_pk_add_f32 v[24:25], v[24:25], v[220:221]
    v_pk_fma_f32 v[26:27], v[220:221], v[220:221], v[26:27]
    v_pk_add_f32 v[24:25], v[24:25], v[222:223]
    v_pk_fma_f32 v[26:27], v[222:223], v[222:223], v[26:27]
    v_pk_fma_f32 v[84:85], v[224:225], v[14:15], v[14:15] op_sel:[0,0,1] op_sel_hi:[1,0,1]
    v_pk_fma_f32 v[86:87], v[226:227], v[14:15], v[14:15] op_sel:[0,0,1] op_sel_hi:[1,0,1]
    v_pk_fma_f32 v[88:89], v[228:229], v[14:15], v[14:15] op_sel:[0,0,1] op_sel_hi:[1,0,1]
    v_pk_fma_f32 v[90:91], v[230:231], v[14:15], v[14:15] op_sel:[0,0,1] op_sel_hi:[1,0,1]
    v_pk_fma_f32 v[224:225], v[84:85], v[44:45], v[224:225]
    v_pk_fma_f32 v[226:227], v[86:87], v[46:47], v[226:227]
    v_pk_fma_f32 v[228:229], v[88:89], v[48:49], v[228:229]
    v_pk_fma_f32 v[230:231], v[90:91], v[50:51], v[230:231]
    v_pk_add_f32 v[24:25], v[24:25], v[224:225]
    v_pk_fma_f32 v[26:27], v[224:225], v[224:225], v[26:27]
    v_pk_add_f32 v[24:25], v[24:25], v[226:227]
    v_pk_fma_f32 v[26:27], v[226:227], v[226:227], v[26:27]
    v_pk_add_f32 v[24:25], v[24:25], v[228:229]
    v_pk_fma_f32 v[26:27], v[228:229], v[228:229], v[26:27]
    v_pk_add_f32 v[24:25], v[24:25], v[230:231]
    v_pk_fma_f32 v[26:27], v[230:231], v[230:231], v[26:27]
    v_pk_fma_f32 v[92:93], v[232:233], v[14:15], v[14:15] op_sel:[0,0,1] op_sel_hi:[1,0,1]
    v_pk_fma_f32 v[94:95], v[234:235], v[14:15], v[14:15] op_sel:[0,0,1] op_sel_hi:[1,0,1]
    v_pk_fma_f32 v[96:97], v[236:237], v[14:15], v[14:15] op_sel:[0,0,1] op_sel_hi:[1,0,1]
    v_pk_fma_f32 v[98:99], v[238:239], v[14:15], v[14:15] op_sel:[0,0,1] op_sel_hi:[1,0,1]
    v_pk_fma_f32 v[232:233], v[92:93], v[52:53], v[232:233]
    v_pk_fma_f32 v[234:235], v[94:95], v[54:55], v[234:235]
    v_pk_fma_f32 v[236:237], v[96:97], v[56:57], v[236:237]
    v_pk_fma_f32 v[238:239], v[98:99], v[58:59], v[238:239]
    v_pk_add_f32 v[24:25], v[24:25], v[232:233]
    v_pk_fma_f32 v[26:27], v[232:233], v[232:233], v[26:27]
    v_pk_add_f32 v[24:25], v[24:25], v[234:235]
    v_pk_fma_f32 v[26:27], v[234:235], v[234:235], v[26:27]
    v_pk_add_f32 v[24:25], v[24:25], v[236:237]
    v_pk_fma_f32 v[26:27], v[236:237], v[236:237], v[26:27]
    v_pk_add_f32 v[24:25], v[24:25], v[238:239]
    v_pk_fma_f32 v[26:27], v[238:239], v[238:239], v[26:27]
    v_pk_fma_f32 v[100:101], v[240:241], v[14:15], v[14:15] op_sel:[0,0,1] op_sel_hi:[1,0,1]
    v_pk_fma_f32 v[102:103], v[242:243], v[14:15], v[14:15] op_sel:[0,0,1] op_sel_hi:[1,0,1]
    v_pk_fma_f32 v[104:105], v[244:245], v[14:15], v[14:15] op_sel:[0,0,1] op_sel_hi:[1,0,1]
    v_pk_fma_f32 v[106:107], v[246:247], v[14:15], v[14:15] op_sel:[0,0,1] op_sel_hi:[1,0,1]
    v_pk_fma_f32 v[240:241], v[100:101], v[60:61], v[240:241]
    v_pk_fma_f32 v[242:243], v[102:103], v[62:63], v[242:243]
    v_pk_fma_f32 v[244:245], v[104:105], v[64:65], v[244:245]
    v_pk_fma_f32 v[246:247], v[106:107], v[66:67], v[246:247]
    v_pk_add_f32 v[24:25], v[24:25], v[240:241]
    v_pk_fma_f32 v[26:27], v[240:241], v[240:241], v[26:27]
    v_pk_add_f32 v[24:25], v[24:25], v[242:243]
    v_pk_fma_f32 v[26:27], v[242:243], v[242:243], v[26:27]
    v_pk_add_f32 v[24:25], v[24:25], v[244:245]
    v_pk_fma_f32 v[26:27], v[244:245], v[244:245], v[26:27]
    v_pk_add_f32 v[24:25], v[24:25], v[246:247]
    v_pk_fma_f32 v[26:27], v[246:247], v[246:247], v[26:27]
    v_pk_fma_f32 v[108:109], v[248:249], v[14:15], v[14:15] op_sel:[0,0,1] op_sel_hi:[1,0,1]
    v_pk_fma_f32 v[110:111], v[250:251], v[14:15], v[14:15] op_sel:[0,0,1] op_sel_hi:[1,0,1]
    v_pk_fma_f32 v[112:113], v[252:253], v[14:15], v[14:15] op_sel:[0,0,1] op_sel_hi:[1,0,1]
    v_pk_fma_f32 v[114:115], v[254:255], v[14:15], v[14:15] op_sel:[0,0,1] op_sel_hi:[1,0,1]
    v_pk_fma_f32 v[248:249], v[108:109], v[68:69], v[248:249]
    v_pk_fma_f32 v[250:251], v[110:111], v[70:71], v[250:251]
    v_pk_fma_f32 v[252:253], v[112:113], v[72:73], v[252:253]
    v_pk_fma_f32 v[254:255], v[114:115], v[74:75], v[254:255]
    v_pk_add_f32 v[24:25], v[24:25], v[248:249]
    v_pk_fma_f32 v[26:27], v[248:249], v[248:249], v[26:27]
    v_pk_add_f32 v[24:25], v[24:25], v[250:251]
    v_pk_fma_f32 v[26:27], v[250:251], v[250:251], v[26:27]
    v_pk_add_f32 v[24:25], v[24:25], v[252:253]
    v_pk_fma_f32 v[26:27], v[252:253], v[252:253], v[26:27]
    v_pk_add_f32 v[24:25], v[24:25], v[254:255]
    v_pk_fma_f32 v[26:27], v[254:255], v[254:255], v[26:27]
    v_add_f32 v24, v24, v25
    v_add_f32 v26, v26, v27
    s_nop 1
    v_permlane32_swap_b32 v24, v26
    v_add_f32 v24, v24, v26
    v_mov_b32 v26, v24
    s_nop 1
    v_permlane16_swap_b32 v24, v26
    v_add_f32 v24, v24, v26
    s_nop 1
    v_add_f32 v24, v24, v24 row_ror:8 row_mask:0xf bank_mask:0xf
    s_nop 1
    v_add_f32 v24, v24, v24 row_ror:4 row_mask:0xf bank_mask:0xf
    v_mul_f32 v24, s60, v24
    v_mov_b32 v26, v24
    s_nop 1
    v_permlane32_swap_b32 v24, v26
    v_fma_f32 v26, -v24, v24, v26
    v_max_f32 v26, 0, v26
    v_add_f32 v14, s61, v26
    v_rsq_f32 v14, v14
    s_nop 0
    v_mul_f32 v26, v26, v14
    v_fma_f32 v26, v26, v14, s61
    v_mul_f32 v14, s62, v14
    v_rsq_f32 v26, v26
    s_nop 0
    v_mul_f32 v14, v14, v26
    v_mul_f32_e64 v15, -v24, v14
    s_setprio 3
    s_mul_i32 s66, s76, 40960
    s_add_u32 s66, s66, 0x1000000
    s_lshl_b32 s68, s74, 5
    s_add_u32 s68, s68, s79
    v_mov_b32 v13, s53
    v_pk_fma_f32 v[76:77], v[216:217], v[14:15], v[14:15] op_sel:[0,0,1] op_sel_hi:[1,0,1]
    v_pk_fma_f32 v[78:79], v[218:219], v[14:15], v[14:15] op_sel:[0,0,1] op_sel_hi:[1,0,1]
    v_pk_fma_f32 v[80:81], v[220:221], v[14:15], v[14:15] op_sel:[0,0,1] op_sel_hi:[1,0,1]
    v_pk_fma_f32 v[82:83], v[222:223], v[14:15], v[14:15] op_sel:[0,0,1] op_sel_hi:[1,0,1]
    v_cvt_pk_bf16_f32 v116, v76, v77
    v_cvt_pk_bf16_f32 v117, v78, v79
    v_cvt_pk_bf16_f32 v118, v80, v81
    v_cvt_pk_bf16_f32 v119, v82, v83
    v_and_b32 v116, -2, v116
    s_cmp_lg_u32 s55, 0
    s_cbranch_scc1 BS_221
    buffer_store_dwordx4 v[116:119], v0, s[32:35], s66 offen
BR_222:
    s_add_u32 s66, s66, 8192
    v_pk_fma_f32 v[84:85], v[224:225], v[14:15], v[14:15] op_sel:[0,0,1] op_sel_hi:[1,0,1]
    v_pk_fma_f32 v[86:87], v[226:227], v[14:15], v[14:15] op_sel:[0,0,1] op_sel_hi:[1,0,1]
    v_pk_fma_f32 v[88:89], v[228:229], v[14:15], v[14:15] op_sel:[0,0,1] op_sel_hi:[1,0,1]
    v_pk_fma_f32 v[90:91], v[230:231], v[14:15], v[14:15] op_sel:[0,0,1] op_sel_hi:[1,0,1]
    v_cvt_pk_bf16_f32 v120, v84, v85
    v_cvt_pk_bf16_f32 v121, v86, v87
    v_cvt_pk_bf16_f32 v122, v88, v89
    v_cvt_pk_bf16_f32 v123, v90, v91
    v_and_b32 v120, -2, v120
    s_cmp_lg_u32 s55, 0
    s_cbranch_scc1 BS_223
    buffer_store_dwordx4 v[120:123], v0, s[32:35], s66 offen
BR_224:
    s_add_u32 s66, s66, 8192
    v_pk_fma_f32 v[92:93], v[232:233], v[14:15], v[14:15] op_sel:[0,0,1] op_sel_hi:[1,0,1]
    v_pk_fma_f32 v[94:95], v[234:235], v[14:15], v[14:15] op_sel:[0,0,1] op_sel_hi:[1,0,1]
    v_pk_fma_f32 v[96:97], v[236:237], v[14:15], v[14:15] op_sel:[0,0,1] op_sel_hi:[1,0,1]
    v_pk_fma_f32 v[98:99], v[238:239], v[14:15], v[14:15] op_sel:[0,0,1] op_sel_hi:[1,0,1]
    v_cvt_pk_bf16_f32 v124, v92, v93
    v_cvt_pk_bf16_f32 v125, v94, v95
    v_cvt_pk_bf16_f32 v126, v96, v97
    v_cvt_pk_bf16_f32 v127, v98, v99
    v_and_b32 v124, -2, v124
    s_cmp_lg_u32 s55, 0
    s_cbranch_scc1 BS_225
    buffer_store_dwordx4 v[124:127], v0, s[32:35], s66 offen
BR_226:
    s_add_u32 s66, s66, 8192
    v_pk_fma_f32 v[100:101], v[240:241], v[14:15], v[14:15] op_sel:[0,0,1] op_sel_hi:[1,0,1]
    v_pk_fma_f32 v[102:103], v[242:243], v[14:15], v[14:15] op_sel:[0,0,1] op_sel_hi:[1,0,1]
    v_pk_fma_f32 v[104:105], v[244:245], v[14:15], v[14:15] op_sel:[0,0,1] op_sel_hi:[1,0,1]
    v_pk_fma_f32 v[106:107], v[246:247], v[14:15], v[14:15] op_sel:[0,0,1] op_sel_hi:[1,0,1]
    v_cvt_pk_bf16_f32 v128, v100, v101
    v_cvt_pk_bf16_f32 v129, v102, v103
    v_cvt_pk_bf16_f32 v130, v104, v105
    v_cvt_pk_bf16_f32 v131, v106, v107
    v_and_b32 v128, -2, v128
    s_cmp_lg_u32 s55, 0
    s_cbranch_scc1 BS_227
    buffer_store_dwordx4 v[128:131], v0, s[32:35], s66 offen
BR_228:
    s_add_u32 s66, s66, 8192
    v_pk_fma_f32 v[108:109], v[248:249], v[14:15], v[14:15] op_sel:[0,0,1] op_sel_hi:[1,0,1]
    v_pk_fma_f32 v[110:111], v[250:251], v[14:15], v[14:15] op_sel:[0,0,1] op_sel_hi:[1,0,1]
    v_pk_fma_f32 v[112:113], v[252:253], v[14:15], v[14:15] op_sel:[0,0,1] op_sel_hi:[1,0,1]
    v_pk_fma_f32 v[114:115], v[254:255], v[14:15], v[14:15] op_sel:[0,0,1] op_sel_hi:[1,0,1]
    v_cvt_pk_bf16_f32 v132, v108, v109
    v_cvt_pk_bf16_f32 v133, v110, v111
    v_cvt_pk_bf16_f32 v134, v112, v113
    v_cvt_pk_bf16_f32 v135, v114, v115
    v_and_b32 v132, -2, v132
    s_cmp_lg_u32 s55, 0
    s_cbranch_scc1 BS_229
    buffer_store_dwordx4 v[132:135], v0, s[32:35], s66 offen
    buffer_store_dword v13, v11, s[32:35], s68 offen offset:256
BR_230:
    s_setprio 0
SB_END:
    s_movk_i32 s63, 820
    v_add_u32 v42, 0, v1
    v_mul_u32_u24 v43, s63, v42
    v_lshrrev_b32 v43, 16, v43
    v_lshlrev_b32 v43, 1, v43
    v_xor_b32 v42, v42, v43
    v_lshlrev_b32 v36, 4, v42
    v_add_u32 v42, 64, v1
    v_mul_u32_u24 v43, s63, v42
    v_lshrrev_b32 v43, 16, v43
    v_lshlrev_b32 v43, 1, v43
    v_xor_b32 v42, v42, v43
    v_lshlrev_b32 v37, 4, v42
    v_add_u32 v42, 128, v1
    v_mul_u32_u24 v43, s63, v42
    v_lshrrev_b32 v43, 16, v43
    v_lshlrev_b32 v43, 1, v43
    v_xor_b32 v42, v42, v43
    v_lshlrev_b32 v38, 4, v42
    v_add_u32 v42, 192, v1
    v_mul_u32_u24 v43, s63, v42
    v_lshrrev_b32 v43, 16, v43
    v_lshlrev_b32 v43, 1, v43
    v_xor_b32 v42, v42, v43
    v_lshlrev_b32 v39, 4, v42
    v_add_u32 v42, 256, v1
    v_mul_u32_u24 v43, s63, v42
    v_lshrrev_b32 v43, 16, v43
    v_lshlrev_b32 v43, 1, v43
    v_xor_b32 v42, v42, v43
    v_lshlrev_b32 v40, 4, v42
    s_add_u32 s74, s70, 0
    s_add_u32 s75, s72, 0
    s_lshl_b32 s76, s28, 3
    s_add_u32 s76, s76, s74
    v_add_u32 v10, s75, v9
    v_add_u32 v16, s75, v36
    v_add_u32 v17, s75, v37
    v_add_u32 v18, s75, v38
    v_add_u32 v19, s75, v39
    v_add_u32 v20, s75, v40
    s_add_u32 s77, s73, 0
    s_lshl_b32 s66, s28, 13
    s_lshl_b32 s67, s74, 8
    s_add_u32 s66, s66, s67
    s_add_u32 s66, s66, 133120
    s_lshl_b32 s63, s74, 1
    s_lshr_b32 s63, 0xe4e4, s63
    s_and_b32 s63, s63, 3
    s_mul_i32 s63, s63, 122880
    s_mul_i32 s67, s28, 835584
    s_add_u32 s67, s67, s63
    s_add_u32 s67, s67, 0x1454000
    s_bitcmp1_b32 0xf0, s74
    s_cselect_b32 s80, 1, 0x10000
    s_and_b32 s63, s79, 31
    s_add_u32 s81, s66, s63
    s_add_u32 s81, s81, 5120
    s_add_u32 s68, s67, 40960
    s_add_u32 s69, s67, 81920
    s_mov_b32 s58, 0
PL_231:
    buffer_load_dword v13, v12, s[32:35], s66 offen sc1
    s_add_u32 s58, s58, 1
    s_waitcnt vmcnt(0)
    v_cmp_ne_u32 vcc, s53, v13
    s_nop 1
    s_cbranch_vccz PD_232
    s_cmp_lt_u32 s58, s57
    s_cbranch_scc1 PL_231
    s_mov_b32 s57, 0
PD_232:
    s_setprio 0
ML_233:
    buffer_load_dwordx4 v[76:79], v0, s[32:35], s67 offen sc1
    s_add_u32 s67, s67, 8192
    buffer_load_dwordx4 v[80:83], v0, s[32:35], s68 offen sc1
    s_add_u32 s68, s68, 8192
    buffer_load_dwordx4 v[84:87], v0, s[32:35], s69 offen sc1
    s_add_u32 s69, s69, 8192
    buffer_load_dwordx4 v[88:91], v0, s[32:35], s67 offen sc1
    s_add_u32 s67, s67, 8192
    buffer_load_dwordx4 v[92:95], v0, s[32:35], s68 offen sc1
    s_add_u32 s68, s68, 8192
    buffer_load_dwordx4 v[96:99], v0, s[32:35], s69 offen sc1
    s_add_u32 s69, s69, 8192
    buffer_load_dwordx4 v[100:103], v0, s[32:35], s67 offen sc1
    s_add_u32 s67, s67, 8192
    buffer_load_dwordx4 v[104:107], v0, s[32:35], s68 offen sc1
    s_add_u32 s68, s68, 8192
    buffer_load_dwordx4 v[108:111], v0, s[32:35], s69 offen sc1
    s_add_u32 s69, s69, 8192
    buffer_load_dwordx4 v[112:115], v0, s[32:35], s67 offen sc1
    s_add_u32 s67, s67, 8192
    buffer_load_dwordx4 v[116:119], v0, s[32:35], s68 offen sc1
    s_add_u32 s68, s68, 8192
    buffer_load_dwordx4 v[120:123], v0, s[32:35], s69 offen sc1
    s_add_u32 s69, s69, 8192
    buffer_load_dwordx4 v[124:127], v0, s[32:35], s67 offen sc1
    buffer_load_dwordx4 v[128:131], v0, s[32:35], s68 offen sc1
    buffer_load_dwordx4 v[132:135], v0, s[32:35], s69 offen sc1
    s_waitcnt vmcnt(14)
    v_dot2c_f32_bf16 v136, s89, v76
    v_dot2c_f32_bf16 v137, s90, v76
    v_dot2c_f32_bf16 v138, s89, v77
    v_dot2c_f32_bf16 v139, s90, v77
    v_dot2c_f32_bf16 v140, s89, v78
    v_dot2c_f32_bf16 v141, s90, v78
    v_dot2c_f32_bf16 v142, s89, v79
    v_dot2c_f32_bf16 v143, s90, v79
    s_waitcnt vmcnt(13)
    v_dot2c_f32_bf16 v136, s89, v80
    v_dot2c_f32_bf16 v137, s90, v80
    v_dot2c_f32_bf16 v138, s89, v81
    v_dot2c_f32_bf16 v139, s90, v81
    v_dot2c_f32_bf16 v140, s89, v82
    v_dot2c_f32_bf16 v141, s90, v82
    v_dot2c_f32_bf16 v142, s89, v83
    v_dot2c_f32_bf16 v143, s90, v83
    s_waitcnt vmcnt(12)
    v_or3_b32 v13, v77, v81, v85
    v_dot2c_f32_bf16 v136, s89, v84
    v_dot2c_f32_bf16 v137, s90, v84
    v_dot2c_f32_bf16 v138, s89, v85
    v_dot2c_f32_bf16 v139, s90, v85
    v_dot2c_f32_bf16 v140, s89, v86
    v_dot2c_f32_bf16 v141, s90, v86
    v_dot2c_f32_bf16 v142, s89, v87
    v_dot2c_f32_bf16 v143, s90, v87
    v_cvt_pk_bf16_f32 v44, v136, v137
    v_cvt_pk_bf16_f32 v45, v138, v139
    v_cvt_pk_bf16_f32 v46, v140, v141
    v_cvt_pk_bf16_f32 v47, v142, v143
    ds_write_b128 v10, v[44:47] offset:0
    s_waitcnt vmcnt(11)
    v_dot2c_f32_bf16 v144, s89, v88
    v_dot2c_f32_bf16 v145, s90, v88
    v_dot2c_f32_bf16 v146, s89, v89
    v_dot2c_f32_bf16 v147, s90, v89
    v_dot2c_f32_bf16 v148, s89, v90
    v_dot2c_f32_bf16 v149, s90, v90
    v_dot2c_f32_bf16 v150, s89, v91
    v_dot2c_f32_bf16 v151, s90, v91
    s_waitcnt vmcnt(10)
    v_or3_b32 v13, v13, v89, v93
    v_dot2c_f32_bf16 v144, s89, v92
    v_dot2c_f32_bf16 v145, s90, v92
    v_dot2c_f32_bf16 v146, s89, v93
    v_dot2c_f32_bf16 v147, s90, v93
    v_dot2c_f32_bf16 v148, s89, v94
    v_dot2c_f32_bf16 v149, s90, v94
    v_dot2c_f32_bf16 v150, s89, v95
    v_dot2c_f32_bf16 v151, s90, v95
    s_waitcnt vmcnt(9)
    v_dot2c_f32_bf16 v144, s89, v96
    v_dot2c_f32_bf16 v145, s90, v96
    v_dot2c_f32_bf16 v146, s89, v97
    v_dot2c_f32_bf16 v147, s90, v97
    v_dot2c_f32_bf16 v148, s89, v98
    v_dot2c_f32_bf16 v149, s90, v98
    v_dot2c_f32_bf16 v150, s89, v99
    v_dot2c_f32_bf16 v151, s90, v99
    v_cvt_pk_bf16_f32 v48, v144, v145
    v_cvt_pk_bf16_f32 v49, v146, v147
    v_cvt_pk_bf16_f32 v50, v148, v149
    v_cvt_pk_bf16_f32 v51, v150, v151
    ds_write_b128 v10, v[48:51] offset:256
    s_waitcnt vmcnt(8)
    v_or3_b32 v13, v13, v97, v101
    v_dot2c_f32_bf16 v152, s89, v100
    v_dot2c_f32_bf16 v153, s90, v100
    v_dot2c_f32_bf16 v154, s89, v101
    v_dot2c_f32_bf16 v155, s90, v101
    v_dot2c_f32_bf16 v156, s89, v102
    v_dot2c_f32_bf16 v157, s90, v102
    v_dot2c_f32_bf16 v158, s89, v103
    v_dot2c_f32_bf16 v159, s90, v103
    s_waitcnt vmcnt(7)
    v_dot2c_f32_bf16 v152, s89, v104
    v_dot2c_f32_bf16 v153, s90, v104
    v_dot2c_f32_bf16 v154, s89, v105
    v_dot2c_f32_bf16 v155, s90, v105
    v_dot2c_f32_bf16 v156, s89, v106
    v_dot2c_f32_bf16 v157, s90, v106
    v_dot2c_f32_bf16 v158, s89, v107
    v_dot2c_f32_bf16 v159, s90, v107
    s_waitcnt vmcnt(6)
    v_or3_b32 v13, v13, v105, v109
    v_dot2c_f32_bf16 v152, s89, v108
    v_dot2c_f32_bf16 v153, s90, v108
    v_dot2c_f32_bf16 v154, s89, v109
    v_dot2c_f32_bf16 v155, s90, v109
    v_dot2c_f32_bf16 v156, s89, v110
    v_dot2c_f32_bf16 v157, s90, v110
    v_dot2c_f32_bf16 v158, s89, v111
    v_dot2c_f32_bf16 v159, s90, v111
    v_cvt_pk_bf16_f32 v52, v152, v153
    v_cvt_pk_bf16_f32 v53, v154, v155
    v_cvt_pk_bf16_f32 v54, v156, v157
    v_cvt_pk_bf16_f32 v55, v158, v159
    ds_write_b128 v10, v[52:55] offset:512
    s_waitcnt vmcnt(5)
    v_dot2c_f32_bf16 v160, s89, v112
    v_dot2c_f32_bf16 v161, s90, v112
    v_dot2c_f32_bf16 v162, s89, v113
    v_dot2c_f32_bf16 v163, s90, v113
    v_dot2c_f32_bf16 v164, s89, v114
    v_dot2c_f32_bf16 v165, s90, v114
    v_dot2c_f32_bf16 v166, s89, v115
    v_dot2c_f32_bf16 v167, s90, v115
    s_waitcnt vmcnt(4)
    v_or3_b32 v13, v13, v113, v117
    v_dot2c_f32_bf16 v160, s89, v116
    v_dot2c_f32_bf16 v161, s90, v116
    v_dot2c_f32_bf16 v162, s89, v117
    v_dot2c_f32_bf16 v163, s90, v117
    v_dot2c_f32_bf16 v164, s89, v118
    v_dot2c_f32_bf16 v165, s90, v118
    v_dot2c_f32_bf16 v166, s89, v119
    v_dot2c_f32_bf16 v167, s90, v119
    s_waitcnt vmcnt(3)
    v_dot2c_f32_bf16 v160, s89, v120
    v_dot2c_f32_bf16 v161, s90, v120
    v_dot2c_f32_bf16 v162, s89, v121
    v_dot2c_f32_bf16 v163, s90, v121
    v_dot2c_f32_bf16 v164, s89, v122
    v_dot2c_f32_bf16 v165, s90, v122
    v_dot2c_f32_bf16 v166, s89, v123
    v_dot2c_f32_bf16 v167, s90, v123
    v_cvt_pk_bf16_f32 v56, v160, v161
    v_cvt_pk_bf16_f32 v57, v162, v163
    v_cvt_pk_bf16_f32 v58, v164, v165
    v_cvt_pk_bf16_f32 v59, v166, v167
    ds_write_b128 v10, v[56:59] offset:768
    s_waitcnt vmcnt(2)
    v_or3_b32 v13, v13, v121, v125
    v_dot2c_f32_bf16 v168, s89, v124
    v_dot2c_f32_bf16 v169, s90, v124
    v_dot2c_f32_bf16 v170, s89, v125
    v_dot2c_f32_bf16 v171, s90, v125
    v_dot2c_f32_bf16 v172, s89, v126
    v_dot2c_f32_bf16 v173, s90, v126
    v_dot2c_f32_bf16 v174, s89, v127
    v_dot2c_f32_bf16 v175, s90, v127
    s_waitcnt vmcnt(1)
    v_dot2c_f32_bf16 v168, s89, v128
    v_dot2c_f32_bf16 v169, s90, v128
    v_dot2c_f32_bf16 v170, s89, v129
    v_dot2c_f32_bf16 v171, s90, v129
    v_dot2c_f32_bf16 v172, s89, v130
    v_dot2c_f32_bf16 v173, s90, v130
    v_dot2c_f32_bf16 v174, s89, v131
    v_dot2c_f32_bf16 v175, s90, v131
    s_waitcnt vmcnt(0)
    v_or3_b32 v13, v13, v129, v133
    v_and_b32 v13, s80, v13
    v_cmp_ne_u32 vcc, 0, v13
    v_dot2c_f32_bf16 v168, s89, v132
    v_dot2c_f32_bf16 v169, s90, v132
    v_dot2c_f32_bf16 v170, s89, v133
    v_dot2c_f32_bf16 v171, s90, v133
    v_dot2c_f32_bf16 v172, s89, v134
    v_dot2c_f32_bf16 v173, s90, v134
    v_dot2c_f32_bf16 v174, s89, v135
    v_dot2c_f32_bf16 v175, s90, v135
    s_cbranch_vccnz MF_234
MO_235:
    v_cvt_pk_bf16_f32 v60, v168, v169
    v_cvt_pk_bf16_f32 v61, v170, v171
    v_cvt_pk_bf16_f32 v62, v172, v173
    v_cvt_pk_bf16_f32 v63, v174, v175
    ds_write_b128 v10, v[60:63] offset:1024
    s_cmp_ge_u32 s74, 4
    s_cbranch_scc1 MQ_236
    v_mov_b32 v13, s53
    s_cmp_lg_u32 s55, 0
    s_cbranch_scc1 BS_237
    buffer_store_dword v13, v11, s[32:35], s81 offen
BR_238:
MQ_236:
    ds_read_b128 v[76:79], v16
    ds_read_b128 v[80:83], v17
    ds_read_b128 v[84:87], v18
    ds_read_b128 v[88:91], v19
    ds_read_b128 v[92:95], v20
    s_add_u32 s66, s77, 4096
    s_waitcnt lgkmcnt(4)
    buffer_store_dwordx4 v[76:79], v2, s[40:43], s77 offen offset:0 sc1
    s_waitcnt lgkmcnt(3)
    buffer_store_dwordx4 v[80:83], v2, s[40:43], s77 offen offset:1024 sc1
    s_waitcnt lgkmcnt(2)
    buffer_store_dwordx4 v[84:87], v2, s[40:43], s77 offen offset:2048 sc1
    s_waitcnt lgkmcnt(1)
    buffer_store_dwordx4 v[88:91], v2, s[40:43], s77 offen offset:3072 sc1
    s_waitcnt lgkmcnt(0)
    buffer_store_dwordx4 v[92:95], v2, s[40:43], s66 offen offset:0 sc1
    s_setprio 0
    s_add_u32 s74, s70, 3
    s_add_u32 s75, s72, 40960
    s_lshl_b32 s76, s28, 3
    s_add_u32 s76, s76, s74
    v_add_u32 v10, s75, v9
    v_add_u32 v16, s75, v36
    v_add_u32 v17, s75, v37
    v_add_u32 v18, s75, v38
    v_add_u32 v19, s75, v39
    v_add_u32 v20, s75, v40
    s_add_u32 s77, s73, 983040
    s_lshl_b32 s66, s28, 13
    s_lshl_b32 s67, s74, 8
    s_add_u32 s66, s66, s67
    s_add_u32 s66, s66, 133120
    s_lshl_b32 s63, s74, 1
    s_lshr_b32 s63, 0xe4e4, s63
    s_and_b32 s63, s63, 3
    s_mul_i32 s63, s63, 122880
    s_mul_i32 s67, s28, 835584
    s_add_u32 s67, s67, s63
    s_add_u32 s67, s67, 0x1454000
    s_bitcmp1_b32 0xf0, s74
    s_cselect_b32 s80, 1, 0x10000
    s_and_b32 s63, s79, 31
    s_add_u32 s81, s66, s63
    s_add_u32 s81, s81, 5120
    s_add_u32 s68, s67, 40960
    s_add_u32 s69, s67, 81920
    s_mov_b32 s58, 0
PL_239:
    buffer_load_dword v13, v12, s[32:35], s66 offen sc1
    s_add_u32 s58, s58, 1
    s_waitcnt vmcnt(0)
    v_cmp_ne_u32 vcc, s53, v13
    s_nop 1
    s_cbranch_vccz PD_240
    s_cmp_lt_u32 s58, s57
    s_cbranch_scc1 PL_239
    s_mov_b32 s57, 0
PD_240:
    s_setprio 0
ML_241:
    buffer_load_dwordx4 v[76:79], v0, s[32:35], s67 offen sc1
    s_add_u32 s67, s67, 8192
    buffer_load_dwordx4 v[80:83], v0, s[32:35], s68 offen sc1
    s_add_u32 s68, s68, 8192
    buffer_load_dwordx4 v[84:87], v0, s[32:35], s69 offen sc1
    s_add_u32 s69, s69, 8192
    buffer_load_dwordx4 v[88:91], v0, s[32:35], s67 offen sc1
    s_add_u32 s67, s67, 8192
    buffer_load_dwordx4 v[92:95], v0, s[32:35], s68 offen sc1
    s_add_u32 s68, s68, 8192
    buffer_load_dwordx4 v[96:99], v0, s[32:35], s69 offen sc1
    s_add_u32 s69, s69, 8192
    buffer_load_dwordx4 v[100:103], v0, s[32:35], s67 offen sc1
    s_add_u32 s67, s67, 8192
    buffer_load_dwordx4 v[104:107], v0, s[32:35], s68 offen sc1
    s_add_u32 s68, s68, 8192
    buffer_load_dwordx4 v[108:111], v0, s[32:35], s69 offen sc1
    s_add_u32 s69, s69, 8192
    buffer_load_dwordx4 v[112:115], v0, s[32:35], s67 offen sc1
    s_add_u32 s67, s67, 8192
    buffer_load_dwordx4 v[116:119], v0, s[32:35], s68 offen sc1
    s_add_u32 s68, s68, 8192
    buffer_load_dwordx4 v[120:123], v0, s[32:35], s69 offen sc1
    s_add_u32 s69, s69, 8192
    buffer_load_dwordx4 v[124:127], v0, s[32:35], s67 offen sc1
    buffer_load_dwordx4 v[128:131], v0, s[32:35], s68 offen sc1
    buffer_load_dwordx4 v[132:135], v0, s[32:35], s69 offen sc1
    s_waitcnt vmcnt(14)
    v_dot2c_f32_bf16 v176, s89, v76
    v_dot2c_f32_bf16 v177, s90, v76
    v_dot2c_f32_bf16 v178, s89, v77
    v_dot2c_f32_bf16 v179, s90, v77
    v_dot2c_f32_bf16 v180, s89, v78
    v_dot2c_f32_bf16 v181, s90, v78
    v_dot2c_f32_bf16 v182, s89, v79
    v_dot2c_f32_bf16 v183, s90, v79
    s_waitcnt vmcnt(13)
    v_dot2c_f32_bf16 v176, s89, v80
    v_dot2c_f32_bf16 v177, s90, v80
    v_dot2c_f32_bf16 v178, s89, v81
    v_dot2c_f32_bf16 v179, s90, v81
    v_dot2c_f32_bf16 v180, s89, v82
    v_dot2c_f32_bf16 v181, s90, v82
    v_dot2c_f32_bf16 v182, s89, v83
    v_dot2c_f32_bf16 v183, s90, v83
    s_waitcnt vmcnt(12)
    v_or3_b32 v13, v77, v81, v85
    v_dot2c_f32_bf16 v176, s89, v84
    v_dot2c_f32_bf16 v177, s90, v84
    v_dot2c_f32_bf16 v178, s89, v85
    v_dot2c_f32_bf16 v179, s90, v85
    v_dot2c_f32_bf16 v180, s89, v86
    v_dot2c_f32_bf16 v181, s90, v86
    v_dot2c_f32_bf16 v182, s89, v87
    v_dot2c_f32_bf16 v183, s90, v87
    v_cvt_pk_bf16_f32 v44, v176, v177
    v_cvt_pk_bf16_f32 v45, v178, v179
    v_cvt_pk_bf16_f32 v46, v180, v181
    v_cvt_pk_bf16_f32 v47, v182, v183
    ds_write_b128 v10, v[44:47] offset:0
    s_waitcnt vmcnt(11)
    v_dot2c_f32_bf16 v184, s89, v88
    v_dot2c_f32_bf16 v185, s90, v88
    v_dot2c_f32_bf16 v186, s89, v89
    v_dot2c_f32_bf16 v187, s90, v89
    v_dot2c_f32_bf16 v188, s89, v90
    v_dot2c_f32_bf16 v189, s90, v90
    v_dot2c_f32_bf16 v190, s89, v91
    v_dot2c_f32_bf16 v191, s90, v91
    s_waitcnt vmcnt(10)
    v_or3_b32 v13, v13, v89, v93
    v_dot2c_f32_bf16 v184, s89, v92
    v_dot2c_f32_bf16 v185, s90, v92
    v_dot2c_f32_bf16 v186, s89, v93
    v_dot2c_f32_bf16 v187, s90, v93
    v_dot2c_f32_bf16 v188, s89, v94
    v_dot2c_f32_bf16 v189, s90, v94
    v_dot2c_f32_bf16 v190, s89, v95
    v_dot2c_f32_bf16 v191, s90, v95
    s_waitcnt vmcnt(9)
    v_dot2c_f32_bf16 v184, s89, v96
    v_dot2c_f32_bf16 v185, s90, v96
    v_dot2c_f32_bf16 v186, s89, v97
    v_dot2c_f32_bf16 v187, s90, v97
    v_dot2c_f32_bf16 v188, s89, v98
    v_dot2c_f32_bf16 v189, s90, v98
    v_dot2c_f32_bf16 v190, s89, v99
    v_dot2c_f32_bf16 v191, s90, v99
    v_cvt_pk_bf16_f32 v48, v184, v185
    v_cvt_pk_bf16_f32 v49, v186, v187
    v_cvt_pk_bf16_f32 v50, v188, v189
    v_cvt_pk_bf16_f32 v51, v190, v191
    ds_write_b128 v10, v[48:51] offset:256
    s_waitcnt vmcnt(8)
    v_or3_b32 v13, v13, v97, v101
    v_dot2c_f32_bf16 v192, s89, v100
    v_dot2c_f32_bf16 v193, s90, v100
    v_dot2c_f32_bf16 v194, s89, v101
    v_dot2c_f32_bf16 v195, s90, v101
    v_dot2c_f32_bf16 v196, s89, v102
    v_dot2c_f32_bf16 v197, s90, v102
    v_dot2c_f32_bf16 v198, s89, v103
    v_dot2c_f32_bf16 v199, s90, v103
    s_waitcnt vmcnt(7)
    v_dot2c_f32_bf16 v192, s89, v104
    v_dot2c_f32_bf16 v193, s90, v104
    v_dot2c_f32_bf16 v194, s89, v105
    v_dot2c_f32_bf16 v195, s90, v105
    v_dot2c_f32_bf16 v196, s89, v106
    v_dot2c_f32_bf16 v197, s90, v106
    v_dot2c_f32_bf16 v198, s89, v107
    v_dot2c_f32_bf16 v199, s90, v107
    s_waitcnt vmcnt(6)
    v_or3_b32 v13, v13, v105, v109
    v_dot2c_f32_bf16 v192, s89, v108
    v_dot2c_f32_bf16 v193, s90, v108
    v_dot2c_f32_bf16 v194, s89, v109
    v_dot2c_f32_bf16 v195, s90, v109
    v_dot2c_f32_bf16 v196, s89, v110
    v_dot2c_f32_bf16 v197, s90, v110
    v_dot2c_f32_bf16 v198, s89, v111
    v_dot2c_f32_bf16 v199, s90, v111
    v_cvt_pk_bf16_f32 v52, v192, v193
    v_cvt_pk_bf16_f32 v53, v194, v195
    v_cvt_pk_bf16_f32 v54, v196, v197
    v_cvt_pk_bf16_f32 v55, v198, v199
    ds_write_b128 v10, v[52:55] offset:512
    s_waitcnt vmcnt(5)
    v_dot2c_f32_bf16 v200, s89, v112
    v_dot2c_f32_bf16 v201, s90, v112
    v_dot2c_f32_bf16 v202, s89, v113
    v_dot2c_f32_bf16 v203, s90, v113
    v_dot2c_f32_bf16 v204, s89, v114
    v_dot2c_f32_bf16 v205, s90, v114
    v_dot2c_f32_bf16 v206, s89, v115
    v_dot2c_f32_bf16 v207, s90, v115
    s_waitcnt vmcnt(4)
    v_or3_b32 v13, v13, v113, v117
    v_dot2c_f32_bf16 v200, s89, v116
    v_dot2c_f32_bf16 v201, s90, v116
    v_dot2c_f32_bf16 v202, s89, v117
    v_dot2c_f32_bf16 v203, s90, v117
    v_dot2c_f32_bf16 v204, s89, v118
    v_dot2c_f32_bf16 v205, s90, v118
    v_dot2c_f32_bf16 v206, s89, v119
    v_dot2c_f32_bf16 v207, s90, v119
    s_waitcnt vmcnt(3)
    v_dot2c_f32_bf16 v200, s89, v120
    v_dot2c_f32_bf16 v201, s90, v120
    v_dot2c_f32_bf16 v202, s89, v121
    v_dot2c_f32_bf16 v203, s90, v121
    v_dot2c_f32_bf16 v204, s89, v122
    v_dot2c_f32_bf16 v205, s90, v122
    v_dot2c_f32_bf16 v206, s89, v123
    v_dot2c_f32_bf16 v207, s90, v123
    v_cvt_pk_bf16_f32 v56, v200, v201
    v_cvt_pk_bf16_f32 v57, v202, v203
    v_cvt_pk_bf16_f32 v58, v204, v205
    v_cvt_pk_bf16_f32 v59, v206, v207
    ds_write_b128 v10, v[56:59] offset:768
    s_waitcnt vmcnt(2)
    v_or3_b32 v13, v13, v121, v125
    v_dot2c_f32_bf16 v208, s89, v124
    v_dot2c_f32_bf16 v209, s90, v124
    v_dot2c_f32_bf16 v210, s89, v125
    v_dot2c_f32_bf16 v211, s90, v125
    v_dot2c_f32_bf16 v212, s89, v126
    v_dot2c_f32_bf16 v213, s90, v126
    v_dot2c_f32_bf16 v214, s89, v127
    v_dot2c_f32_bf16 v215, s90, v127
    s_waitcnt vmcnt(1)
    v_dot2c_f32_bf16 v208, s89, v128
    v_dot2c_f32_bf16 v209, s90, v128
    v_dot2c_f32_bf16 v210, s89, v129
    v_dot2c_f32_bf16 v211, s90, v129
    v_dot2c_f32_bf16 v212, s89, v130
    v_dot2c_f32_bf16 v213, s90, v130
    v_dot2c_f32_bf16 v214, s89, v131
    v_dot2c_f32_bf16 v215, s90, v131
    s_waitcnt vmcnt(0)
    v_or3_b32 v13, v13, v129, v133
    v_and_b32 v13, s80, v13
    v_cmp_ne_u32 vcc, 0, v13
    v_dot2c_f32_bf16 v208, s89, v132
    v_dot2c_f32_bf16 v209, s90, v132
    v_dot2c_f32_bf16 v210, s89, v133
    v_dot2c_f32_bf16 v211, s90, v133
    v_dot2c_f32_bf16 v212, s89, v134
    v_dot2c_f32_bf16 v213, s90, v134
    v_dot2c_f32_bf16 v214, s89, v135
    v_dot2c_f32_bf16 v215, s90, v135
    s_cbranch_vccnz MF_242
MO_243:
    v_cvt_pk_bf16_f32 v60, v208, v209
    v_cvt_pk_bf16_f32 v61, v210, v211
    v_cvt_pk_bf16_f32 v62, v212, v213
    v_cvt_pk_bf16_f32 v63, v214, v215
    ds_write_b128 v10, v[60:63] offset:1024
    s_cmp_ge_u32 s74, 4
    s_cbranch_scc1 MQ_244
    v_mov_b32 v13, s53
    s_cmp_lg_u32 s55, 0
    s_cbranch_scc1 BS_245
    buffer_store_dword v13, v11, s[32:35], s81 offen
BR_246:
MQ_244:
    ds_read_b128 v[76:79], v16
    ds_read_b128 v[80:83], v17
    ds_read_b128 v[84:87], v18
    ds_read_b128 v[88:91], v19
    ds_read_b128 v[92:95], v20
    s_add_u32 s66, s77, 4096
    s_waitcnt lgkmcnt(4)
    buffer_store_dwordx4 v[76:79], v2, s[40:43], s77 offen offset:0 sc1
    s_waitcnt lgkmcnt(3)
    buffer_store_dwordx4 v[80:83], v2, s[40:43], s77 offen offset:1024 sc1
    s_waitcnt lgkmcnt(2)
    buffer_store_dwordx4 v[84:87], v2, s[40:43], s77 offen offset:2048 sc1
    s_waitcnt lgkmcnt(1)
    buffer_store_dwordx4 v[88:91], v2, s[40:43], s77 offen offset:3072 sc1
    s_waitcnt lgkmcnt(0)
    buffer_store_dwordx4 v[92:95], v2, s[40:43], s66 offen offset:0 sc1
    s_setprio 0
    s_add_u32 s74, s70, 6
    s_cmp_gt_u32 s74, 7
    s_cbranch_scc1 SC_END
    s_add_u32 s75, s72, 81920
    s_lshl_b32 s76, s28, 3
    s_add_u32 s76, s76, s74
    v_add_u32 v10, s75, v9
    v_add_u32 v16, s75, v36
    v_add_u32 v17, s75, v37
    v_add_u32 v18, s75, v38
    v_add_u32 v19, s75, v39
    v_add_u32 v20, s75, v40
    s_add_u32 s77, s73, 1966080
    s_lshl_b32 s66, s28, 13
    s_lshl_b32 s67, s74, 8
    s_add_u32 s66, s66, s67
    s_add_u32 s66, s66, 133120
    s_lshl_b32 s63, s74, 1
    s_lshr_b32 s63, 0xe4e4, s63
    s_and_b32 s63, s63, 3
    s_mul_i32 s63, s63, 122880
    s_mul_i32 s67, s28, 835584
    s_add_u32 s67, s67, s63
    s_add_u32 s67, s67, 0x1454000
    s_bitcmp1_b32 0xf0, s74
    s_cselect_b32 s80, 1, 0x10000
    s_and_b32 s63, s79, 31
    s_add_u32 s81, s66, s63
    s_add_u32 s81, s81, 5120
    s_add_u32 s68, s67, 40960
    s_add_u32 s69, s67, 81920
    s_mov_b32 s58, 0
PL_247:
    buffer_load_dword v13, v12, s[32:35], s66 offen sc1
    s_add_u32 s58, s58, 1
    s_waitcnt vmcnt(0)
    v_cmp_ne_u32 vcc, s53, v13
    s_nop 1
    s_cbranch_vccz PD_248
    s_cmp_lt_u32 s58, s57
    s_cbranch_scc1 PL_247
    s_mov_b32 s57, 0
PD_248:
    s_setprio 0
ML_249:
    buffer_load_dwordx4 v[76:79], v0, s[32:35], s67 offen sc1
    s_add_u32 s67, s67, 8192
    buffer_load_dwordx4 v[80:83], v0, s[32:35], s68 offen sc1
    s_add_u32 s68, s68, 8192
    buffer_load_dwordx4 v[84:87], v0, s[32:35], s69 offen sc1
    s_add_u32 s69, s69, 8192
    buffer_load_dwordx4 v[88:91], v0, s[32:35], s67 offen sc1
    s_add_u32 s67, s67, 8192
    buffer_load_dwordx4 v[92:95], v0, s[32:35], s68 offen sc1
    s_add_u32 s68, s68, 8192
    buffer_load_dwordx4 v[96:99], v0, s[32:35], s69 offen sc1
    s_add_u32 s69, s69, 8192
    buffer_load_dwordx4 v[100:103], v0, s[32:35], s67 offen sc1
    s_add_u32 s67, s67, 8192
    buffer_load_dwordx4 v[104:107], v0, s[32:35], s68 offen sc1
    s_add_u32 s68, s68, 8192
    buffer_load_dwordx4 v[108:111], v0, s[32:35], s69 offen sc1
    s_add_u32 s69, s69, 8192
    buffer_load_dwordx4 v[112:115], v0, s[32:35], s67 offen sc1
    s_add_u32 s67, s67, 8192
    buffer_load_dwordx4 v[116:119], v0, s[32:35], s68 offen sc1
    s_add_u32 s68, s68, 8192
    buffer_load_dwordx4 v[120:123], v0, s[32:35], s69 offen sc1
    s_add_u32 s69, s69, 8192
    buffer_load_dwordx4 v[124:127], v0, s[32:35], s67 offen sc1
    buffer_load_dwordx4 v[128:131], v0, s[32:35], s68 offen sc1
    buffer_load_dwordx4 v[132:135], v0, s[32:35], s69 offen sc1
    s_waitcnt vmcnt(14)
    v_dot2c_f32_bf16 v216, s89, v76
    v_dot2c_f32_bf16 v217, s90, v76
    v_dot2c_f32_bf16 v218, s89, v77
    v_dot2c_f32_bf16 v219, s90, v77
    v_dot2c_f32_bf16 v220, s89, v78
    v_dot2c_f32_bf16 v221, s90, v78
    v_dot2c_f32_bf16 v222, s89, v79
    v_dot2c_f32_bf16 v223, s90, v79
    s_waitcnt vmcnt(13)
    v_dot2c_f32_bf16 v216, s89, v80
    v_dot2c_f32_bf16 v217, s90, v80
    v_dot2c_f32_bf16 v218, s89, v81
    v_dot2c_f32_bf16 v219, s90, v81
    v_dot2c_f32_bf16 v220, s89, v82
    v_dot2c_f32_bf16 v221, s90, v82
    v_dot2c_f32_bf16 v222, s89, v83
    v_dot2c_f32_bf16 v223, s90, v83
    s_waitcnt vmcnt(12)
    v_or3_b32 v13, v77, v81, v85
    v_dot2c_f32_bf16 v216, s89, v84
    v_dot2c_f32_bf16 v217, s90, v84
    v_dot2c_f32_bf16 v218, s89, v85
    v_dot2c_f32_bf16 v219, s90, v85
    v_dot2c_f32_bf16 v220, s89, v86
    v_dot2c_f32_bf16 v221, s90, v86
    v_dot2c_f32_bf16 v222, s89, v87
    v_dot2c_f32_bf16 v223, s90, v87
    v_cvt_pk_bf16_f32 v44, v216, v217
    v_cvt_pk_bf16_f32 v45, v218, v219
    v_cvt_pk_bf16_f32 v46, v220, v221
    v_cvt_pk_bf16_f32 v47, v222, v223
    ds_write_b128 v10, v[44:47] offset:0
    s_waitcnt vmcnt(11)
    v_dot2c_f32_bf16 v224, s89, v88
    v_dot2c_f32_bf16 v225, s90, v88
    v_dot2c_f32_bf16 v226, s89, v89
    v_dot2c_f32_bf16 v227, s90, v89
    v_dot2c_f32_bf16 v228, s89, v90
    v_dot2c_f32_bf16 v229, s90, v90
    v_dot2c_f32_bf16 v230, s89, v91
    v_dot2c_f32_bf16 v231, s90, v91
    s_waitcnt vmcnt(10)
    v_or3_b32 v13, v13, v89, v93
    v_dot2c_f32_bf16 v224, s89, v92
    v_dot2c_f32_bf16 v225, s90, v92
    v_dot2c_f32_bf16 v226, s89, v93
    v_dot2c_f32_bf16 v227, s90, v93
    v_dot2c_f32_bf16 v228, s89, v94
    v_dot2c_f32_bf16 v229, s90, v94
    v_dot2c_f32_bf16 v230, s89, v95
    v_dot2c_f32_bf16 v231, s90, v95
    s_waitcnt vmcnt(9)
    v_dot2c_f32_bf16 v224, s89, v96
    v_dot2c_f32_bf16 v225, s90, v96
    v_dot2c_f32_bf16 v226, s89, v97
    v_dot2c_f32_bf16 v227, s90, v97
    v_dot2c_f32_bf16 v228, s89, v98
    v_dot2c_f32_bf16 v229, s90, v98
    v_dot2c_f32_bf16 v230, s89, v99
    v_dot2c_f32_bf16 v231, s90, v99
    v_cvt_pk_bf16_f32 v48, v224, v225
    v_cvt_pk_bf16_f32 v49, v226, v227
    v_cvt_pk_bf16_f32 v50, v228, v229
    v_cvt_pk_bf16_f32 v51, v230, v231
    ds_write_b128 v10, v[48:51] offset:256
    s_waitcnt vmcnt(8)
    v_or3_b32 v13, v13, v97, v101
    v_dot2c_f32_bf16 v232, s89, v100
    v_dot2c_f32_bf16 v233, s90, v100
    v_dot2c_f32_bf16 v234, s89, v101
    v_dot2c_f32_bf16 v235, s90, v101
    v_dot2c_f32_bf16 v236, s89, v102
    v_dot2c_f32_bf16 v237, s90, v102
    v_dot2c_f32_bf16 v238, s89, v103
    v_dot2c_f32_bf16 v239, s90, v103
    s_waitcnt vmcnt(7)
    v_dot2c_f32_bf16 v232, s89, v104
    v_dot2c_f32_bf16 v233, s90, v104
    v_dot2c_f32_bf16 v234, s89, v105
    v_dot2c_f32_bf16 v235, s90, v105
    v_dot2c_f32_bf16 v236, s89, v106
    v_dot2c_f32_bf16 v237, s90, v106
    v_dot2c_f32_bf16 v238, s89, v107
    v_dot2c_f32_bf16 v239, s90, v107
    s_waitcnt vmcnt(6)
    v_or3_b32 v13, v13, v105, v109
    v_dot2c_f32_bf16 v232, s89, v108
    v_dot2c_f32_bf16 v233, s90, v108
    v_dot2c_f32_bf16 v234, s89, v109
    v_dot2c_f32_bf16 v235, s90, v109
    v_dot2c_f32_bf16 v236, s89, v110
    v_dot2c_f32_bf16 v237, s90, v110
    v_dot2c_f32_bf16 v238, s89, v111
    v_dot2c_f32_bf16 v239, s90, v111
    v_cvt_pk_bf16_f32 v52, v232, v233
    v_cvt_pk_bf16_f32 v53, v234, v235
    v_cvt_pk_bf16_f32 v54, v236, v237
    v_cvt_pk_bf16_f32 v55, v238, v239
    ds_write_b128 v10, v[52:55] offset:512
    s_waitcnt vmcnt(5)
    v_dot2c_f32_bf16 v240, s89, v112
    v_dot2c_f32_bf16 v241, s90, v112
    v_dot2c_f32_bf16 v242, s89, v113
    v_dot2c_f32_bf16 v243, s90, v113
    v_dot2c_f32_bf16 v244, s89, v114
    v_dot2c_f32_bf16 v245, s90, v114
    v_dot2c_f32_bf16 v246, s89, v115
    v_dot2c_f32_bf16 v247, s90, v115
    s_waitcnt vmcnt(4)
    v_or3_b32 v13, v13, v113, v117
    v_dot2c_f32_bf16 v240, s89, v116
    v_dot2c_f32_bf16 v241, s90, v116
    v_dot2c_f32_bf16 v242, s89, v117
    v_dot2c_f32_bf16 v243, s90, v117
    v_dot2c_f32_bf16 v244, s89, v118
    v_dot2c_f32_bf16 v245, s90, v118
    v_dot2c_f32_bf16 v246, s89, v119
    v_dot2c_f32_bf16 v247, s90, v119
    s_waitcnt vmcnt(3)
    v_dot2c_f32_bf16 v240, s89, v120
    v_dot2c_f32_bf16 v241, s90, v120
    v_dot2c_f32_bf16 v242, s89, v121
    v_dot2c_f32_bf16 v243, s90, v121
    v_dot2c_f32_bf16 v244, s89, v122
    v_dot2c_f32_bf16 v245, s90, v122
    v_dot2c_f32_bf16 v246, s89, v123
    v_dot2c_f32_bf16 v247, s90, v123
    v_cvt_pk_bf16_f32 v56, v240, v241
    v_cvt_pk_bf16_f32 v57, v242, v243
    v_cvt_pk_bf16_f32 v58, v244, v245
    v_cvt_pk_bf16_f32 v59, v246, v247
    ds_write_b128 v10, v[56:59] offset:768
    s_waitcnt vmcnt(2)
    v_or3_b32 v13, v13, v121, v125
    v_dot2c_f32_bf16 v248, s89, v124
    v_dot2c_f32_bf16 v249, s90, v124
    v_dot2c_f32_bf16 v250, s89, v125
    v_dot2c_f32_bf16 v251, s90, v125
    v_dot2c_f32_bf16 v252, s89, v126
    v_dot2c_f32_bf16 v253, s90, v126
    v_dot2c_f32_bf16 v254, s89, v127
    v_dot2c_f32_bf16 v255, s90, v127
    s_waitcnt vmcnt(1)
    v_dot2c_f32_bf16 v248, s89, v128
    v_dot2c_f32_bf16 v249, s90, v128
    v_dot2c_f32_bf16 v250, s89, v129
    v_dot2c_f32_bf16 v251, s90, v129
    v_dot2c_f32_bf16 v252, s89, v130
    v_dot2c_f32_bf16 v253, s90, v130
    v_dot2c_f32_bf16 v254, s89, v131
    v_dot2c_f32_bf16 v255, s90, v131
    s_waitcnt vmcnt(0)
    v_or3_b32 v13, v13, v129, v133
    v_and_b32 v13, s80, v13
    v_cmp_ne_u32 vcc, 0, v13
    v_dot2c_f32_bf16 v248, s89, v132
    v_dot2c_f32_bf16 v249, s90, v132
    v_dot2c_f32_bf16 v250, s89, v133
    v_dot2c_f32_bf16 v251, s90, v133
    v_dot2c_f32_bf16 v252, s89, v134
    v_dot2c_f32_bf16 v253, s90, v134
    v_dot2c_f32_bf16 v254, s89, v135
    v_dot2c_f32_bf16 v255, s90, v135
    s_cbranch_vccnz MF_250
MO_251:
    v_cvt_pk_bf16_f32 v60, v248, v249
    v_cvt_pk_bf16_f32 v61, v250, v251
    v_cvt_pk_bf16_f32 v62, v252, v253
    v_cvt_pk_bf16_f32 v63, v254, v255
    ds_write_b128 v10, v[60:63] offset:1024
    s_cmp_ge_u32 s74, 4
    s_cbranch_scc1 MQ_252
    v_mov_b32 v13, s53
    s_cmp_lg_u32 s55, 0
    s_cbranch_scc1 BS_253
    buffer_store_dword v13, v11, s[32:35], s81 offen
BR_254:
MQ_252:
    ds_read_b128 v[76:79], v16
    ds_read_b128 v[80:83], v17
    ds_read_b128 v[84:87], v18
    ds_read_b128 v[88:91], v19
    ds_read_b128 v[92:95], v20
    s_add_u32 s66, s77, 4096
    s_waitcnt lgkmcnt(4)
    buffer_store_dwordx4 v[76:79], v2, s[40:43], s77 offen offset:0 sc1
    s_waitcnt lgkmcnt(3)
    buffer_store_dwordx4 v[80:83], v2, s[40:43], s77 offen offset:1024 sc1
    s_waitcnt lgkmcnt(2)
    buffer_store_dwordx4 v[84:87], v2, s[40:43], s77 offen offset:2048 sc1
    s_waitcnt lgkmcnt(1)
    buffer_store_dwordx4 v[88:91], v2, s[40:43], s77 offen offset:3072 sc1
    s_waitcnt lgkmcnt(0)
    buffer_store_dwordx4 v[92:95], v2, s[40:43], s66 offen offset:0 sc1
    s_setprio 0
SC_END:
    s_endpgm
BS_135:
    buffer_store_dwordx4 v[36:39], v0, s[32:35], s66 offen sc1
    s_add_u32 s66, s66, 8192
    buffer_store_dwordx4 v[36:39], v0, s[32:35], s66 offen sc1
    s_add_u32 s66, s66, 8192
    buffer_store_dwordx4 v[36:39], v0, s[32:35], s66 offen sc1
    s_add_u32 s66, s66, 8192
    buffer_store_dwordx4 v[36:39], v0, s[32:35], s66 offen sc1
    s_add_u32 s66, s66, 8192
    buffer_store_dwordx4 v[36:39], v0, s[32:35], s66 offen sc1
    s_branch BR_136
CS_137:
    s_mov_b32 s58, 0
CL_255:
    ds_read_b128 v[116:119], v30
    s_add_u32 s58, s58, 1
    s_waitcnt lgkmcnt(0)
    v_min_u32 v116, v116, v117
    v_min3_u32 v116, v116, v118, v119
    v_cmp_gt_u32 vcc, v31, v116
    s_nop 1
    s_cbranch_vccz CR_138
    s_cmp_lt_u32 s58, 80000
    s_cbranch_scc1 CL_255
    s_branch CR_138
BS_139:
    buffer_store_dwordx4 v[116:119], v0, s[32:35], s66 offen sc1
    s_branch BR_140
BS_141:
    buffer_store_dwordx4 v[120:123], v0, s[32:35], s66 offen sc1
    s_branch BR_142
BS_143:
    buffer_store_dwordx4 v[124:127], v0, s[32:35], s66 offen sc1
    s_branch BR_144
BS_145:
    buffer_store_dwordx4 v[128:131], v0, s[32:35], s66 offen sc1
    s_branch BR_146
BS_147:
    buffer_store_dwordx4 v[132:135], v0, s[32:35], s66 offen sc1
    buffer_store_dword v13, v11, s[32:35], s68 offen offset:0 sc1
    s_branch BR_148
BS_149:
    buffer_store_dwordx4 v[36:39], v0, s[32:35], s66 offen sc1
    s_add_u32 s66, s66, 8192
    buffer_store_dwordx4 v[36:39], v0, s[32:35], s66 offen sc1
    s_add_u32 s66, s66, 8192
    buffer_store_dwordx4 v[36:39], v0, s[32:35], s66 offen sc1
    s_add_u32 s66, s66, 8192
    buffer_store_dwordx4 v[36:39], v0, s[32:35], s66 offen sc1
    s_add_u32 s66, s66, 8192
    buffer_store_dwordx4 v[36:39], v0, s[32:35], s66 offen sc1
    s_branch BR_150
SA_F1:
    s_mov_b32 s58, 0
SA_YL1:
    s_add_u32 s67, s74, 0
    s_min_u32 s67, s67, 7
    s_lshl_b32 s67, s67, 3
    s_add_u32 s67, s67, s28
    s_mul_i32 s67, s67, 40960
    s_add_u32 s67, s67, 0x700000
    s_mov_b64 exec, s[94:95]
    buffer_load_dwordx4 v[116:119], v8, s[32:35], s67 offen offset:0 sc1
    s_mov_b64 exec, s[96:97]
    buffer_load_dwordx4 v[120:123], v8, s[32:35], s67 offen offset:2048 sc1
    s_mov_b64 exec, s[98:99]
    s_add_u32 s67, s67, 4096
    buffer_load_dwordx4 v[124:127], v8, s[32:35], s67 offen offset:0 sc1
    s_mov_b64 exec, s[100:101]
    buffer_load_dwordx4 v[128:131], v8, s[32:35], s67 offen offset:2048 sc1
    s_mov_b64 exec, s[82:83]
    s_add_u32 s67, s67, 4096
    buffer_load_dwordx4 v[132:135], v8, s[32:35], s67 offen offset:0 sc1
    s_add_u32 s58, s58, 1
    s_mov_b64 exec, s[94:95]
    s_waitcnt vmcnt(4)
    v_max3_u32 v10, v116, v117, v118
    ds_write_b128 v28, v[116:119] offset:0
    v_max_u32 v10, v10, v119
    v_cmp_eq_u32 s[94:95], -1, v10
    s_mov_b64 exec, s[96:97]
    s_waitcnt vmcnt(3)
    v_max3_u32 v10, v120, v121, v122
    ds_write_b128 v28, v[120:123] offset:1024
    v_max_u32 v10, v10, v123
    v_cmp_eq_u32 s[96:97], -1, v10
    s_mov_b64 exec, s[98:99]
    s_waitcnt vmcnt(2)
    v_max3_u32 v10, v124, v125, v126
    ds_write_b128 v28, v[124:127] offset:2048
    v_max_u32 v10, v10, v127
    v_cmp_eq_u32 s[98:99], -1, v10
    s_mov_b64 exec, s[100:101]
    s_waitcnt vmcnt(1)
    v_max3_u32 v10, v128, v129, v130
    ds_write_b128 v28, v[128:131] offset:3072
    v_max_u32 v10, v10, v131
    v_cmp_eq_u32 s[100:101], -1, v10
    s_mov_b64 exec, s[82:83]
    s_waitcnt vmcnt(0)
    v_max3_u32 v10, v132, v133, v134
    ds_write_b128 v28, v[132:135] offset:4096
    v_max_u32 v10, v10, v135
    v_cmp_eq_u32 s[82:83], -1, v10
    s_mov_b64 exec, -1
    s_or_b64 s[64:65], s[94:95], s[96:97]
    s_or_b64 s[80:81], s[98:99], s[100:101]
    s_or_b64 s[64:65], s[64:65], s[82:83]
    s_or_b64 s[80:81], s[80:81], s[64:65]
    s_cbranch_scc0 SA_G1
    s_cmp_lt_u32 s58, s57
    s_cbranch_scc1 SA_YL1
    s_mov_b32 s57, 0
    s_branch SA_G1
CS_151:
    s_mov_b32 s58, 0
CL_256:
    ds_read_b128 v[116:119], v30
    s_add_u32 s58, s58, 1
    s_waitcnt lgkmcnt(0)
    v_min_u32 v116, v116, v117
    v_min3_u32 v116, v116, v118, v119
    v_cmp_gt_u32 vcc, v31, v116
    s_nop 1
    s_cbranch_vccz CR_152
    s_cmp_lt_u32 s58, 80000
    s_cbranch_scc1 CL_256
    s_branch CR_152
BS_153:
    buffer_store_dwordx4 v[116:119], v0, s[32:35], s66 offen sc1
    s_branch BR_154
BS_155:
    buffer_store_dwordx4 v[120:123], v0, s[32:35], s66 offen sc1
    s_branch BR_156
BS_157:
    buffer_store_dwordx4 v[124:127], v0, s[32:35], s66 offen sc1
    s_branch BR_158
BS_159:
    buffer_store_dwordx4 v[128:131], v0, s[32:35], s66 offen sc1
    s_branch BR_160
BS_161:
    buffer_store_dwordx4 v[132:135], v0, s[32:35], s66 offen sc1
    buffer_store_dword v13, v11, s[32:35], s68 offen offset:0 sc1
    s_branch BR_162
BS_163:
    buffer_store_dwordx4 v[36:39], v0, s[32:35], s66 offen sc1
    s_add_u32 s66, s66, 8192
    buffer_store_dwordx4 v[36:39], v0, s[32:35], s66 offen sc1
    s_add_u32 s66, s66, 8192
    buffer_store_dwordx4 v[36:39], v0, s[32:35], s66 offen sc1
    s_add_u32 s66, s66, 8192
    buffer_store_dwordx4 v[36:39], v0, s[32:35], s66 offen sc1
    s_add_u32 s66, s66, 8192
    buffer_store_dwordx4 v[36:39], v0, s[32:35], s66 offen sc1
    s_branch BR_164
SA_F2:
    s_mov_b32 s58, 0
SA_YL2:
    s_add_u32 s67, s74, 0
    s_min_u32 s67, s67, 7
    s_lshl_b32 s67, s67, 3
    s_add_u32 s67, s67, s28
    s_mul_i32 s67, s67, 40960
    s_add_u32 s67, s67, 0x700000
    s_mov_b64 exec, s[94:95]
    buffer_load_dwordx4 v[116:119], v8, s[32:35], s67 offen offset:0 sc1
    s_mov_b64 exec, s[96:97]
    buffer_load_dwordx4 v[120:123], v8, s[32:35], s67 offen offset:2048 sc1
    s_mov_b64 exec, s[98:99]
    s_add_u32 s67, s67, 4096
    buffer_load_dwordx4 v[124:127], v8, s[32:35], s67 offen offset:0 sc1
    s_mov_b64 exec, s[100:101]
    buffer_load_dwordx4 v[128:131], v8, s[32:35], s67 offen offset:2048 sc1
    s_mov_b64 exec, s[82:83]
    s_add_u32 s67, s67, 4096
    buffer_load_dwordx4 v[132:135], v8, s[32:35], s67 offen offset:0 sc1
    s_add_u32 s58, s58, 1
    s_mov_b64 exec, s[94:95]
    s_waitcnt vmcnt(4)
    v_max3_u32 v10, v116, v117, v118
    ds_write_b128 v28, v[116:119] offset:0
    v_max_u32 v10, v10, v119
    v_cmp_eq_u32 s[94:95], -1, v10
    s_mov_b64 exec, s[96:97]
    s_waitcnt vmcnt(3)
    v_max3_u32 v10, v120, v121, v122
    ds_write_b128 v28, v[120:123] offset:1024
    v_max_u32 v10, v10, v123
    v_cmp_eq_u32 s[96:97], -1, v10
    s_mov_b64 exec, s[98:99]
    s_waitcnt vmcnt(2)
    v_max3_u32 v10, v124, v125, v126
    ds_write_b128 v28, v[124:127] offset:2048
    v_max_u32 v10, v10, v127
    v_cmp_eq_u32 s[98:99], -1, v10
    s_mov_b64 exec, s[100:101]
    s_waitcnt vmcnt(1)
    v_max3_u32 v10, v128, v129, v130
    ds_write_b128 v28, v[128:131] offset:3072
    v_max_u32 v10, v10, v131
    v_cmp_eq_u32 s[100:101], -1, v10
    s_mov_b64 exec, s[82:83]
    s_waitcnt vmcnt(0)
    v_max3_u32 v10, v132, v133, v134
    ds_write_b128 v28, v[132:135] offset:4096
    v_max_u32 v10, v10, v135
    v_cmp_eq_u32 s[82:83], -1, v10
    s_mov_b64 exec, -1
    s_or_b64 s[64:65], s[94:95], s[96:97]
    s_or_b64 s[80:81], s[98:99], s[100:101]
    s_or_b64 s[64:65], s[64:65], s[82:83]
    s_or_b64 s[80:81], s[80:81], s[64:65]
    s_cbranch_scc0 SA_G2
    s_cmp_lt_u32 s58, s57
    s_cbranch_scc1 SA_YL2
    s_mov_b32 s57, 0
    s_branch SA_G2
CS_165:
    s_mov_b32 s58, 0
CL_257:
    ds_read_b128 v[116:119], v30
    s_add_u32 s58, s58, 1
    s_waitcnt lgkmcnt(0)
    v_min_u32 v116, v116, v117
    v_min3_u32 v116, v116, v118, v119
    v_cmp_gt_u32 vcc, v31, v116
    s_nop 1
    s_cbranch_vccz CR_166
    s_cmp_lt_u32 s58, 80000
    s_cbranch_scc1 CL_257
    s_branch CR_166
BS_167:
    buffer_store_dwordx4 v[116:119], v0, s[32:35], s66 offen sc1
    s_branch BR_168
BS_169:
    buffer_store_dwordx4 v[120:123], v0, s[32:35], s66 offen sc1
    s_branch BR_170
BS_171:
    buffer_store_dwordx4 v[124:127], v0, s[32:35], s66 offen sc1
    s_branch BR_172
BS_173:
    buffer_store_dwordx4 v[128:131], v0, s[32:35], s66 offen sc1
    s_branch BR_174
BS_175:
    buffer_store_dwordx4 v[132:135], v0, s[32:35], s66 offen sc1
    buffer_store_dword v13, v11, s[32:35], s68 offen offset:0 sc1
    s_branch BR_176
BS_183:
    buffer_store_dword v13, v11, s[32:35], s81 offen sc1
    s_branch BR_184
MF_180:
    s_add_u32 s58, s58, 1
    s_cmp_ge_u32 s58, s57
    s_cbranch_scc1 MO_181
    s_xor_b32 s89, s89, 0x8000
    s_xor_b32 s90, s90, 0x80000000
    v_dot2c_f32_bf16 v136, s89, v76
    v_dot2c_f32_bf16 v137, s90, v76
    v_dot2c_f32_bf16 v138, s89, v77
    v_dot2c_f32_bf16 v139, s90, v77
    v_dot2c_f32_bf16 v140, s89, v78
    v_dot2c_f32_bf16 v141, s90, v78
    v_dot2c_f32_bf16 v142, s89, v79
    v_dot2c_f32_bf16 v143, s90, v79
    v_dot2c_f32_bf16 v136, s89, v80
    v_dot2c_f32_bf16 v137, s90, v80
    v_dot2c_f32_bf16 v138, s89, v81
    v_dot2c_f32_bf16 v139, s90, v81
    v_dot2c_f32_bf16 v140, s89, v82
    v_dot2c_f32_bf16 v141, s90, v82
    v_dot2c_f32_bf16 v142, s89, v83
    v_dot2c_f32_bf16 v143, s90, v83
    v_dot2c_f32_bf16 v136, s89, v84
    v_dot2c_f32_bf16 v137, s90, v84
    v_dot2c_f32_bf16 v138, s89, v85
    v_dot2c_f32_bf16 v139, s90, v85
    v_dot2c_f32_bf16 v140, s89, v86
    v_dot2c_f32_bf16 v141, s90, v86
    v_dot2c_f32_bf16 v142, s89, v87
    v_dot2c_f32_bf16 v143, s90, v87
    v_dot2c_f32_bf16 v144, s89, v88
    v_dot2c_f32_bf16 v145, s90, v88
    v_dot2c_f32_bf16 v146, s89, v89
    v_dot2c_f32_bf16 v147, s90, v89
    v_dot2c_f32_bf16 v148, s89, v90
    v_dot2c_f32_bf16 v149, s90, v90
    v_dot2c_f32_bf16 v150, s89, v91
    v_dot2c_f32_bf16 v151, s90, v91
    v_dot2c_f32_bf16 v144, s89, v92
    v_dot2c_f32_bf16 v145, s90, v92
    v_dot2c_f32_bf16 v146, s89, v93
    v_dot2c_f32_bf16 v147, s90, v93
    v_dot2c_f32_bf16 v148, s89, v94
    v_dot2c_f32_bf16 v149, s90, v94
    v_dot2c_f32_bf16 v150, s89, v95
    v_dot2c_f32_bf16 v151, s90, v95
    v_dot2c_f32_bf16 v144, s89, v96
    v_dot2c_f32_bf16 v145, s90, v96
    v_dot2c_f32_bf16 v146, s89, v97
    v_dot2c_f32_bf16 v147, s90, v97
    v_dot2c_f32_bf16 v148, s89, v98
    v_dot2c_f32_bf16 v149, s90, v98
    v_dot2c_f32_bf16 v150, s89, v99
    v_dot2c_f32_bf16 v151, s90, v99
    v_dot2c_f32_bf16 v152, s89, v100
    v_dot2c_f32_bf16 v153, s90, v100
    v_dot2c_f32_bf16 v154, s89, v101
    v_dot2c_f32_bf16 v155, s90, v101
    v_dot2c_f32_bf16 v156, s89, v102
    v_dot2c_f32_bf16 v157, s90, v102
    v_dot2c_f32_bf16 v158, s89, v103
    v_dot2c_f32_bf16 v159, s90, v103
    v_dot2c_f32_bf16 v152, s89, v104
    v_dot2c_f32_bf16 v153, s90, v104
    v_dot2c_f32_bf16 v154, s89, v105
    v_dot2c_f32_bf16 v155, s90, v105
    v_dot2c_f32_bf16 v156, s89, v106
    v_dot2c_f32_bf16 v157, s90, v106
    v_dot2c_f32_bf16 v158, s89, v107
    v_dot2c_f32_bf16 v159, s90, v107
    v_dot2c_f32_bf16 v152, s89, v108
    v_dot2c_f32_bf16 v153, s90, v108
    v_dot2c_f32_bf16 v154, s89, v109
    v_dot2c_f32_bf16 v155, s90, v109
    v_dot2c_f32_bf16 v156, s89, v110
    v_dot2c_f32_bf16 v157, s90, v110
    v_dot2c_f32_bf16 v158, s89, v111
    v_dot2c_f32_bf16 v159, s90, v111
    v_dot2c_f32_bf16 v160, s89, v112
    v_dot2c_f32_bf16 v161, s90, v112
    v_dot2c_f32_bf16 v162, s89, v113
    v_dot2c_f32_bf16 v163, s90, v113
    v_dot2c_f32_bf16 v164, s89, v114
    v_dot2c_f32_bf16 v165, s90, v114
    v_dot2c_f32_bf16 v166, s89, v115
    v_dot2c_f32_bf16 v167, s90, v115
    v_dot2c_f32_bf16 v160, s89, v116
    v_dot2c_f32_bf16 v161, s90, v116
    v_dot2c_f32_bf16 v162, s89, v117
    v_dot2c_f32_bf16 v163, s90, v117
    v_dot2c_f32_bf16 v164, s89, v118
    v_dot2c_f32_bf16 v165, s90, v118
    v_dot2c_f32_bf16 v166, s89, v119
    v_dot2c_f32_bf16 v167, s90, v119
    v_dot2c_f32_bf16 v160, s89, v120
    v_dot2c_f32_bf16 v161, s90, v120
    v_dot2c_f32_bf16 v162, s89, v121
    v_dot2c_f32_bf16 v163, s90, v121
    v_dot2c_f32_bf16 v164, s89, v122
    v_dot2c_f32_bf16 v165, s90, v122
    v_dot2c_f32_bf16 v166, s89, v123
    v_dot2c_f32_bf16 v167, s90, v123
    v_dot2c_f32_bf16 v168, s89, v124
    v_dot2c_f32_bf16 v169, s90, v124
    v_dot2c_f32_bf16 v170, s89, v125
    v_dot2c_f32_bf16 v171, s90, v125
    v_dot2c_f32_bf16 v172, s89, v126
    v_dot2c_f32_bf16 v173, s90, v126
    v_dot2c_f32_bf16 v174, s89, v127
    v_dot2c_f32_bf16 v175, s90, v127
    v_dot2c_f32_bf16 v168, s89, v128
    v_dot2c_f32_bf16 v169, s90, v128
    v_dot2c_f32_bf16 v170, s89, v129
    v_dot2c_f32_bf16 v171, s90, v129
    v_dot2c_f32_bf16 v172, s89, v130
    v_dot2c_f32_bf16 v173, s90, v130
    v_dot2c_f32_bf16 v174, s89, v131
    v_dot2c_f32_bf16 v175, s90, v131
    v_dot2c_f32_bf16 v168, s89, v132
    v_dot2c_f32_bf16 v169, s90, v132
    v_dot2c_f32_bf16 v170, s89, v133
    v_dot2c_f32_bf16 v171, s90, v133
    v_dot2c_f32_bf16 v172, s89, v134
    v_dot2c_f32_bf16 v173, s90, v134
    v_dot2c_f32_bf16 v174, s89, v135
    v_dot2c_f32_bf16 v175, s90, v135
    s_xor_b32 s89, s89, 0x8000
    s_xor_b32 s90, s90, 0x80000000
    s_sub_u32 s67, s67, 32768
    s_sub_u32 s68, s68, 32768
    s_sub_u32 s69, s69, 32768
    s_branch ML_179
BS_185:
    buffer_store_dwordx4 v[116:119], v0, s[32:35], s66 offen sc1
    s_branch BR_186
BS_187:
    buffer_store_dwordx4 v[120:123], v0, s[32:35], s66 offen sc1
    s_branch BR_188
BS_189:
    buffer_store_dwordx4 v[124:127], v0, s[32:35], s66 offen sc1
    s_branch BR_190
BS_191:
    buffer_store_dwordx4 v[128:131], v0, s[32:35], s66 offen sc1
    s_branch BR_192
BS_193:
    buffer_store_dwordx4 v[132:135], v0, s[32:35], s66 offen sc1
    buffer_store_dword v13, v11, s[32:35], s68 offen offset:256 sc1
    s_branch BR_194
BS_201:
    buffer_store_dword v13, v11, s[32:35], s81 offen sc1
    s_branch BR_202
MF_198:
    s_add_u32 s58, s58, 1
    s_cmp_ge_u32 s58, s57
    s_cbranch_scc1 MO_199
    s_xor_b32 s89, s89, 0x8000
    s_xor_b32 s90, s90, 0x80000000
    v_dot2c_f32_bf16 v176, s89, v76
    v_dot2c_f32_bf16 v177, s90, v76
    v_dot2c_f32_bf16 v178, s89, v77
    v_dot2c_f32_bf16 v179, s90, v77
    v_dot2c_f32_bf16 v180, s89, v78
    v_dot2c_f32_bf16 v181, s90, v78
    v_dot2c_f32_bf16 v182, s89, v79
    v_dot2c_f32_bf16 v183, s90, v79
    v_dot2c_f32_bf16 v176, s89, v80
    v_dot2c_f32_bf16 v177, s90, v80
    v_dot2c_f32_bf16 v178, s89, v81
    v_dot2c_f32_bf16 v179, s90, v81
    v_dot2c_f32_bf16 v180, s89, v82
    v_dot2c_f32_bf16 v181, s90, v82
    v_dot2c_f32_bf16 v182, s89, v83
    v_dot2c_f32_bf16 v183, s90, v83
    v_dot2c_f32_bf16 v176, s89, v84
    v_dot2c_f32_bf16 v177, s90, v84
    v_dot2c_f32_bf16 v178, s89, v85
    v_dot2c_f32_bf16 v179, s90, v85
    v_dot2c_f32_bf16 v180, s89, v86
    v_dot2c_f32_bf16 v181, s90, v86
    v_dot2c_f32_bf16 v182, s89, v87
    v_dot2c_f32_bf16 v183, s90, v87
    v_dot2c_f32_bf16 v184, s89, v88
    v_dot2c_f32_bf16 v185, s90, v88
    v_dot2c_f32_bf16 v186, s89, v89
    v_dot2c_f32_bf16 v187, s90, v89
    v_dot2c_f32_bf16 v188, s89, v90
    v_dot2c_f32_bf16 v189, s90, v90
    v_dot2c_f32_bf16 v190, s89, v91
    v_dot2c_f32_bf16 v191, s90, v91
    v_dot2c_f32_bf16 v184, s89, v92
    v_dot2c_f32_bf16 v185, s90, v92
    v_dot2c_f32_bf16 v186, s89, v93
    v_dot2c_f32_bf16 v187, s90, v93
    v_dot2c_f32_bf16 v188, s89, v94
    v_dot2c_f32_bf16 v189, s90, v94
    v_dot2c_f32_bf16 v190, s89, v95
    v_dot2c_f32_bf16 v191, s90, v95
    v_dot2c_f32_bf16 v184, s89, v96
    v_dot2c_f32_bf16 v185, s90, v96
    v_dot2c_f32_bf16 v186, s89, v97
    v_dot2c_f32_bf16 v187, s90, v97
    v_dot2c_f32_bf16 v188, s89, v98
    v_dot2c_f32_bf16 v189, s90, v98
    v_dot2c_f32_bf16 v190, s89, v99
    v_dot2c_f32_bf16 v191, s90, v99
    v_dot2c_f32_bf16 v192, s89, v100
    v_dot2c_f32_bf16 v193, s90, v100
    v_dot2c_f32_bf16 v194, s89, v101
    v_dot2c_f32_bf16 v195, s90, v101
    v_dot2c_f32_bf16 v196, s89, v102
    v_dot2c_f32_bf16 v197, s90, v102
    v_dot2c_f32_bf16 v198, s89, v103
    v_dot2c_f32_bf16 v199, s90, v103
    v_dot2c_f32_bf16 v192, s89, v104
    v_dot2c_f32_bf16 v193, s90, v104
    v_dot2c_f32_bf16 v194, s89, v105
    v_dot2c_f32_bf16 v195, s90, v105
    v_dot2c_f32_bf16 v196, s89, v106
    v_dot2c_f32_bf16 v197, s90, v106
    v_dot2c_f32_bf16 v198, s89, v107
    v_dot2c_f32_bf16 v199, s90, v107
    v_dot2c_f32_bf16 v192, s89, v108
    v_dot2c_f32_bf16 v193, s90, v108
    v_dot2c_f32_bf16 v194, s89, v109
    v_dot2c_f32_bf16 v195, s90, v109
    v_dot2c_f32_bf16 v196, s89, v110
    v_dot2c_f32_bf16 v197, s90, v110
    v_dot2c_f32_bf16 v198, s89, v111
    v_dot2c_f32_bf16 v199, s90, v111
    v_dot2c_f32_bf16 v200, s89, v112
    v_dot2c_f32_bf16 v201, s90, v112
    v_dot2c_f32_bf16 v202, s89, v113
    v_dot2c_f32_bf16 v203, s90, v113
    v_dot2c_f32_bf16 v204, s89, v114
    v_dot2c_f32_bf16 v205, s90, v114
    v_dot2c_f32_bf16 v206, s89, v115
    v_dot2c_f32_bf16 v207, s90, v115
    v_dot2c_f32_bf16 v200, s89, v116
    v_dot2c_f32_bf16 v201, s90, v116
    v_dot2c_f32_bf16 v202, s89, v117
    v_dot2c_f32_bf16 v203, s90, v117
    v_dot2c_f32_bf16 v204, s89, v118
    v_dot2c_f32_bf16 v205, s90, v118
    v_dot2c_f32_bf16 v206, s89, v119
    v_dot2c_f32_bf16 v207, s90, v119
    v_dot2c_f32_bf16 v200, s89, v120
    v_dot2c_f32_bf16 v201, s90, v120
    v_dot2c_f32_bf16 v202, s89, v121
    v_dot2c_f32_bf16 v203, s90, v121
    v_dot2c_f32_bf16 v204, s89, v122
    v_dot2c_f32_bf16 v205, s90, v122
    v_dot2c_f32_bf16 v206, s89, v123
    v_dot2c_f32_bf16 v207, s90, v123
    v_dot2c_f32_bf16 v208, s89, v124
    v_dot2c_f32_bf16 v209, s90, v124
    v_dot2c_f32_bf16 v210, s89, v125
    v_dot2c_f32_bf16 v211, s90, v125
    v_dot2c_f32_bf16 v212, s89, v126
    v_dot2c_f32_bf16 v213, s90, v126
    v_dot2c_f32_bf16 v214, s89, v127
    v_dot2c_f32_bf16 v215, s90, v127
    v_dot2c_f32_bf16 v208, s89, v128
    v_dot2c_f32_bf16 v209, s90, v128
    v_dot2c_f32_bf16 v210, s89, v129
    v_dot2c_f32_bf16 v211, s90, v129
    v_dot2c_f32_bf16 v212, s89, v130
    v_dot2c_f32_bf16 v213, s90, v130
    v_dot2c_f32_bf16 v214, s89, v131
    v_dot2c_f32_bf16 v215, s90, v131
    v_dot2c_f32_bf16 v208, s89, v132
    v_dot2c_f32_bf16 v209, s90, v132
    v_dot2c_f32_bf16 v210, s89, v133
    v_dot2c_f32_bf16 v211, s90, v133
    v_dot2c_f32_bf16 v212, s89, v134
    v_dot2c_f32_bf16 v213, s90, v134
    v_dot2c_f32_bf16 v214, s89, v135
    v_dot2c_f32_bf16 v215, s90, v135
    s_xor_b32 s89, s89, 0x8000
    s_xor_b32 s90, s90, 0x80000000
    s_sub_u32 s67, s67, 32768
    s_sub_u32 s68, s68, 32768
    s_sub_u32 s69, s69, 32768
    s_branch ML_197
BS_203:
    buffer_store_dwordx4 v[116:119], v0, s[32:35], s66 offen sc1
    s_branch BR_204
BS_205:
    buffer_store_dwordx4 v[120:123], v0, s[32:35], s66 offen sc1
    s_branch BR_206
BS_207:
    buffer_store_dwordx4 v[124:127], v0, s[32:35], s66 offen sc1
    s_branch BR_208
BS_209:
    buffer_store_dwordx4 v[128:131], v0, s[32:35], s66 offen sc1
    s_branch BR_210
BS_211:
    buffer_store_dwordx4 v[132:135], v0, s[32:35], s66 offen sc1
    buffer_store_dword v13, v11, s[32:35], s68 offen offset:256 sc1
    s_branch BR_212
BS_219:
    buffer_store_dword v13, v11, s[32:35], s81 offen sc1
    s_branch BR_220
MF_216:
    s_add_u32 s58, s58, 1
    s_cmp_ge_u32 s58, s57
    s_cbranch_scc1 MO_217
    s_xor_b32 s89, s89, 0x8000
    s_xor_b32 s90, s90, 0x80000000
    v_dot2c_f32_bf16 v216, s89, v76
    v_dot2c_f32_bf16 v217, s90, v76
    v_dot2c_f32_bf16 v218, s89, v77
    v_dot2c_f32_bf16 v219, s90, v77
    v_dot2c_f32_bf16 v220, s89, v78
    v_dot2c_f32_bf16 v221, s90, v78
    v_dot2c_f32_bf16 v222, s89, v79
    v_dot2c_f32_bf16 v223, s90, v79
    v_dot2c_f32_bf16 v216, s89, v80
    v_dot2c_f32_bf16 v217, s90, v80
    v_dot2c_f32_bf16 v218, s89, v81
    v_dot2c_f32_bf16 v219, s90, v81
    v_dot2c_f32_bf16 v220, s89, v82
    v_dot2c_f32_bf16 v221, s90, v82
    v_dot2c_f32_bf16 v222, s89, v83
    v_dot2c_f32_bf16 v223, s90, v83
    v_dot2c_f32_bf16 v216, s89, v84
    v_dot2c_f32_bf16 v217, s90, v84
    v_dot2c_f32_bf16 v218, s89, v85
    v_dot2c_f32_bf16 v219, s90, v85
    v_dot2c_f32_bf16 v220, s89, v86
    v_dot2c_f32_bf16 v221, s90, v86
    v_dot2c_f32_bf16 v222, s89, v87
    v_dot2c_f32_bf16 v223, s90, v87
    v_dot2c_f32_bf16 v224, s89, v88
    v_dot2c_f32_bf16 v225, s90, v88
    v_dot2c_f32_bf16 v226, s89, v89
    v_dot2c_f32_bf16 v227, s90, v89
    v_dot2c_f32_bf16 v228, s89, v90
    v_dot2c_f32_bf16 v229, s90, v90
    v_dot2c_f32_bf16 v230, s89, v91
    v_dot2c_f32_bf16 v231, s90, v91
    v_dot2c_f32_bf16 v224, s89, v92
    v_dot2c_f32_bf16 v225, s90, v92
    v_dot2c_f32_bf16 v226, s89, v93
    v_dot2c_f32_bf16 v227, s90, v93
    v_dot2c_f32_bf16 v228, s89, v94
    v_dot2c_f32_bf16 v229, s90, v94
    v_dot2c_f32_bf16 v230, s89, v95
    v_dot2c_f32_bf16 v231, s90, v95
    v_dot2c_f32_bf16 v224, s89, v96
    v_dot2c_f32_bf16 v225, s90, v96
    v_dot2c_f32_bf16 v226, s89, v97
    v_dot2c_f32_bf16 v227, s90, v97
    v_dot2c_f32_bf16 v228, s89, v98
    v_dot2c_f32_bf16 v229, s90, v98
    v_dot2c_f32_bf16 v230, s89, v99
    v_dot2c_f32_bf16 v231, s90, v99
    v_dot2c_f32_bf16 v232, s89, v100
    v_dot2c_f32_bf16 v233, s90, v100
    v_dot2c_f32_bf16 v234, s89, v101
    v_dot2c_f32_bf16 v235, s90, v101
    v_dot2c_f32_bf16 v236, s89, v102
    v_dot2c_f32_bf16 v237, s90, v102
    v_dot2c_f32_bf16 v238, s89, v103
    v_dot2c_f32_bf16 v239, s90, v103
    v_dot2c_f32_bf16 v232, s89, v104
    v_dot2c_f32_bf16 v233, s90, v104
    v_dot2c_f32_bf16 v234, s89, v105
    v_dot2c_f32_bf16 v235, s90, v105
    v_dot2c_f32_bf16 v236, s89, v106
    v_dot2c_f32_bf16 v237, s90, v106
    v_dot2c_f32_bf16 v238, s89, v107
    v_dot2c_f32_bf16 v239, s90, v107
    v_dot2c_f32_bf16 v232, s89, v108
    v_dot2c_f32_bf16 v233, s90, v108
    v_dot2c_f32_bf16 v234, s89, v109
    v_dot2c_f32_bf16 v235, s90, v109
    v_dot2c_f32_bf16 v236, s89, v110
    v_dot2c_f32_bf16 v237, s90, v110
    v_dot2c_f32_bf16 v238, s89, v111
    v_dot2c_f32_bf16 v239, s90, v111
    v_dot2c_f32_bf16 v240, s89, v112
    v_dot2c_f32_bf16 v241, s90, v112
    v_dot2c_f32_bf16 v242, s89, v113
    v_dot2c_f32_bf16 v243, s90, v113
    v_dot2c_f32_bf16 v244, s89, v114
    v_dot2c_f32_bf16 v245, s90, v114
    v_dot2c_f32_bf16 v246, s89, v115
    v_dot2c_f32_bf16 v247, s90, v115
    v_dot2c_f32_bf16 v240, s89, v116
    v_dot2c_f32_bf16 v241, s90, v116
    v_dot2c_f32_bf16 v242, s89, v117
    v_dot2c_f32_bf16 v243, s90, v117
    v_dot2c_f32_bf16 v244, s89, v118
    v_dot2c_f32_bf16 v245, s90, v118
    v_dot2c_f32_bf16 v246, s89, v119
    v_dot2c_f32_bf16 v247, s90, v119
    v_dot2c_f32_bf16 v240, s89, v120
    v_dot2c_f32_bf16 v241, s90, v120
    v_dot2c_f32_bf16 v242, s89, v121
    v_dot2c_f32_bf16 v243, s90, v121
    v_dot2c_f32_bf16 v244, s89, v122
    v_dot2c_f32_bf16 v245, s90, v122
    v_dot2c_f32_bf16 v246, s89, v123
    v_dot2c_f32_bf16 v247, s90, v123
    v_dot2c_f32_bf16 v248, s89, v124
    v_dot2c_f32_bf16 v249, s90, v124
    v_dot2c_f32_bf16 v250, s89, v125
    v_dot2c_f32_bf16 v251, s90, v125
    v_dot2c_f32_bf16 v252, s89, v126
    v_dot2c_f32_bf16 v253, s90, v126
    v_dot2c_f32_bf16 v254, s89, v127
    v_dot2c_f32_bf16 v255, s90, v127
    v_dot2c_f32_bf16 v248, s89, v128
    v_dot2c_f32_bf16 v249, s90, v128
    v_dot2c_f32_bf16 v250, s89, v129
    v_dot2c_f32_bf16 v251, s90, v129
    v_dot2c_f32_bf16 v252, s89, v130
    v_dot2c_f32_bf16 v253, s90, v130
    v_dot2c_f32_bf16 v254, s89, v131
    v_dot2c_f32_bf16 v255, s90, v131
    v_dot2c_f32_bf16 v248, s89, v132
    v_dot2c_f32_bf16 v249, s90, v132
    v_dot2c_f32_bf16 v250, s89, v133
    v_dot2c_f32_bf16 v251, s90, v133
    v_dot2c_f32_bf16 v252, s89, v134
    v_dot2c_f32_bf16 v253, s90, v134
    v_dot2c_f32_bf16 v254, s89, v135
    v_dot2c_f32_bf16 v255, s90, v135
    s_xor_b32 s89, s89, 0x8000
    s_xor_b32 s90, s90, 0x80000000
    s_sub_u32 s67, s67, 32768
    s_sub_u32 s68, s68, 32768
    s_sub_u32 s69, s69, 32768
    s_branch ML_215
BS_221:
    buffer_store_dwordx4 v[116:119], v0, s[32:35], s66 offen sc1
    s_branch BR_222
BS_223:
    buffer_store_dwordx4 v[120:123], v0, s[32:35], s66 offen sc1
    s_branch BR_224
BS_225:
    buffer_store_dwordx4 v[124:127], v0, s[32:35], s66 offen sc1
    s_branch BR_226
BS_227:
    buffer_store_dwordx4 v[128:131], v0, s[32:35], s66 offen sc1
    s_branch BR_228
BS_229:
    buffer_store_dwordx4 v[132:135], v0, s[32:35], s66 offen sc1
    buffer_store_dword v13, v11, s[32:35], s68 offen offset:256 sc1
    s_branch BR_230
BS_237:
    buffer_store_dword v13, v11, s[32:35], s81 offen sc1
    s_branch BR_238
MF_234:
    s_add_u32 s58, s58, 1
    s_cmp_ge_u32 s58, s57
    s_cbranch_scc1 MO_235
    s_xor_b32 s89, s89, 0x8000
    s_xor_b32 s90, s90, 0x80000000
    v_dot2c_f32_bf16 v136, s89, v76
    v_dot2c_f32_bf16 v137, s90, v76
    v_dot2c_f32_bf16 v138, s89, v77
    v_dot2c_f32_bf16 v139, s90, v77
    v_dot2c_f32_bf16 v140, s89, v78
    v_dot2c_f32_bf16 v141, s90, v78
    v_dot2c_f32_bf16 v142, s89, v79
    v_dot2c_f32_bf16 v143, s90, v79
    v_dot2c_f32_bf16 v136, s89, v80
    v_dot2c_f32_bf16 v137, s90, v80
    v_dot2c_f32_bf16 v138, s89, v81
    v_dot2c_f32_bf16 v139, s90, v81
    v_dot2c_f32_bf16 v140, s89, v82
    v_dot2c_f32_bf16 v141, s90, v82
    v_dot2c_f32_bf16 v142, s89, v83
    v_dot2c_f32_bf16 v143, s90, v83
    v_dot2c_f32_bf16 v136, s89, v84
    v_dot2c_f32_bf16 v137, s90, v84
    v_dot2c_f32_bf16 v138, s89, v85
    v_dot2c_f32_bf16 v139, s90, v85
    v_dot2c_f32_bf16 v140, s89, v86
    v_dot2c_f32_bf16 v141, s90, v86
    v_dot2c_f32_bf16 v142, s89, v87
    v_dot2c_f32_bf16 v143, s90, v87
    v_dot2c_f32_bf16 v144, s89, v88
    v_dot2c_f32_bf16 v145, s90, v88
    v_dot2c_f32_bf16 v146, s89, v89
    v_dot2c_f32_bf16 v147, s90, v89
    v_dot2c_f32_bf16 v148, s89, v90
    v_dot2c_f32_bf16 v149, s90, v90
    v_dot2c_f32_bf16 v150, s89, v91
    v_dot2c_f32_bf16 v151, s90, v91
    v_dot2c_f32_bf16 v144, s89, v92
    v_dot2c_f32_bf16 v145, s90, v92
    v_dot2c_f32_bf16 v146, s89, v93
    v_dot2c_f32_bf16 v147, s90, v93
    v_dot2c_f32_bf16 v148, s89, v94
    v_dot2c_f32_bf16 v149, s90, v94
    v_dot2c_f32_bf16 v150, s89, v95
    v_dot2c_f32_bf16 v151, s90, v95
    v_dot2c_f32_bf16 v144, s89, v96
    v_dot2c_f32_bf16 v145, s90, v96
    v_dot2c_f32_bf16 v146, s89, v97
    v_dot2c_f32_bf16 v147, s90, v97
    v_dot2c_f32_bf16 v148, s89, v98
    v_dot2c_f32_bf16 v149, s90, v98
    v_dot2c_f32_bf16 v150, s89, v99
    v_dot2c_f32_bf16 v151, s90, v99
    v_dot2c_f32_bf16 v152, s89, v100
    v_dot2c_f32_bf16 v153, s90, v100
    v_dot2c_f32_bf16 v154, s89, v101
    v_dot2c_f32_bf16 v155, s90, v101
    v_dot2c_f32_bf16 v156, s89, v102
    v_dot2c_f32_bf16 v157, s90, v102
    v_dot2c_f32_bf16 v158, s89, v103
    v_dot2c_f32_bf16 v159, s90, v103
    v_dot2c_f32_bf16 v152, s89, v104
    v_dot2c_f32_bf16 v153, s90, v104
    v_dot2c_f32_bf16 v154, s89, v105
    v_dot2c_f32_bf16 v155, s90, v105
    v_dot2c_f32_bf16 v156, s89, v106
    v_dot2c_f32_bf16 v157, s90, v106
    v_dot2c_f32_bf16 v158, s89, v107
    v_dot2c_f32_bf16 v159, s90, v107
    v_dot2c_f32_bf16 v152, s89, v108
    v_dot2c_f32_bf16 v153, s90, v108
    v_dot2c_f32_bf16 v154, s89, v109
    v_dot2c_f32_bf16 v155, s90, v109
    v_dot2c_f32_bf16 v156, s89, v110
    v_dot2c_f32_bf16 v157, s90, v110
    v_dot2c_f32_bf16 v158, s89, v111
    v_dot2c_f32_bf16 v159, s90, v111
    v_dot2c_f32_bf16 v160, s89, v112
    v_dot2c_f32_bf16 v161, s90, v112
    v_dot2c_f32_bf16 v162, s89, v113
    v_dot2c_f32_bf16 v163, s90, v113
    v_dot2c_f32_bf16 v164, s89, v114
    v_dot2c_f32_bf16 v165, s90, v114
    v_dot2c_f32_bf16 v166, s89, v115
    v_dot2c_f32_bf16 v167, s90, v115
    v_dot2c_f32_bf16 v160, s89, v116
    v_dot2c_f32_bf16 v161, s90, v116
    v_dot2c_f32_bf16 v162, s89, v117
    v_dot2c_f32_bf16 v163, s90, v117
    v_dot2c_f32_bf16 v164, s89, v118
    v_dot2c_f32_bf16 v165, s90, v118
    v_dot2c_f32_bf16 v166, s89, v119
    v_dot2c_f32_bf16 v167, s90, v119
    v_dot2c_f32_bf16 v160, s89, v120
    v_dot2c_f32_bf16 v161, s90, v120
    v_dot2c_f32_bf16 v162, s89, v121
    v_dot2c_f32_bf16 v163, s90, v121
    v_dot2c_f32_bf16 v164, s89, v122
    v_dot2c_f32_bf16 v165, s90, v122
    v_dot2c_f32_bf16 v166, s89, v123
    v_dot2c_f32_bf16 v167, s90, v123
    v_dot2c_f32_bf16 v168, s89, v124
    v_dot2c_f32_bf16 v169, s90, v124
    v_dot2c_f32_bf16 v170, s89, v125
    v_dot2c_f32_bf16 v171, s90, v125
    v_dot2c_f32_bf16 v172, s89, v126
    v_dot2c_f32_bf16 v173, s90, v126
    v_dot2c_f32_bf16 v174, s89, v127
    v_dot2c_f32_bf16 v175, s90, v127
    v_dot2c_f32_bf16 v168, s89, v128
    v_dot2c_f32_bf16 v169, s90, v128
    v_dot2c_f32_bf16 v170, s89, v129
    v_dot2c_f32_bf16 v171, s90, v129
    v_dot2c_f32_bf16 v172, s89, v130
    v_dot2c_f32_bf16 v173, s90, v130
    v_dot2c_f32_bf16 v174, s89, v131
    v_dot2c_f32_bf16 v175, s90, v131
    v_dot2c_f32_bf16 v168, s89, v132
    v_dot2c_f32_bf16 v169, s90, v132
    v_dot2c_f32_bf16 v170, s89, v133
    v_dot2c_f32_bf16 v171, s90, v133
    v_dot2c_f32_bf16 v172, s89, v134
    v_dot2c_f32_bf16 v173, s90, v134
    v_dot2c_f32_bf16 v174, s89, v135
    v_dot2c_f32_bf16 v175, s90, v135
    s_xor_b32 s89, s89, 0x8000
    s_xor_b32 s90, s90, 0x80000000
    s_sub_u32 s67, s67, 32768
    s_sub_u32 s68, s68, 32768
    s_sub_u32 s69, s69, 32768
    s_branch ML_233
BS_245:
    buffer_store_dword v13, v11, s[32:35], s81 offen sc1
    s_branch BR_246
MF_242:
    s_add_u32 s58, s58, 1
    s_cmp_ge_u32 s58, s57
    s_cbranch_scc1 MO_243
    s_xor_b32 s89, s89, 0x8000
    s_xor_b32 s90, s90, 0x80000000
    v_dot2c_f32_bf16 v176, s89, v76
    v_dot2c_f32_bf16 v177, s90, v76
    v_dot2c_f32_bf16 v178, s89, v77
    v_dot2c_f32_bf16 v179, s90, v77
    v_dot2c_f32_bf16 v180, s89, v78
    v_dot2c_f32_bf16 v181, s90, v78
    v_dot2c_f32_bf16 v182, s89, v79
    v_dot2c_f32_bf16 v183, s90, v79
    v_dot2c_f32_bf16 v176, s89, v80
    v_dot2c_f32_bf16 v177, s90, v80
    v_dot2c_f32_bf16 v178, s89, v81
    v_dot2c_f32_bf16 v179, s90, v81
    v_dot2c_f32_bf16 v180, s89, v82
    v_dot2c_f32_bf16 v181, s90, v82
    v_dot2c_f32_bf16 v182, s89, v83
    v_dot2c_f32_bf16 v183, s90, v83
    v_dot2c_f32_bf16 v176, s89, v84
    v_dot2c_f32_bf16 v177, s90, v84
    v_dot2c_f32_bf16 v178, s89, v85
    v_dot2c_f32_bf16 v179, s90, v85
    v_dot2c_f32_bf16 v180, s89, v86
    v_dot2c_f32_bf16 v181, s90, v86
    v_dot2c_f32_bf16 v182, s89, v87
    v_dot2c_f32_bf16 v183, s90, v87
    v_dot2c_f32_bf16 v184, s89, v88
    v_dot2c_f32_bf16 v185, s90, v88
    v_dot2c_f32_bf16 v186, s89, v89
    v_dot2c_f32_bf16 v187, s90, v89
    v_dot2c_f32_bf16 v188, s89, v90
    v_dot2c_f32_bf16 v189, s90, v90
    v_dot2c_f32_bf16 v190, s89, v91
    v_dot2c_f32_bf16 v191, s90, v91
    v_dot2c_f32_bf16 v184, s89, v92
    v_dot2c_f32_bf16 v185, s90, v92
    v_dot2c_f32_bf16 v186, s89, v93
    v_dot2c_f32_bf16 v187, s90, v93
    v_dot2c_f32_bf16 v188, s89, v94
    v_dot2c_f32_bf16 v189, s90, v94
    v_dot2c_f32_bf16 v190, s89, v95
    v_dot2c_f32_bf16 v191, s90, v95
    v_dot2c_f32_bf16 v184, s89, v96
    v_dot2c_f32_bf16 v185, s90, v96
    v_dot2c_f32_bf16 v186, s89, v97
    v_dot2c_f32_bf16 v187, s90, v97
    v_dot2c_f32_bf16 v188, s89, v98
    v_dot2c_f32_bf16 v189, s90, v98
    v_dot2c_f32_bf16 v190, s89, v99
    v_dot2c_f32_bf16 v191, s90, v99
    v_dot2c_f32_bf16 v192, s89, v100
    v_dot2c_f32_bf16 v193, s90, v100
    v_dot2c_f32_bf16 v194, s89, v101
    v_dot2c_f32_bf16 v195, s90, v101
    v_dot2c_f32_bf16 v196, s89, v102
    v_dot2c_f32_bf16 v197, s90, v102
    v_dot2c_f32_bf16 v198, s89, v103
    v_dot2c_f32_bf16 v199, s90, v103
    v_dot2c_f32_bf16 v192, s89, v104
    v_dot2c_f32_bf16 v193, s90, v104
    v_dot2c_f32_bf16 v194, s89, v105
    v_dot2c_f32_bf16 v195, s90, v105
    v_dot2c_f32_bf16 v196, s89, v106
    v_dot2c_f32_bf16 v197, s90, v106
    v_dot2c_f32_bf16 v198, s89, v107
    v_dot2c_f32_bf16 v199, s90, v107
    v_dot2c_f32_bf16 v192, s89, v108
    v_dot2c_f32_bf16 v193, s90, v108
    v_dot2c_f32_bf16 v194, s89, v109
    v_dot2c_f32_bf16 v195, s90, v109
    v_dot2c_f32_bf16 v196, s89, v110
    v_dot2c_f32_bf16 v197, s90, v110
    v_dot2c_f32_bf16 v198, s89, v111
    v_dot2c_f32_bf16 v199, s90, v111
    v_dot2c_f32_bf16 v200, s89, v112
    v_dot2c_f32_bf16 v201, s90, v112
    v_dot2c_f32_bf16 v202, s89, v113
    v_dot2c_f32_bf16 v203, s90, v113
    v_dot2c_f32_bf16 v204, s89, v114
    v_dot2c_f32_bf16 v205, s90, v114
    v_dot2c_f32_bf16 v206, s89, v115
    v_dot2c_f32_bf16 v207, s90, v115
    v_dot2c_f32_bf16 v200, s89, v116
    v_dot2c_f32_bf16 v201, s90, v116
    v_dot2c_f32_bf16 v202, s89, v117
    v_dot2c_f32_bf16 v203, s90, v117
    v_dot2c_f32_bf16 v204, s89, v118
    v_dot2c_f32_bf16 v205, s90, v118
    v_dot2c_f32_bf16 v206, s89, v119
    v_dot2c_f32_bf16 v207, s90, v119
    v_dot2c_f32_bf16 v200, s89, v120
    v_dot2c_f32_bf16 v201, s90, v120
    v_dot2c_f32_bf16 v202, s89, v121
    v_dot2c_f32_bf16 v203, s90, v121
    v_dot2c_f32_bf16 v204, s89, v122
    v_dot2c_f32_bf16 v205, s90, v122
    v_dot2c_f32_bf16 v206, s89, v123
    v_dot2c_f32_bf16 v207, s90, v123
    v_dot2c_f32_bf16 v208, s89, v124
    v_dot2c_f32_bf16 v209, s90, v124
    v_dot2c_f32_bf16 v210, s89, v125
    v_dot2c_f32_bf16 v211, s90, v125
    v_dot2c_f32_bf16 v212, s89, v126
    v_dot2c_f32_bf16 v213, s90, v126
    v_dot2c_f32_bf16 v214, s89, v127
    v_dot2c_f32_bf16 v215, s90, v127
    v_dot2c_f32_bf16 v208, s89, v128
    v_dot2c_f32_bf16 v209, s90, v128
    v_dot2c_f32_bf16 v210, s89, v129
    v_dot2c_f32_bf16 v211, s90, v129
    v_dot2c_f32_bf16 v212, s89, v130
    v_dot2c_f32_bf16 v213, s90, v130
    v_dot2c_f32_bf16 v214, s89, v131
    v_dot2c_f32_bf16 v215, s90, v131
    v_dot2c_f32_bf16 v208, s89, v132
    v_dot2c_f32_bf16 v209, s90, v132
    v_dot2c_f32_bf16 v210, s89, v133
    v_dot2c_f32_bf16 v211, s90, v133
    v_dot2c_f32_bf16 v212, s89, v134
    v_dot2c_f32_bf16 v213, s90, v134
    v_dot2c_f32_bf16 v214, s89, v135
    v_dot2c_f32_bf16 v215, s90, v135
    s_xor_b32 s89, s89, 0x8000
    s_xor_b32 s90, s90, 0x80000000
    s_sub_u32 s67, s67, 32768
    s_sub_u32 s68, s68, 32768
    s_sub_u32 s69, s69, 32768
    s_branch ML_241
BS_253:
    buffer_store_dword v13, v11, s[32:35], s81 offen sc1
    s_branch BR_254
MF_250:
    s_add_u32 s58, s58, 1
    s_cmp_ge_u32 s58, s57
    s_cbranch_scc1 MO_251
    s_xor_b32 s89, s89, 0x8000
    s_xor_b32 s90, s90, 0x80000000
    v_dot2c_f32_bf16 v216, s89, v76
    v_dot2c_f32_bf16 v217, s90, v76
    v_dot2c_f32_bf16 v218, s89, v77
    v_dot2c_f32_bf16 v219, s90, v77
    v_dot2c_f32_bf16 v220, s89, v78
    v_dot2c_f32_bf16 v221, s90, v78
    v_dot2c_f32_bf16 v222, s89, v79
    v_dot2c_f32_bf16 v223, s90, v79
    v_dot2c_f32_bf16 v216, s89, v80
    v_dot2c_f32_bf16 v217, s90, v80
    v_dot2c_f32_bf16 v218, s89, v81
    v_dot2c_f32_bf16 v219, s90, v81
    v_dot2c_f32_bf16 v220, s89, v82
    v_dot2c_f32_bf16 v221, s90, v82
    v_dot2c_f32_bf16 v222, s89, v83
    v_dot2c_f32_bf16 v223, s90, v83
    v_dot2c_f32_bf16 v216, s89, v84
    v_dot2c_f32_bf16 v217, s90, v84
    v_dot2c_f32_bf16 v218, s89, v85
    v_dot2c_f32_bf16 v219, s90, v85
    v_dot2c_f32_bf16 v220, s89, v86
    v_dot2c_f32_bf16 v221, s90, v86
    v_dot2c_f32_bf16 v222, s89, v87
    v_dot2c_f32_bf16 v223, s90, v87
    v_dot2c_f32_bf16 v224, s89, v88
    v_dot2c_f32_bf16 v225, s90, v88
    v_dot2c_f32_bf16 v226, s89, v89
    v_dot2c_f32_bf16 v227, s90, v89
    v_dot2c_f32_bf16 v228, s89, v90
    v_dot2c_f32_bf16 v229, s90, v90
    v_dot2c_f32_bf16 v230, s89, v91
    v_dot2c_f32_bf16 v231, s90, v91
    v_dot2c_f32_bf16 v224, s89, v92
    v_dot2c_f32_bf16 v225, s90, v92
    v_dot2c_f32_bf16 v226, s89, v93
    v_dot2c_f32_bf16 v227, s90, v93
    v_dot2c_f32_bf16 v228, s89, v94
    v_dot2c_f32_bf16 v229, s90, v94
    v_dot2c_f32_bf16 v230, s89, v95
    v_dot2c_f32_bf16 v231, s90, v95
    v_dot2c_f32_bf16 v224, s89, v96
    v_dot2c_f32_bf16 v225, s90, v96
    v_dot2c_f32_bf16 v226, s89, v97
    v_dot2c_f32_bf16 v227, s90, v97
    v_dot2c_f32_bf16 v228, s89, v98
    v_dot2c_f32_bf16 v229, s90, v98
    v_dot2c_f32_bf16 v230, s89, v99
    v_dot2c_f32_bf16 v231, s90, v99
    v_dot2c_f32_bf16 v232, s89, v100
    v_dot2c_f32_bf16 v233, s90, v100
    v_dot2c_f32_bf16 v234, s89, v101
    v_dot2c_f32_bf16 v235, s90, v101
    v_dot2c_f32_bf16 v236, s89, v102
    v_dot2c_f32_bf16 v237, s90, v102
    v_dot2c_f32_bf16 v238, s89, v103
    v_dot2c_f32_bf16 v239, s90, v103
    v_dot2c_f32_bf16 v232, s89, v104
    v_dot2c_f32_bf16 v233, s90, v104
    v_dot2c_f32_bf16 v234, s89, v105
    v_dot2c_f32_bf16 v235, s90, v105
    v_dot2c_f32_bf16 v236, s89, v106
    v_dot2c_f32_bf16 v237, s90, v106
    v_dot2c_f32_bf16 v238, s89, v107
    v_dot2c_f32_bf16 v239, s90, v107
    v_dot2c_f32_bf16 v232, s89, v108
    v_dot2c_f32_bf16 v233, s90, v108
    v_dot2c_f32_bf16 v234, s89, v109
    v_dot2c_f32_bf16 v235, s90, v109
    v_dot2c_f32_bf16 v236, s89, v110
    v_dot2c_f32_bf16 v237, s90, v110
    v_dot2c_f32_bf16 v238, s89, v111
    v_dot2c_f32_bf16 v239, s90, v111
    v_dot2c_f32_bf16 v240, s89, v112
    v_dot2c_f32_bf16 v241, s90, v112
    v_dot2c_f32_bf16 v242, s89, v113
    v_dot2c_f32_bf16 v243, s90, v113
    v_dot2c_f32_bf16 v244, s89, v114
    v_dot2c_f32_bf16 v245, s90, v114
    v_dot2c_f32_bf16 v246, s89, v115
    v_dot2c_f32_bf16 v247, s90, v115
    v_dot2c_f32_bf16 v240, s89, v116
    v_dot2c_f32_bf16 v241, s90, v116
    v_dot2c_f32_bf16 v242, s89, v117
    v_dot2c_f32_bf16 v243, s90, v117
    v_dot2c_f32_bf16 v244, s89, v118
    v_dot2c_f32_bf16 v245, s90, v118
    v_dot2c_f32_bf16 v246, s89, v119
    v_dot2c_f32_bf16 v247, s90, v119
    v_dot2c_f32_bf16 v240, s89, v120
    v_dot2c_f32_bf16 v241, s90, v120
    v_dot2c_f32_bf16 v242, s89, v121
    v_dot2c_f32_bf16 v243, s90, v121
    v_dot2c_f32_bf16 v244, s89, v122
    v_dot2c_f32_bf16 v245, s90, v122
    v_dot2c_f32_bf16 v246, s89, v123
    v_dot2c_f32_bf16 v247, s90, v123
    v_dot2c_f32_bf16 v248, s89, v124
    v_dot2c_f32_bf16 v249, s90, v124
    v_dot2c_f32_bf16 v250, s89, v125
    v_dot2c_f32_bf16 v251, s90, v125
    v_dot2c_f32_bf16 v252, s89, v126
    v_dot2c_f32_bf16 v253, s90, v126
    v_dot2c_f32_bf16 v254, s89, v127
    v_dot2c_f32_bf16 v255, s90, v127
    v_dot2c_f32_bf16 v248, s89, v128
    v_dot2c_f32_bf16 v249, s90, v128
    v_dot2c_f32_bf16 v250, s89, v129
    v_dot2c_f32_bf16 v251, s90, v129
    v_dot2c_f32_bf16 v252, s89, v130
    v_dot2c_f32_bf16 v253, s90, v130
    v_dot2c_f32_bf16 v254, s89, v131
    v_dot2c_f32_bf16 v255, s90, v131
    v_dot2c_f32_bf16 v248, s89, v132
    v_dot2c_f32_bf16 v249, s90, v132
    v_dot2c_f32_bf16 v250, s89, v133
    v_dot2c_f32_bf16 v251, s90, v133
    v_dot2c_f32_bf16 v252, s89, v134
    v_dot2c_f32_bf16 v253, s90, v134
    v_dot2c_f32_bf16 v254, s89, v135
    v_dot2c_f32_bf16 v255, s90, v135
    s_xor_b32 s89, s89, 0x8000
    s_xor_b32 s90, s90, 0x80000000
    s_sub_u32 s67, s67, 32768
    s_sub_u32 s68, s68, 32768
    s_sub_u32 s69, s69, 32768
    s_branch ML_249
END:
    s_endpgm
.section .rodata,"a"
.p2align 6
.amdhsa_kernel interleave_layers__ssm_conv_h3__mixer_channel_mlp__prompt_kernel
  .amdhsa_next_free_vgpr 256
  .amdhsa_next_free_sgpr 102
  .amdhsa_accum_offset 256
  .amdhsa_group_segment_fixed_size 0
  .amdhsa_kernarg_size 112
  .amdhsa_user_sgpr_count 2
  .amdhsa_user_sgpr_kernarg_segment_ptr 1
  .amdhsa_system_sgpr_workgroup_id_x 1
.end_amdhsa_kernel
```
